```python
import torch

def _softmax(x, axis=-1):
    return torch.softmax(x, dim=axis)

def _gelu(x):
    return torch.nn.functional.gelu(x, approximate='tanh')

def _silu(x):
    return torch.nn.functional.silu(x)

def _sigmoid(x):
    return torch.sigmoid(x)

def _layernorm(x, axis=-1, eps=1e-05):
    m = x.mean(dim=axis, keepdim=True)
    v = x.var(dim=axis, keepdim=True, unbiased=False)
    return (x - m) / torch.sqrt(v + eps)

def _scatter_add(tgt, idx, src, axis=0):
    return tgt.clone().index_add_(axis, idx, src)

def _segment_sum(src, seg, n):
    out = torch.zeros((n,) + src.shape[1:], dtype=src.dtype)
    return out.index_add_(0, seg, src)

def _pad(x, pw):
    flat = tuple((v for pair in reversed(pw) for v in pair))
    return torch.nn.functional.pad(x, flat)
kernel_name = 'parallel_sum__softmax_full_mha__mixer_gmlp__prompt'

def setup_inputs():

    _w = lambda a: (lambda t: t.to(torch.bfloat16) if t.is_floating_point() else t)(torch.as_tensor(a))

    def _A_setup():
        B, S, D = (1, 2048, 512)
        return {'x': _w((lambda *s: torch.randn(*s, dtype=torch.bfloat16) * 0.05)(B, S, D)), 'wqkv': _w((lambda *s: torch.randn(*s, dtype=torch.bfloat16) * 0.2)(D, 3 * D)), 'wo': _w((lambda *s: torch.randn(*s, dtype=torch.bfloat16) * 0.1)(D, D))}
    _A_in = _A_setup()

    def _B_setup():
        B, S, D, F = (1, 2048, 512, 1376)
        Fh = F // 2
        return {'x': _w((lambda *s: torch.randn(*s, dtype=torch.bfloat16) * 0.05)(B, S, D)), 'w_in': _w((lambda *s: torch.randn(*s, dtype=torch.bfloat16) * 0.8)(D, 2 * Fh)), 'w_sp': _w(0.01 * (lambda *s: torch.randn(*s, dtype=torch.bfloat16) * 0.8)(S, S)), 'b_sp': _w(1.0 + 0.01 * (lambda *s: torch.randn(*s, dtype=torch.bfloat16) * 0.1)(S)), 'w_out': _w((lambda *s: torch.randn(*s, dtype=torch.bfloat16) * 0.1)(Fh, D))}
    _B_in = _B_setup()
    return {'A_x': _A_in['x'], 'A_wqkv': _A_in['wqkv'], 'A_wo': _A_in['wo'], 'B_x': _B_in['x'], 'B_w_in': _B_in['w_in'], 'B_w_sp': _B_in['w_sp'], 'B_b_sp': _B_in['b_sp'], 'B_w_out': _B_in['w_out']}

def reference(A_x, A_wqkv, A_wo, B_x, B_w_in, B_w_sp, B_b_sp, B_w_out):

    def _A_ref(x, wqkv, wo):
        B, S, D = x.shape
        H = 32
        Dh = D // H
        qkv = (lambda x, *d: x.permute(*d))((x @ wqkv).reshape(B, S, 3, H, Dh), 2, 0, 3, 1, 4)
        q, k, v = (qkv[0], qkv[1], qkv[2])
        scale = Dh ** (-0.5)
        scores = torch.einsum('bhqd,bhkd->bhqk', q, k) * scale
        p = _softmax(scores, axis=-1)
        o = torch.einsum('bhqk,bhkd->bhqd', p, v)
        return (lambda x, *d: x.permute(*d))(o, 0, 2, 1, 3).reshape(B, S, D) @ wo

    def _B_ref(x, w_in, w_sp, b_sp, w_out):
        B, S, D = x.shape
        F = w_in.shape[-1]
        Fh = F // 2
        z = _gelu(torch.einsum('bsd,df->bsf', x, w_in))
        z1 = z[..., :Fh].clone()
        z2 = _layernorm(z[..., Fh:], axis=-1)
        g = torch.einsum('ts,bsf->btf', w_sp, z2) + b_sp[None, :, None]
        return torch.einsum('bsf,fd->bsd', z1 * g, w_out)
    x = A_x
    xn = _layernorm(x, axis=-1)
    return x + _A_ref(xn, A_wqkv, A_wo) + _B_ref(xn, B_w_in, B_w_sp, B_b_sp, B_w_out)
```

```asm
; @launch grid=(256,1,1) block=(768,1,1) lds=163840
.amdgcn_target "amdgcn-amd-amdhsa--gfx950"
.text
.globl parallel_sum__softmax_full_mha__mixer_gmlp__prompt_kernel
.p2align 8
.type parallel_sum__softmax_full_mha__mixer_gmlp__prompt_kernel,@function
parallel_sum__softmax_full_mha__mixer_gmlp__prompt_kernel:
    s_cmp_ge_u32 s2, 256
    s_cbranch_scc1 m_end
    s_load_dwordx4 s[4:7], s[0:1], 0
    s_load_dwordx2 s[8:9], s[0:1], 32
    s_load_dwordx2 s[10:11], s[0:1], 80
    v_lshrrev_b32 v1, 6, v0
    v_and_b32 v2, 63, v0
    s_and_b32 s3, s2, 7
    v_readfirstlane_b32 s12, v1
    s_lshr_b32 s35, s2, 3
    s_and_b32 s15, s3, 1
    s_lshl_b32 s15, s15, 3
    s_and_b32 s36, s35, 7
    s_add_u32 s15, s15, s36
    s_and_b32 s16, s3, 6
    s_bfe_u32 s36, s35, 0x10003
    s_add_u32 s16, s16, s36
    s_lshr_b32 s17, s35, 4
    v_and_b32 v3, 31, v2
    v_lshrrev_b32 v4, 5, v2
    s_add_u32 s72, s16, 19
    s_sub_u32 s36, s16, 4
    s_cmp_lt_u32 s16, 3
    s_cselect_b32 s72, s72, s36
    s_cmp_eq_u32 s16, 3
    s_cselect_b32 s72, 10, s72
    s_add_u32 s73, s16, 4
    s_add_u32 s36, s16, 16
    s_cmp_lt_u32 s16, 6
    s_cselect_b32 s73, s73, s36
    s_add_u32 s36, s16, 11
    s_cmp_eq_u32 s17, 0
    s_cselect_b32 s73, s36, s73
    s_cselect_b32 s74, s36, s72
    s_cmp_lt_u32 s12, 4
    s_cbranch_scc1 m_compute
    s_cmp_ge_u32 s12, 8
    s_cbranch_scc1 m_aux
m_loader:
    s_setprio 3
    s_sub_u32 s13, s12, 4
    s_lshl_b32 s18, s13, 12
    s_add_u32 s19, s18, 65536
    s_and_b32 s60, s16, 3
    s_lshl_b32 s60, s60, 1
    s_add_u32 s60, s60, s15
    s_and_b32 s60, s60, 7
    v_lshrrev_b32 v5, 3, v2
    s_lshl_b32 s36, s13, 5
    s_lshl_b32 s37, s15, 7
    s_add_u32 s36, s36, s37
    v_add_u32 v6, s36, v5
    v_lshlrev_b32 v6, 10, v6
    v_lshrrev_b32 v7, 4, v2
    v_and_b32 v18, 7, v2
    v_xor_b32 v19, v7, v18
    v_lshl_add_u32 v8, v19, 4, v6
    v_xor_b32 v19, 4, v19
    v_lshl_add_u32 v9, v19, 4, v6
    v_add_u32 v9, 7168, v9
    v_add_u32 v10, 14336, v8
    v_add_u32 v11, 14336, v9
    s_lshl_b32 s36, s13, 4
    v_add_u32 v5, s36, v5
    v_bfe_u32 v19, v2, 4, 1
    v_lshlrev_b32 v19, 2, v19
    v_xor_b32 v19, v19, v18
    v_lshlrev_b32 v19, 4, v19
    s_movk_i32 s36, 3072
    s_movk_i32 s37, 2752
    v_mad_u32_u24 v12, v5, s36, v19
    v_mad_u32_u24 v14, v5, s37, v19
    v_add_u32 v13, 23552, v12
    v_add_u32 v15, 20992, v14
    s_lshl_b32 s36, s16, 7
    s_lshl_b32 s48, s17, 11
    s_add_u32 s48, s48, s36
    s_add_u32 s49, s36, 1024
    s_lshl_b32 s50, s74, 7
    s_lshl_b32 s51, s73, 7
    s_waitcnt lgkmcnt(0)
    s_mov_b32 s20, s4
    s_mov_b32 s21, s5
    s_mov_b32 s22, 2097152
    s_mov_b32 s23, 0x20000
    s_mov_b32 s24, s6
    s_mov_b32 s25, s7
    s_mov_b32 s26, 1572864
    s_mov_b32 s27, 0x20000
    s_mov_b32 s44, s8
    s_mov_b32 s45, s9
    s_mov_b32 s46, 1409024
    s_mov_b32 s47, 0x20000
    s_cmp_eq_u32 s17, 0
    s_cbranch_scc0 m_loader1
    s_add_u32 m0, s18, 0
    s_lshl_b32 s32, s60, 7
    buffer_load_dwordx4 v8, s[20:23], s32 offen offset:0 lds
    buffer_load_dwordx4 v9, s[20:23], s32 offen offset:1024 lds
    buffer_load_dwordx4 v10, s[20:23], s32 offen offset:2048 lds
    buffer_load_dwordx4 v11, s[20:23], s32 offen offset:3072 lds
    s_mul_i32 s33, s60, 196608
    s_add_u32 m0, s19, 0
    s_add_u32 s32, s33, s48
    buffer_load_dwordx4 v12, s[24:27], s32 offen lds
    buffer_load_dwordx4 v13, s[24:27], s32 offen offset:1024 lds
    s_add_u32 m0, s19, 2048
    s_add_u32 s32, s33, s49
    buffer_load_dwordx4 v12, s[24:27], s32 offen lds
    buffer_load_dwordx4 v13, s[24:27], s32 offen offset:1024 lds
    s_add_u32 s60, s60, 1
    s_and_b32 s60, s60, 7
    s_add_u32 m0, s18, 16384
    s_lshl_b32 s32, s60, 7
    buffer_load_dwordx4 v8, s[20:23], s32 offen offset:0 lds
    buffer_load_dwordx4 v9, s[20:23], s32 offen offset:1024 lds
    buffer_load_dwordx4 v10, s[20:23], s32 offen offset:2048 lds
    buffer_load_dwordx4 v11, s[20:23], s32 offen offset:3072 lds
    s_mul_i32 s33, s60, 196608
    s_add_u32 m0, s19, 16384
    s_add_u32 s32, s33, s48
    buffer_load_dwordx4 v12, s[24:27], s32 offen lds
    buffer_load_dwordx4 v13, s[24:27], s32 offen offset:1024 lds
    s_add_u32 m0, s19, 18432
    s_add_u32 s32, s33, s49
    buffer_load_dwordx4 v12, s[24:27], s32 offen lds
    buffer_load_dwordx4 v13, s[24:27], s32 offen offset:1024 lds
    s_add_u32 s60, s60, 1
    s_and_b32 s60, s60, 7
    s_add_u32 m0, s18, 32768
    s_lshl_b32 s32, s60, 7
    buffer_load_dwordx4 v8, s[20:23], s32 offen offset:0 lds
    buffer_load_dwordx4 v9, s[20:23], s32 offen offset:1024 lds
    buffer_load_dwordx4 v10, s[20:23], s32 offen offset:2048 lds
    buffer_load_dwordx4 v11, s[20:23], s32 offen offset:3072 lds
    s_mul_i32 s33, s60, 196608
    s_add_u32 m0, s19, 32768
    s_add_u32 s32, s33, s48
    buffer_load_dwordx4 v12, s[24:27], s32 offen lds
    buffer_load_dwordx4 v13, s[24:27], s32 offen offset:1024 lds
    s_add_u32 m0, s19, 34816
    s_add_u32 s32, s33, s49
    buffer_load_dwordx4 v12, s[24:27], s32 offen lds
    buffer_load_dwordx4 v13, s[24:27], s32 offen offset:1024 lds
    s_add_u32 s60, s60, 1
    s_and_b32 s60, s60, 7
    s_mov_b32 s36, 24444928
    s_load_dword s61, s[10:11], s36
    s_waitcnt lgkmcnt(0)
    s_mul_i32 s61, s61, 1664525
    s_add_u32 s61, s61, 1013904223
    s_waitcnt vmcnt(16)
    s_barrier
    s_add_u32 m0, s18, 49152
    s_lshl_b32 s32, s60, 7
    buffer_load_dwordx4 v8, s[20:23], s32 offen offset:0 lds
    buffer_load_dwordx4 v9, s[20:23], s32 offen offset:1024 lds
    buffer_load_dwordx4 v10, s[20:23], s32 offen offset:2048 lds
    buffer_load_dwordx4 v11, s[20:23], s32 offen offset:3072 lds
    s_mul_i32 s33, s60, 196608
    s_add_u32 m0, s19, 49152
    s_add_u32 s32, s33, s48
    buffer_load_dwordx4 v12, s[24:27], s32 offen lds
    buffer_load_dwordx4 v13, s[24:27], s32 offen offset:1024 lds
    s_add_u32 m0, s19, 51200
    s_add_u32 s32, s33, s49
    buffer_load_dwordx4 v12, s[24:27], s32 offen lds
    buffer_load_dwordx4 v13, s[24:27], s32 offen offset:1024 lds
    s_add_u32 s60, s60, 1
    s_and_b32 s60, s60, 7
    s_waitcnt vmcnt(16)
    s_barrier
    s_add_u32 m0, s18, 0
    s_lshl_b32 s32, s60, 7
    buffer_load_dwordx4 v8, s[20:23], s32 offen offset:0 lds
    buffer_load_dwordx4 v9, s[20:23], s32 offen offset:1024 lds
    buffer_load_dwordx4 v10, s[20:23], s32 offen offset:2048 lds
    buffer_load_dwordx4 v11, s[20:23], s32 offen offset:3072 lds
    s_mul_i32 s33, s60, 196608
    s_add_u32 m0, s19, 0
    s_add_u32 s32, s33, s48
    buffer_load_dwordx4 v12, s[24:27], s32 offen lds
    buffer_load_dwordx4 v13, s[24:27], s32 offen offset:1024 lds
    s_add_u32 m0, s19, 2048
    s_add_u32 s32, s33, s49
    buffer_load_dwordx4 v12, s[24:27], s32 offen lds
    buffer_load_dwordx4 v13, s[24:27], s32 offen offset:1024 lds
    s_add_u32 s60, s60, 1
    s_and_b32 s60, s60, 7
    s_waitcnt vmcnt(16)
    s_barrier
    s_add_u32 m0, s18, 16384
    s_lshl_b32 s32, s60, 7
    buffer_load_dwordx4 v8, s[20:23], s32 offen offset:0 lds
    buffer_load_dwordx4 v9, s[20:23], s32 offen offset:1024 lds
    buffer_load_dwordx4 v10, s[20:23], s32 offen offset:2048 lds
    buffer_load_dwordx4 v11, s[20:23], s32 offen offset:3072 lds
    s_mul_i32 s33, s60, 196608
    s_add_u32 m0, s19, 16384
    s_add_u32 s32, s33, s48
    buffer_load_dwordx4 v12, s[24:27], s32 offen lds
    buffer_load_dwordx4 v13, s[24:27], s32 offen offset:1024 lds
    s_add_u32 m0, s19, 18432
    s_add_u32 s32, s33, s49
    buffer_load_dwordx4 v12, s[24:27], s32 offen lds
    buffer_load_dwordx4 v13, s[24:27], s32 offen offset:1024 lds
    s_add_u32 s60, s60, 1
    s_and_b32 s60, s60, 7
    s_waitcnt vmcnt(16)
    s_barrier
    s_add_u32 m0, s18, 32768
    s_lshl_b32 s32, s60, 7
    buffer_load_dwordx4 v8, s[20:23], s32 offen offset:0 lds
    buffer_load_dwordx4 v9, s[20:23], s32 offen offset:1024 lds
    buffer_load_dwordx4 v10, s[20:23], s32 offen offset:2048 lds
    buffer_load_dwordx4 v11, s[20:23], s32 offen offset:3072 lds
    s_mul_i32 s33, s60, 196608
    s_add_u32 m0, s19, 32768
    s_add_u32 s32, s33, s48
    buffer_load_dwordx4 v12, s[24:27], s32 offen lds
    buffer_load_dwordx4 v13, s[24:27], s32 offen offset:1024 lds
    s_add_u32 m0, s19, 34816
    s_add_u32 s32, s33, s49
    buffer_load_dwordx4 v12, s[24:27], s32 offen lds
    buffer_load_dwordx4 v13, s[24:27], s32 offen offset:1024 lds
    s_add_u32 s60, s60, 1
    s_and_b32 s60, s60, 7
    s_waitcnt vmcnt(16)
    s_barrier
    s_add_u32 m0, s18, 49152
    s_lshl_b32 s32, s60, 7
    buffer_load_dwordx4 v8, s[20:23], s32 offen offset:0 lds
    buffer_load_dwordx4 v9, s[20:23], s32 offen offset:1024 lds
    buffer_load_dwordx4 v10, s[20:23], s32 offen offset:2048 lds
    buffer_load_dwordx4 v11, s[20:23], s32 offen offset:3072 lds
    s_mul_i32 s33, s60, 196608
    s_add_u32 m0, s19, 49152
    s_add_u32 s32, s33, s48
    buffer_load_dwordx4 v12, s[24:27], s32 offen lds
    buffer_load_dwordx4 v13, s[24:27], s32 offen offset:1024 lds
    s_add_u32 m0, s19, 51200
    s_add_u32 s32, s33, s49
    buffer_load_dwordx4 v12, s[24:27], s32 offen lds
    buffer_load_dwordx4 v13, s[24:27], s32 offen offset:1024 lds
    s_add_u32 s60, s60, 1
    s_and_b32 s60, s60, 7
    s_waitcnt vmcnt(16)
    s_barrier
    s_xor_b32 s60, s60, 4
    s_mul_i32 s33, s60, 176128
    s_add_u32 m0, s19, 0
    s_add_u32 s32, s33, s50
    buffer_load_dwordx4 v14, s[44:47], s32 offen lds
    buffer_load_dwordx4 v15, s[44:47], s32 offen offset:1024 lds
    s_add_u32 s60, s60, 1
    s_and_b32 s60, s60, 7
    s_waitcnt vmcnt(10)
    s_barrier
    s_mul_i32 s33, s60, 176128
    s_add_u32 m0, s19, 16384
    s_add_u32 s32, s33, s50
    buffer_load_dwordx4 v14, s[44:47], s32 offen lds
    buffer_load_dwordx4 v15, s[44:47], s32 offen offset:1024 lds
    s_add_u32 s60, s60, 1
    s_and_b32 s60, s60, 7
    s_waitcnt vmcnt(4)
    s_barrier
    s_mul_i32 s33, s60, 176128
    s_add_u32 m0, s19, 32768
    s_add_u32 s32, s33, s50
    buffer_load_dwordx4 v14, s[44:47], s32 offen lds
    buffer_load_dwordx4 v15, s[44:47], s32 offen offset:1024 lds
    s_add_u32 s60, s60, 1
    s_and_b32 s60, s60, 7
    s_waitcnt vmcnt(2)
    s_barrier
    s_mul_i32 s33, s60, 176128
    s_add_u32 m0, s19, 49152
    s_add_u32 s32, s33, s50
    buffer_load_dwordx4 v14, s[44:47], s32 offen lds
    buffer_load_dwordx4 v15, s[44:47], s32 offen offset:1024 lds
    s_add_u32 s60, s60, 1
    s_and_b32 s60, s60, 7
    s_waitcnt vmcnt(0)
    s_barrier
    s_add_u32 m0, s18, 0
    s_lshl_b32 s32, s60, 7
    buffer_load_dwordx4 v8, s[20:23], s32 offen offset:0 lds
    buffer_load_dwordx4 v9, s[20:23], s32 offen offset:1024 lds
    buffer_load_dwordx4 v10, s[20:23], s32 offen offset:2048 lds
    buffer_load_dwordx4 v11, s[20:23], s32 offen offset:3072 lds
    s_mul_i32 s33, s60, 176128
    s_add_u32 m0, s19, 0
    s_add_u32 s32, s33, s50
    buffer_load_dwordx4 v14, s[44:47], s32 offen lds
    buffer_load_dwordx4 v15, s[44:47], s32 offen offset:1024 lds
    s_add_u32 s60, s60, 1
    s_and_b32 s60, s60, 7
    s_add_u32 m0, s18, 16384
    s_lshl_b32 s32, s60, 7
    buffer_load_dwordx4 v8, s[20:23], s32 offen offset:0 lds
    buffer_load_dwordx4 v9, s[20:23], s32 offen offset:1024 lds
    buffer_load_dwordx4 v10, s[20:23], s32 offen offset:2048 lds
    buffer_load_dwordx4 v11, s[20:23], s32 offen offset:3072 lds
    s_mul_i32 s33, s60, 176128
    s_add_u32 m0, s19, 16384
    s_add_u32 s32, s33, s50
    buffer_load_dwordx4 v14, s[44:47], s32 offen lds
    buffer_load_dwordx4 v15, s[44:47], s32 offen offset:1024 lds
    s_add_u32 s60, s60, 1
    s_and_b32 s60, s60, 7
    s_waitcnt vmcnt(0)
    s_barrier
    s_add_u32 m0, s18, 32768
    s_lshl_b32 s32, s60, 7
    buffer_load_dwordx4 v8, s[20:23], s32 offen offset:0 lds
    buffer_load_dwordx4 v9, s[20:23], s32 offen offset:1024 lds
    buffer_load_dwordx4 v10, s[20:23], s32 offen offset:2048 lds
    buffer_load_dwordx4 v11, s[20:23], s32 offen offset:3072 lds
    s_mul_i32 s33, s60, 176128
    s_add_u32 m0, s19, 32768
    s_add_u32 s32, s33, s50
    buffer_load_dwordx4 v14, s[44:47], s32 offen lds
    buffer_load_dwordx4 v15, s[44:47], s32 offen offset:1024 lds
    s_add_u32 s60, s60, 1
    s_and_b32 s60, s60, 7
    s_add_u32 m0, s18, 49152
    s_lshl_b32 s32, s60, 7
    buffer_load_dwordx4 v8, s[20:23], s32 offen offset:0 lds
    buffer_load_dwordx4 v9, s[20:23], s32 offen offset:1024 lds
    buffer_load_dwordx4 v10, s[20:23], s32 offen offset:2048 lds
    buffer_load_dwordx4 v11, s[20:23], s32 offen offset:3072 lds
    s_mul_i32 s33, s60, 176128
    s_add_u32 m0, s19, 49152
    s_add_u32 s32, s33, s50
    buffer_load_dwordx4 v14, s[44:47], s32 offen lds
    buffer_load_dwordx4 v15, s[44:47], s32 offen offset:1024 lds
    s_add_u32 s60, s60, 1
    s_and_b32 s60, s60, 7
    s_branch m_attn
m_loader1:
    s_add_u32 m0, s18, 0
    s_lshl_b32 s32, s60, 7
    buffer_load_dwordx4 v8, s[20:23], s32 offen offset:0 lds
    buffer_load_dwordx4 v9, s[20:23], s32 offen offset:1024 lds
    buffer_load_dwordx4 v10, s[20:23], s32 offen offset:2048 lds
    buffer_load_dwordx4 v11, s[20:23], s32 offen offset:3072 lds
    s_mul_i32 s33, s60, 196608
    s_add_u32 m0, s19, 0
    s_add_u32 s32, s33, s48
    buffer_load_dwordx4 v12, s[24:27], s32 offen lds
    buffer_load_dwordx4 v13, s[24:27], s32 offen offset:1024 lds
    s_add_u32 s60, s60, 1
    s_and_b32 s60, s60, 7
    s_add_u32 m0, s18, 16384
    s_lshl_b32 s32, s60, 7
    buffer_load_dwordx4 v8, s[20:23], s32 offen offset:0 lds
    buffer_load_dwordx4 v9, s[20:23], s32 offen offset:1024 lds
    buffer_load_dwordx4 v10, s[20:23], s32 offen offset:2048 lds
    buffer_load_dwordx4 v11, s[20:23], s32 offen offset:3072 lds
    s_mul_i32 s33, s60, 196608
    s_add_u32 m0, s19, 16384
    s_add_u32 s32, s33, s48
    buffer_load_dwordx4 v12, s[24:27], s32 offen lds
    buffer_load_dwordx4 v13, s[24:27], s32 offen offset:1024 lds
    s_add_u32 s60, s60, 1
    s_and_b32 s60, s60, 7
    s_add_u32 m0, s18, 32768
    s_lshl_b32 s32, s60, 7
    buffer_load_dwordx4 v8, s[20:23], s32 offen offset:0 lds
    buffer_load_dwordx4 v9, s[20:23], s32 offen offset:1024 lds
    buffer_load_dwordx4 v10, s[20:23], s32 offen offset:2048 lds
    buffer_load_dwordx4 v11, s[20:23], s32 offen offset:3072 lds
    s_mul_i32 s33, s60, 196608
    s_add_u32 m0, s19, 32768
    s_add_u32 s32, s33, s48
    buffer_load_dwordx4 v12, s[24:27], s32 offen lds
    buffer_load_dwordx4 v13, s[24:27], s32 offen offset:1024 lds
    s_add_u32 s60, s60, 1
    s_and_b32 s60, s60, 7
    s_mov_b32 s36, 24444928
    s_load_dword s61, s[10:11], s36
    s_waitcnt lgkmcnt(0)
    s_mul_i32 s61, s61, 1664525
    s_add_u32 s61, s61, 1013904223
    s_waitcnt vmcnt(12)
    s_barrier
    s_add_u32 m0, s18, 49152
    s_lshl_b32 s32, s60, 7
    buffer_load_dwordx4 v8, s[20:23], s32 offen offset:0 lds
    buffer_load_dwordx4 v9, s[20:23], s32 offen offset:1024 lds
    buffer_load_dwordx4 v10, s[20:23], s32 offen offset:2048 lds
    buffer_load_dwordx4 v11, s[20:23], s32 offen offset:3072 lds
    s_mul_i32 s33, s60, 196608
    s_add_u32 m0, s19, 49152
    s_add_u32 s32, s33, s48
    buffer_load_dwordx4 v12, s[24:27], s32 offen lds
    buffer_load_dwordx4 v13, s[24:27], s32 offen offset:1024 lds
    s_add_u32 s60, s60, 1
    s_and_b32 s60, s60, 7
    s_waitcnt vmcnt(12)
    s_barrier
    s_add_u32 m0, s18, 0
    s_lshl_b32 s32, s60, 7
    buffer_load_dwordx4 v8, s[20:23], s32 offen offset:0 lds
    buffer_load_dwordx4 v9, s[20:23], s32 offen offset:1024 lds
    buffer_load_dwordx4 v10, s[20:23], s32 offen offset:2048 lds
    buffer_load_dwordx4 v11, s[20:23], s32 offen offset:3072 lds
    s_mul_i32 s33, s60, 196608
    s_add_u32 m0, s19, 0
    s_add_u32 s32, s33, s48
    buffer_load_dwordx4 v12, s[24:27], s32 offen lds
    buffer_load_dwordx4 v13, s[24:27], s32 offen offset:1024 lds
    s_add_u32 s60, s60, 1
    s_and_b32 s60, s60, 7
    s_waitcnt vmcnt(12)
    s_barrier
    s_add_u32 m0, s18, 16384
    s_lshl_b32 s32, s60, 7
    buffer_load_dwordx4 v8, s[20:23], s32 offen offset:0 lds
    buffer_load_dwordx4 v9, s[20:23], s32 offen offset:1024 lds
    buffer_load_dwordx4 v10, s[20:23], s32 offen offset:2048 lds
    buffer_load_dwordx4 v11, s[20:23], s32 offen offset:3072 lds
    s_mul_i32 s33, s60, 196608
    s_add_u32 m0, s19, 16384
    s_add_u32 s32, s33, s48
    buffer_load_dwordx4 v12, s[24:27], s32 offen lds
    buffer_load_dwordx4 v13, s[24:27], s32 offen offset:1024 lds
    s_add_u32 s60, s60, 1
    s_and_b32 s60, s60, 7
    s_waitcnt vmcnt(12)
    s_barrier
    s_add_u32 m0, s18, 32768
    s_lshl_b32 s32, s60, 7
    buffer_load_dwordx4 v8, s[20:23], s32 offen offset:0 lds
    buffer_load_dwordx4 v9, s[20:23], s32 offen offset:1024 lds
    buffer_load_dwordx4 v10, s[20:23], s32 offen offset:2048 lds
    buffer_load_dwordx4 v11, s[20:23], s32 offen offset:3072 lds
    s_mul_i32 s33, s60, 196608
    s_add_u32 m0, s19, 32768
    s_add_u32 s32, s33, s48
    buffer_load_dwordx4 v12, s[24:27], s32 offen lds
    buffer_load_dwordx4 v13, s[24:27], s32 offen offset:1024 lds
    s_add_u32 s60, s60, 1
    s_and_b32 s60, s60, 7
    s_waitcnt vmcnt(12)
    s_barrier
    s_add_u32 m0, s18, 49152
    s_lshl_b32 s32, s60, 7
    buffer_load_dwordx4 v8, s[20:23], s32 offen offset:0 lds
    buffer_load_dwordx4 v9, s[20:23], s32 offen offset:1024 lds
    buffer_load_dwordx4 v10, s[20:23], s32 offen offset:2048 lds
    buffer_load_dwordx4 v11, s[20:23], s32 offen offset:3072 lds
    s_mul_i32 s33, s60, 196608
    s_add_u32 m0, s19, 49152
    s_add_u32 s32, s33, s48
    buffer_load_dwordx4 v12, s[24:27], s32 offen lds
    buffer_load_dwordx4 v13, s[24:27], s32 offen offset:1024 lds
    s_add_u32 s60, s60, 1
    s_and_b32 s60, s60, 7
    s_waitcnt vmcnt(12)
    s_barrier
    s_xor_b32 s60, s60, 4
    s_mul_i32 s33, s60, 176128
    s_add_u32 m0, s19, 0
    s_add_u32 s32, s33, s50
    buffer_load_dwordx4 v14, s[44:47], s32 offen lds
    buffer_load_dwordx4 v15, s[44:47], s32 offen offset:1024 lds
    s_add_u32 m0, s19, 2048
    s_add_u32 s32, s33, s51
    buffer_load_dwordx4 v14, s[44:47], s32 offen lds
    buffer_load_dwordx4 v15, s[44:47], s32 offen offset:1024 lds
    s_add_u32 s60, s60, 1
    s_and_b32 s60, s60, 7
    s_waitcnt vmcnt(10)
    s_barrier
    s_mul_i32 s33, s60, 176128
    s_add_u32 m0, s19, 16384
    s_add_u32 s32, s33, s50
    buffer_load_dwordx4 v14, s[44:47], s32 offen lds
    buffer_load_dwordx4 v15, s[44:47], s32 offen offset:1024 lds
    s_add_u32 m0, s19, 18432
    s_add_u32 s32, s33, s51
    buffer_load_dwordx4 v14, s[44:47], s32 offen lds
    buffer_load_dwordx4 v15, s[44:47], s32 offen offset:1024 lds
    s_add_u32 s60, s60, 1
    s_and_b32 s60, s60, 7
    s_waitcnt vmcnt(8)
    s_barrier
    s_mul_i32 s33, s60, 176128
    s_add_u32 m0, s19, 32768
    s_add_u32 s32, s33, s50
    buffer_load_dwordx4 v14, s[44:47], s32 offen lds
    buffer_load_dwordx4 v15, s[44:47], s32 offen offset:1024 lds
    s_add_u32 m0, s19, 34816
    s_add_u32 s32, s33, s51
    buffer_load_dwordx4 v14, s[44:47], s32 offen lds
    buffer_load_dwordx4 v15, s[44:47], s32 offen offset:1024 lds
    s_add_u32 s60, s60, 1
    s_and_b32 s60, s60, 7
    s_waitcnt vmcnt(4)
    s_barrier
    s_mul_i32 s33, s60, 176128
    s_add_u32 m0, s19, 49152
    s_add_u32 s32, s33, s50
    buffer_load_dwordx4 v14, s[44:47], s32 offen lds
    buffer_load_dwordx4 v15, s[44:47], s32 offen offset:1024 lds
    s_add_u32 m0, s19, 51200
    s_add_u32 s32, s33, s51
    buffer_load_dwordx4 v14, s[44:47], s32 offen lds
    buffer_load_dwordx4 v15, s[44:47], s32 offen offset:1024 lds
    s_add_u32 s60, s60, 1
    s_and_b32 s60, s60, 7
    s_waitcnt vmcnt(0)
    s_barrier
    s_add_u32 m0, s18, 0
    s_lshl_b32 s32, s60, 7
    buffer_load_dwordx4 v8, s[20:23], s32 offen offset:0 lds
    buffer_load_dwordx4 v9, s[20:23], s32 offen offset:1024 lds
    buffer_load_dwordx4 v10, s[20:23], s32 offen offset:2048 lds
    buffer_load_dwordx4 v11, s[20:23], s32 offen offset:3072 lds
    s_mul_i32 s33, s60, 176128
    s_add_u32 m0, s19, 0
    s_add_u32 s32, s33, s50
    buffer_load_dwordx4 v14, s[44:47], s32 offen lds
    buffer_load_dwordx4 v15, s[44:47], s32 offen offset:1024 lds
    s_add_u32 m0, s19, 2048
    s_add_u32 s32, s33, s51
    buffer_load_dwordx4 v14, s[44:47], s32 offen lds
    buffer_load_dwordx4 v15, s[44:47], s32 offen offset:1024 lds
    s_add_u32 s60, s60, 1
    s_and_b32 s60, s60, 7
    s_add_u32 m0, s18, 16384
    s_lshl_b32 s32, s60, 7
    buffer_load_dwordx4 v8, s[20:23], s32 offen offset:0 lds
    buffer_load_dwordx4 v9, s[20:23], s32 offen offset:1024 lds
    buffer_load_dwordx4 v10, s[20:23], s32 offen offset:2048 lds
    buffer_load_dwordx4 v11, s[20:23], s32 offen offset:3072 lds
    s_mul_i32 s33, s60, 176128
    s_add_u32 m0, s19, 16384
    s_add_u32 s32, s33, s50
    buffer_load_dwordx4 v14, s[44:47], s32 offen lds
    buffer_load_dwordx4 v15, s[44:47], s32 offen offset:1024 lds
    s_add_u32 m0, s19, 18432
    s_add_u32 s32, s33, s51
    buffer_load_dwordx4 v14, s[44:47], s32 offen lds
    buffer_load_dwordx4 v15, s[44:47], s32 offen offset:1024 lds
    s_add_u32 s60, s60, 1
    s_and_b32 s60, s60, 7
    s_waitcnt vmcnt(0)
    s_barrier
    s_add_u32 m0, s18, 32768
    s_lshl_b32 s32, s60, 7
    buffer_load_dwordx4 v8, s[20:23], s32 offen offset:0 lds
    buffer_load_dwordx4 v9, s[20:23], s32 offen offset:1024 lds
    buffer_load_dwordx4 v10, s[20:23], s32 offen offset:2048 lds
    buffer_load_dwordx4 v11, s[20:23], s32 offen offset:3072 lds
    s_mul_i32 s33, s60, 176128
    s_add_u32 m0, s19, 32768
    s_add_u32 s32, s33, s50
    buffer_load_dwordx4 v14, s[44:47], s32 offen lds
    buffer_load_dwordx4 v15, s[44:47], s32 offen offset:1024 lds
    s_add_u32 m0, s19, 34816
    s_add_u32 s32, s33, s51
    buffer_load_dwordx4 v14, s[44:47], s32 offen lds
    buffer_load_dwordx4 v15, s[44:47], s32 offen offset:1024 lds
    s_add_u32 s60, s60, 1
    s_and_b32 s60, s60, 7
    s_add_u32 m0, s18, 49152
    s_lshl_b32 s32, s60, 7
    buffer_load_dwordx4 v8, s[20:23], s32 offen offset:0 lds
    buffer_load_dwordx4 v9, s[20:23], s32 offen offset:1024 lds
    buffer_load_dwordx4 v10, s[20:23], s32 offen offset:2048 lds
    buffer_load_dwordx4 v11, s[20:23], s32 offen offset:3072 lds
    s_mul_i32 s33, s60, 176128
    s_add_u32 m0, s19, 49152
    s_add_u32 s32, s33, s50
    buffer_load_dwordx4 v14, s[44:47], s32 offen lds
    buffer_load_dwordx4 v15, s[44:47], s32 offen offset:1024 lds
    s_add_u32 m0, s19, 51200
    s_add_u32 s32, s33, s51
    buffer_load_dwordx4 v14, s[44:47], s32 offen lds
    buffer_load_dwordx4 v15, s[44:47], s32 offen offset:1024 lds
    s_add_u32 s60, s60, 1
    s_and_b32 s60, s60, 7
    s_branch m_attn
m_aux:
    s_load_dwordx2 s[68:69], s[0:1], 16
    s_load_dwordx2 s[70:71], s[0:1], 56
    s_load_dwordx2 s[62:63], s[0:1], 40
    s_sub_u32 s13, s12, 8
    s_lshl_b32 s14, s17, 3
    s_add_u32 s14, s14, s16
    v_lshrrev_b32 v7, 4, v2
    s_waitcnt lgkmcnt(0)
    s_mov_b32 s36, 24444928
    s_load_dword s61, s[10:11], s36
    s_mov_b32 s20, s4
    s_mov_b32 s21, s5
    s_mov_b32 s22, 2097152
    s_mov_b32 s23, 0x20000
    s_mov_b32 s28, s10
    s_mov_b32 s29, s11
    s_mov_b32 s30, 26214400
    s_mov_b32 s31, 0x20000
    s_cmp_ge_u32 s13, 2
    s_cbranch_scc1 m_auxq
    v_lshlrev_b32 v8, 20, v3
    v_add_u32 v8, 1048448, v8
    buffer_load_dword v9, v8, s[28:31], 0 offen sc1
    s_mov_b32 s44, s8
    s_mov_b32 s45, s9
    s_mov_b32 s46, 1409024
    s_mov_b32 s47, 0x20000
    v_lshrrev_b32 v20, 3, v2
    v_mul_u32_u24 v20, 2752, v20
    v_bfe_u32 v21, v2, 4, 1
    v_lshlrev_b32 v21, 2, v21
    v_and_b32 v22, 7, v2
    v_xor_b32 v21, v21, v22
    v_lshl_add_u32 v20, v21, 4, v20
    s_mul_i32 s36, s15, 88064
    s_lshl_b32 s38, s13, 13
    s_add_u32 s38, s38, 139264
    s_lshl_b32 s37, s74, 7
    s_add_u32 s37, s37, s36
    s_add_u32 m0, s38, 0
    s_nop 0
    buffer_load_dwordx4 v20, s[44:47], s37 offen lds
    s_add_u32 s37, s37, 22016
    s_add_u32 m0, s38, 1024
    s_nop 0
    buffer_load_dwordx4 v20, s[44:47], s37 offen lds
    s_add_u32 s37, s37, 22016
    s_add_u32 m0, s38, 4096
    s_nop 0
    buffer_load_dwordx4 v20, s[44:47], s37 offen lds
    s_add_u32 s37, s37, 22016
    s_add_u32 m0, s38, 5120
    s_nop 0
    buffer_load_dwordx4 v20, s[44:47], s37 offen lds
    s_lshl_b32 s37, s73, 7
    s_add_u32 s37, s37, s36
    s_add_u32 m0, s38, 2048
    s_nop 0
    buffer_load_dwordx4 v20, s[44:47], s37 offen lds
    s_add_u32 s37, s37, 22016
    s_add_u32 m0, s38, 3072
    s_nop 0
    buffer_load_dwordx4 v20, s[44:47], s37 offen lds
    s_add_u32 s37, s37, 22016
    s_add_u32 m0, s38, 6144
    s_nop 0
    buffer_load_dwordx4 v20, s[44:47], s37 offen lds
    s_add_u32 s37, s37, 22016
    s_add_u32 m0, s38, 7168
    s_nop 0
    buffer_load_dwordx4 v20, s[44:47], s37 offen lds
    v_bfe_u32 v20, v2, 2, 2
    v_lshl_add_u32 v20, v4, 3, v20
    v_lshlrev_b32 v20, 7, v20
    v_bfe_u32 v21, v2, 3, 1
    v_xor_b32 v21, s13, v21
    v_lshl_add_u32 v20, v21, 6, v20
    v_bfe_u32 v21, v2, 4, 1
    v_lshl_add_u32 v20, v21, 5, v20
    v_and_b32 v21, 3, v2
    v_lshl_add_u32 v20, v21, 3, v20
    v_add_u32 v30, s38, v20
    s_lshr_b32 s36, s15, 3
    s_lshl_b32 s36, s36, 13
    s_add_u32 s36, s36, 65536
    v_add_u32 v20, s36, v20
    s_waitcnt lgkmcnt(0)
    s_mul_i32 s61, s61, 1664525
    s_add_u32 s61, s61, 1013904223
    s_barrier
    ds_read_b64_tr_b16 v[32:33], v20 offset:0
    ds_read_b64_tr_b16 v[34:35], v20 offset:512
    ds_read_b64_tr_b16 v[40:41], v20 offset:2048
    ds_read_b64_tr_b16 v[42:43], v20 offset:2560
    ds_read_b64_tr_b16 v[36:37], v20 offset:4096
    ds_read_b64_tr_b16 v[38:39], v20 offset:4608
    ds_read_b64_tr_b16 v[44:45], v20 offset:6144
    ds_read_b64_tr_b16 v[46:47], v20 offset:6656
    s_waitcnt lgkmcnt(0)
    v_lshlrev_b32 v22, 16, v32
    v_and_b32 v23, 0xffff0000, v32
    v_add_f32 v24, v22, v23
    v_lshlrev_b32 v22, 16, v33
    v_and_b32 v23, 0xffff0000, v33
    v_add_f32 v24, v22, v24
    v_add_f32 v24, v23, v24
    v_lshlrev_b32 v22, 16, v34
    v_and_b32 v23, 0xffff0000, v34
    v_add_f32 v24, v22, v24
    v_add_f32 v24, v23, v24
    v_lshlrev_b32 v22, 16, v35
    v_and_b32 v23, 0xffff0000, v35
    v_add_f32 v24, v22, v24
    v_add_f32 v24, v23, v24
    v_lshlrev_b32 v22, 16, v36
    v_and_b32 v23, 0xffff0000, v36
    v_add_f32 v24, v22, v24
    v_add_f32 v24, v23, v24
    v_lshlrev_b32 v22, 16, v37
    v_and_b32 v23, 0xffff0000, v37
    v_add_f32 v24, v22, v24
    v_add_f32 v24, v23, v24
    v_lshlrev_b32 v22, 16, v38
    v_and_b32 v23, 0xffff0000, v38
    v_add_f32 v24, v22, v24
    v_add_f32 v24, v23, v24
    v_lshlrev_b32 v22, 16, v39
    v_and_b32 v23, 0xffff0000, v39
    v_add_f32 v24, v22, v24
    v_add_f32 v24, v23, v24
    v_lshlrev_b32 v22, 16, v40
    v_and_b32 v23, 0xffff0000, v40
    v_add_f32 v25, v22, v23
    v_lshlrev_b32 v22, 16, v41
    v_and_b32 v23, 0xffff0000, v41
    v_add_f32 v25, v22, v25
    v_add_f32 v25, v23, v25
    v_lshlrev_b32 v22, 16, v42
    v_and_b32 v23, 0xffff0000, v42
    v_add_f32 v25, v22, v25
    v_add_f32 v25, v23, v25
    v_lshlrev_b32 v22, 16, v43
    v_and_b32 v23, 0xffff0000, v43
    v_add_f32 v25, v22, v25
    v_add_f32 v25, v23, v25
    v_lshlrev_b32 v22, 16, v44
    v_and_b32 v23, 0xffff0000, v44
    v_add_f32 v25, v22, v25
    v_add_f32 v25, v23, v25
    v_lshlrev_b32 v22, 16, v45
    v_and_b32 v23, 0xffff0000, v45
    v_add_f32 v25, v22, v25
    v_add_f32 v25, v23, v25
    v_lshlrev_b32 v22, 16, v46
    v_and_b32 v23, 0xffff0000, v46
    v_add_f32 v25, v22, v25
    v_add_f32 v25, v23, v25
    v_lshlrev_b32 v22, 16, v47
    v_and_b32 v23, 0xffff0000, v47
    v_add_f32 v25, v22, v25
    v_add_f32 v25, v23, v25
    v_mov_b32 v32, v24
    v_mov_b32 v33, v25
    s_lshl_b32 s36, s14, 4
    s_add_u32 s36, s36, s15
    s_lshl_b32 s36, s36, 10
    s_lshl_b32 s37, s13, 9
    s_add_u32 s36, s36, s37
    s_add_u32 s36, s36, 24641536
    v_permlane32_swap_b32 v24, v32
    v_permlane32_swap_b32 v25, v33
    v_add_f32 v24, v24, v32
    v_add_f32 v25, v25, v33
    v_lshlrev_b32 v22, 4, v3
    v_mov_b32 v26, 0
    v_mov_b32 v27, s61
    buffer_store_dwordx4 v[24:27], v22, s[28:31], s36 offen sc1
    s_barrier
    s_waitcnt vmcnt(1)
    ds_read_b64_tr_b16 v[32:33], v30 offset:0
    ds_read_b64_tr_b16 v[34:35], v30 offset:512
    ds_read_b64_tr_b16 v[40:41], v30 offset:2048
    ds_read_b64_tr_b16 v[42:43], v30 offset:2560
    ds_read_b64_tr_b16 v[36:37], v30 offset:4096
    ds_read_b64_tr_b16 v[38:39], v30 offset:4608
    ds_read_b64_tr_b16 v[44:45], v30 offset:6144
    ds_read_b64_tr_b16 v[46:47], v30 offset:6656
    s_waitcnt lgkmcnt(0)
    v_lshlrev_b32 v22, 16, v32
    v_and_b32 v23, 0xffff0000, v32
    v_add_f32 v24, v22, v23
    v_lshlrev_b32 v22, 16, v33
    v_and_b32 v23, 0xffff0000, v33
    v_add_f32 v24, v22, v24
    v_add_f32 v24, v23, v24
    v_lshlrev_b32 v22, 16, v34
    v_and_b32 v23, 0xffff0000, v34
    v_add_f32 v24, v22, v24
    v_add_f32 v24, v23, v24
    v_lshlrev_b32 v22, 16, v35
    v_and_b32 v23, 0xffff0000, v35
    v_add_f32 v24, v22, v24
    v_add_f32 v24, v23, v24
    v_lshlrev_b32 v22, 16, v36
    v_and_b32 v23, 0xffff0000, v36
    v_add_f32 v24, v22, v24
    v_add_f32 v24, v23, v24
    v_lshlrev_b32 v22, 16, v37
    v_and_b32 v23, 0xffff0000, v37
    v_add_f32 v24, v22, v24
    v_add_f32 v24, v23, v24
    v_lshlrev_b32 v22, 16, v38
    v_and_b32 v23, 0xffff0000, v38
    v_add_f32 v24, v22, v24
    v_add_f32 v24, v23, v24
    v_lshlrev_b32 v22, 16, v39
    v_and_b32 v23, 0xffff0000, v39
    v_add_f32 v24, v22, v24
    v_add_f32 v24, v23, v24
    v_lshlrev_b32 v22, 16, v40
    v_and_b32 v23, 0xffff0000, v40
    v_add_f32 v25, v22, v23
    v_lshlrev_b32 v22, 16, v41
    v_and_b32 v23, 0xffff0000, v41
    v_add_f32 v25, v22, v25
    v_add_f32 v25, v23, v25
    v_lshlrev_b32 v22, 16, v42
    v_and_b32 v23, 0xffff0000, v42
    v_add_f32 v25, v22, v25
    v_add_f32 v25, v23, v25
    v_lshlrev_b32 v22, 16, v43
    v_and_b32 v23, 0xffff0000, v43
    v_add_f32 v25, v22, v25
    v_add_f32 v25, v23, v25
    v_lshlrev_b32 v22, 16, v44
    v_and_b32 v23, 0xffff0000, v44
    v_add_f32 v25, v22, v25
    v_add_f32 v25, v23, v25
    v_lshlrev_b32 v22, 16, v45
    v_and_b32 v23, 0xffff0000, v45
    v_add_f32 v25, v22, v25
    v_add_f32 v25, v23, v25
    v_lshlrev_b32 v22, 16, v46
    v_and_b32 v23, 0xffff0000, v46
    v_add_f32 v25, v22, v25
    v_add_f32 v25, v23, v25
    v_lshlrev_b32 v22, 16, v47
    v_and_b32 v23, 0xffff0000, v47
    v_add_f32 v25, v22, v25
    v_add_f32 v25, v23, v25
    v_mov_b32 v32, v24
    v_mov_b32 v33, v25
    s_lshl_b32 s36, s14, 4
    s_add_u32 s36, s36, s15
    s_lshl_b32 s36, s36, 10
    s_lshl_b32 s37, s13, 9
    s_add_u32 s36, s36, s37
    s_add_u32 s36, s36, 25690112
    v_permlane32_swap_b32 v24, v32
    v_permlane32_swap_b32 v25, v33
    v_add_f32 v24, v24, v32
    v_add_f32 v25, v25, v33
    v_lshlrev_b32 v22, 4, v3
    v_mov_b32 v26, 0
    v_mov_b32 v27, s61
    buffer_store_dwordx4 v[24:27], v22, s[28:31], s36 offen sc1
    s_barrier
    s_barrier
    s_barrier
    v_lshlrev_b32 v28, 13, v4
    v_lshl_add_u32 v28, v3, 4, v28
    s_lshl_b32 s40, s14, 14
    s_lshl_b32 s37, s13, 9
    s_add_u32 s40, s40, s37
    s_add_u32 s40, s40, 24641536
    s_add_u32 s41, s40, 4096
    buffer_load_dwordx4 v[32:35], v28, s[28:31], s40 offen offset:0 sc1
    buffer_load_dwordx4 v[36:39], v28, s[28:31], s40 offen offset:1024 sc1
    buffer_load_dwordx4 v[40:43], v28, s[28:31], s40 offen offset:2048 sc1
    buffer_load_dwordx4 v[44:47], v28, s[28:31], s40 offen offset:3072 sc1
    buffer_load_dwordx4 v[48:51], v28, s[28:31], s41 offen offset:0 sc1
    buffer_load_dwordx4 v[52:55], v28, s[28:31], s41 offen offset:1024 sc1
    buffer_load_dwordx4 v[56:59], v28, s[28:31], s41 offen offset:2048 sc1
    buffer_load_dwordx4 v[60:63], v28, s[28:31], s41 offen offset:3072 sc1
    s_lshr_b32 s36, s2, 2
    s_cmp_lt_u32 s36, 32
    s_cselect_b32 s44, s68, s70
    s_cselect_b32 s45, s69, s71
    s_cselect_b32 s37, 0, 32
    s_mov_b32 s46, 704512
    s_cselect_b32 s46, 524288, s46
    s_mov_b32 s47, 0x20000
    s_sub_u32 s37, s36, s37
    s_lshl_b32 s76, s37, 14
    s_add_u32 s77, s76, 8192
    s_lshl_b32 s37, s2, 2
    s_add_u32 s37, s37, s13
    s_and_b32 s37, s37, 15
    s_mul_i32 s78, s37, 75
    s_add_u32 s78, s78, s36
    s_lshl_b32 s78, s78, 10
    s_add_u32 s78, s78, 23068672
    v_lshlrev_b32 v22, 12, v4
    v_lshl_add_u32 v22, v3, 1, v22
    s_lshl_b32 s37, s37, 6
    v_add_u32 v22, s37, v22
    buffer_load_ushort v64, v22, s[44:47], s76 offen offset:0
    buffer_load_short_d16_hi v72, v22, s[44:47], s76 offen offset:1024
    buffer_load_ushort v65, v22, s[44:47], s76 offen offset:2048
    buffer_load_short_d16_hi v73, v22, s[44:47], s76 offen offset:3072
    buffer_load_ushort v66, v22, s[44:47], s77 offen offset:0
    buffer_load_short_d16_hi v74, v22, s[44:47], s77 offen offset:1024
    buffer_load_ushort v67, v22, s[44:47], s77 offen offset:2048
    buffer_load_short_d16_hi v75, v22, s[44:47], s77 offen offset:3072
    s_mov_b32 s48, s70
    s_mov_b32 s49, s71
    s_mov_b32 s50, 704512
    s_mov_b32 s51, 0x20000
    s_add_u32 s76, s36, 32
    s_lshl_b32 s76, s76, 14
    s_add_u32 s77, s76, 8192
    buffer_load_ushort v68, v22, s[48:51], s76 offen offset:0
    buffer_load_short_d16_hi v76, v22, s[48:51], s76 offen offset:1024
    buffer_load_ushort v69, v22, s[48:51], s76 offen offset:2048
    buffer_load_short_d16_hi v77, v22, s[48:51], s76 offen offset:3072
    buffer_load_ushort v70, v22, s[48:51], s77 offen offset:0
    buffer_load_short_d16_hi v78, v22, s[48:51], s77 offen offset:1024
    buffer_load_ushort v71, v22, s[48:51], s77 offen offset:2048
    buffer_load_short_d16_hi v79, v22, s[48:51], s77 offen offset:3072
    s_barrier
    s_waitcnt vmcnt(16)
    s_mov_b32 s37, 0x100000
m_chk00:
    v_xor_b32 v22, s61, v35
    v_bitop3_b32 v22, v22, v39, s61 bitop3:0xf6
    v_bitop3_b32 v22, v22, v43, s61 bitop3:0xf6
    v_bitop3_b32 v22, v22, v47, s61 bitop3:0xf6
    v_bitop3_b32 v22, v22, v51, s61 bitop3:0xf6
    v_bitop3_b32 v22, v22, v55, s61 bitop3:0xf6
    v_bitop3_b32 v22, v22, v59, s61 bitop3:0xf6
    v_bitop3_b32 v22, v22, v63, s61 bitop3:0xf6
    v_cmp_ne_u32 vcc, 0, v22
    s_cbranch_vccz m_ok00
    buffer_load_dwordx4 v[32:35], v28, s[28:31], s40 offen offset:0 sc1
    buffer_load_dwordx4 v[36:39], v28, s[28:31], s40 offen offset:1024 sc1
    buffer_load_dwordx4 v[40:43], v28, s[28:31], s40 offen offset:2048 sc1
    buffer_load_dwordx4 v[44:47], v28, s[28:31], s40 offen offset:3072 sc1
    buffer_load_dwordx4 v[48:51], v28, s[28:31], s41 offen offset:0 sc1
    buffer_load_dwordx4 v[52:55], v28, s[28:31], s41 offen offset:1024 sc1
    buffer_load_dwordx4 v[56:59], v28, s[28:31], s41 offen offset:2048 sc1
    buffer_load_dwordx4 v[60:63], v28, s[28:31], s41 offen offset:3072 sc1
    s_sub_u32 s37, s37, 1
    s_waitcnt vmcnt(0)
    s_cmp_lg_u32 s37, 0
    s_cbranch_scc1 m_chk00
m_ok00:
    v_pk_add_f32 v[32:33], v[32:33], v[48:49]
    v_pk_add_f32 v[36:37], v[36:37], v[52:53]
    v_pk_add_f32 v[40:41], v[40:41], v[56:57]
    v_pk_add_f32 v[44:45], v[44:45], v[60:61]
    v_pk_add_f32 v[32:33], v[32:33], v[40:41]
    v_pk_add_f32 v[36:37], v[36:37], v[44:45]
    v_pk_add_f32 v[32:33], v[32:33], v[36:37]
    v_mov_b32 v36, v32
    v_mov_b32 v37, v33
    s_lshl_b32 s36, s13, 9
    s_add_u32 s36, s36, 131072
    v_lshl_add_u32 v22, v3, 4, s36
    v_permlane32_swap_b32 v32, v36
    v_permlane32_swap_b32 v33, v37
    v_add_f32 v32, v32, v36
    v_add_f32 v33, v33, v37
    ds_write_b64 v22, v[32:33] offset:2048
    s_waitcnt lgkmcnt(0)
    s_barrier
    v_lshlrev_b32 v28, 13, v4
    v_lshl_add_u32 v28, v3, 4, v28
    s_lshl_b32 s40, s14, 14
    s_lshl_b32 s37, s13, 9
    s_add_u32 s40, s40, s37
    s_add_u32 s40, s40, 25690112
    s_add_u32 s41, s40, 4096
    buffer_load_dwordx4 v[32:35], v28, s[28:31], s40 offen offset:0 sc1
    buffer_load_dwordx4 v[36:39], v28, s[28:31], s40 offen offset:1024 sc1
    buffer_load_dwordx4 v[40:43], v28, s[28:31], s40 offen offset:2048 sc1
    buffer_load_dwordx4 v[44:47], v28, s[28:31], s40 offen offset:3072 sc1
    buffer_load_dwordx4 v[48:51], v28, s[28:31], s41 offen offset:0 sc1
    buffer_load_dwordx4 v[52:55], v28, s[28:31], s41 offen offset:1024 sc1
    buffer_load_dwordx4 v[56:59], v28, s[28:31], s41 offen offset:2048 sc1
    buffer_load_dwordx4 v[60:63], v28, s[28:31], s41 offen offset:3072 sc1
    s_barrier
    s_barrier
    s_barrier
    s_waitcnt vmcnt(0)
    s_mov_b32 s37, 0x100000
m_chk01:
    v_xor_b32 v22, s61, v35
    v_bitop3_b32 v22, v22, v39, s61 bitop3:0xf6
    v_bitop3_b32 v22, v22, v43, s61 bitop3:0xf6
    v_bitop3_b32 v22, v22, v47, s61 bitop3:0xf6
    v_bitop3_b32 v22, v22, v51, s61 bitop3:0xf6
    v_bitop3_b32 v22, v22, v55, s61 bitop3:0xf6
    v_bitop3_b32 v22, v22, v59, s61 bitop3:0xf6
    v_bitop3_b32 v22, v22, v63, s61 bitop3:0xf6
    v_cmp_ne_u32 vcc, 0, v22
    s_cbranch_vccz m_ok01
    buffer_load_dwordx4 v[32:35], v28, s[28:31], s40 offen offset:0 sc1
    buffer_load_dwordx4 v[36:39], v28, s[28:31], s40 offen offset:1024 sc1
    buffer_load_dwordx4 v[40:43], v28, s[28:31], s40 offen offset:2048 sc1
    buffer_load_dwordx4 v[44:47], v28, s[28:31], s40 offen offset:3072 sc1
    buffer_load_dwordx4 v[48:51], v28, s[28:31], s41 offen offset:0 sc1
    buffer_load_dwordx4 v[52:55], v28, s[28:31], s41 offen offset:1024 sc1
    buffer_load_dwordx4 v[56:59], v28, s[28:31], s41 offen offset:2048 sc1
    buffer_load_dwordx4 v[60:63], v28, s[28:31], s41 offen offset:3072 sc1
    s_sub_u32 s37, s37, 1
    s_waitcnt vmcnt(0)
    s_cmp_lg_u32 s37, 0
    s_cbranch_scc1 m_chk01
m_ok01:
    v_pk_add_f32 v[32:33], v[32:33], v[48:49]
    v_pk_add_f32 v[36:37], v[36:37], v[52:53]
    v_pk_add_f32 v[40:41], v[40:41], v[56:57]
    v_pk_add_f32 v[44:45], v[44:45], v[60:61]
    v_pk_add_f32 v[32:33], v[32:33], v[40:41]
    v_pk_add_f32 v[36:37], v[36:37], v[44:45]
    v_pk_add_f32 v[32:33], v[32:33], v[36:37]
    v_mov_b32 v36, v32
    v_mov_b32 v37, v33
    s_lshl_b32 s36, s13, 9
    s_add_u32 s36, s36, 131072
    v_lshl_add_u32 v22, v3, 4, s36
    v_permlane32_swap_b32 v32, v36
    v_permlane32_swap_b32 v33, v37
    v_add_f32 v32, v32, v36
    v_add_f32 v33, v33, v37
    ds_write_b64 v22, v[32:33] offset:3072
    s_waitcnt lgkmcnt(0)
    v_and_b32 v72, 0xffff0000, v72
    v_or_b32 v64, v64, v72
    v_and_b32 v73, 0xffff0000, v73
    v_or_b32 v65, v65, v73
    v_and_b32 v74, 0xffff0000, v74
    v_or_b32 v66, v66, v74
    v_and_b32 v75, 0xffff0000, v75
    v_or_b32 v67, v67, v75
    v_and_b32 v76, 0xffff0000, v76
    v_or_b32 v68, v68, v76
    v_and_b32 v77, 0xffff0000, v77
    v_or_b32 v69, v69, v77
    v_and_b32 v78, 0xffff0000, v78
    v_or_b32 v70, v70, v78
    v_and_b32 v79, 0xffff0000, v79
    v_or_b32 v71, v71, v79
    v_lshlrev_b32 v22, 4, v2
    buffer_store_dwordx4 v[64:67], v22, s[28:31], s78 offen sc1
    s_add_u32 s78, s78, 65536
    s_cmp_ge_u32 s2, 44
    s_cselect_b32 s37, 0x80000000, 0
    v_or_b32 v22, s37, v22
    buffer_store_dwordx4 v[68:71], v22, s[28:31], s78 offen sc1
    s_barrier
    s_branch m_attn
m_auxq:
    s_lshl_b32 s36, s15, 7
    s_lshl_b32 s37, s14, 3
    s_add_u32 s36, s36, s37
    s_lshl_b32 s37, s13, 2
    s_add_u32 s36, s36, s37
    s_sub_u32 s36, s36, 8
    v_add_u32 v20, s36, v7
    v_and_b32 v21, 15, v2
    v_lshlrev_b32 v22, 10, v20
    v_lshl_add_u32 v22, v21, 4, v22
    buffer_load_dwordx4 v[32:35], v22, s[20:23], 0 offen offset:0
    buffer_load_dwordx4 v[36:39], v22, s[20:23], 0 offen offset:256
    buffer_load_dwordx4 v[40:43], v22, s[20:23], 0 offen offset:512
    buffer_load_dwordx4 v[44:47], v22, s[20:23], 0 offen offset:768
    s_waitcnt lgkmcnt(0)
    s_mul_i32 s61, s61, 1664525
    s_add_u32 s61, s61, 1013904223
    s_waitcnt vmcnt(0)
    v_lshlrev_b32 v28, 16, v32
    v_and_b32 v29, 0xffff0000, v32
    v_mov_b32 v24, v28
    v_mov_b32 v25, v29
    v_mul_f32 v26, v28, v28
    v_mul_f32 v27, v29, v29
    v_lshlrev_b32 v28, 16, v33
    v_and_b32 v29, 0xffff0000, v33
    v_add_f32 v24, v28, v24
    v_add_f32 v25, v29, v25
    v_fmac_f32 v26, v28, v28
    v_fmac_f32 v27, v29, v29
    v_lshlrev_b32 v28, 16, v34
    v_and_b32 v29, 0xffff0000, v34
    v_add_f32 v24, v28, v24
    v_add_f32 v25, v29, v25
    v_fmac_f32 v26, v28, v28
    v_fmac_f32 v27, v29, v29
    v_lshlrev_b32 v28, 16, v35
    v_and_b32 v29, 0xffff0000, v35
    v_add_f32 v24, v28, v24
    v_add_f32 v25, v29, v25
    v_fmac_f32 v26, v28, v28
    v_fmac_f32 v27, v29, v29
    v_lshlrev_b32 v28, 16, v36
    v_and_b32 v29, 0xffff0000, v36
    v_add_f32 v24, v28, v24
    v_add_f32 v25, v29, v25
    v_fmac_f32 v26, v28, v28
    v_fmac_f32 v27, v29, v29
    v_lshlrev_b32 v28, 16, v37
    v_and_b32 v29, 0xffff0000, v37
    v_add_f32 v24, v28, v24
    v_add_f32 v25, v29, v25
    v_fmac_f32 v26, v28, v28
    v_fmac_f32 v27, v29, v29
    v_lshlrev_b32 v28, 16, v38
    v_and_b32 v29, 0xffff0000, v38
    v_add_f32 v24, v28, v24
    v_add_f32 v25, v29, v25
    v_fmac_f32 v26, v28, v28
    v_fmac_f32 v27, v29, v29
    v_lshlrev_b32 v28, 16, v39
    v_and_b32 v29, 0xffff0000, v39
    v_add_f32 v24, v28, v24
    v_add_f32 v25, v29, v25
    v_fmac_f32 v26, v28, v28
    v_fmac_f32 v27, v29, v29
    v_lshlrev_b32 v28, 16, v40
    v_and_b32 v29, 0xffff0000, v40
    v_add_f32 v24, v28, v24
    v_add_f32 v25, v29, v25
    v_fmac_f32 v26, v28, v28
    v_fmac_f32 v27, v29, v29
    v_lshlrev_b32 v28, 16, v41
    v_and_b32 v29, 0xffff0000, v41
    v_add_f32 v24, v28, v24
    v_add_f32 v25, v29, v25
    v_fmac_f32 v26, v28, v28
    v_fmac_f32 v27, v29, v29
    v_lshlrev_b32 v28, 16, v42
    v_and_b32 v29, 0xffff0000, v42
    v_add_f32 v24, v28, v24
    v_add_f32 v25, v29, v25
    v_fmac_f32 v26, v28, v28
    v_fmac_f32 v27, v29, v29
    v_lshlrev_b32 v28, 16, v43
    v_and_b32 v29, 0xffff0000, v43
    v_add_f32 v24, v28, v24
    v_add_f32 v25, v29, v25
    v_fmac_f32 v26, v28, v28
    v_fmac_f32 v27, v29, v29
    v_lshlrev_b32 v28, 16, v44
    v_and_b32 v29, 0xffff0000, v44
    v_add_f32 v24, v28, v24
    v_add_f32 v25, v29, v25
    v_fmac_f32 v26, v28, v28
    v_fmac_f32 v27, v29, v29
    v_lshlrev_b32 v28, 16, v45
    v_and_b32 v29, 0xffff0000, v45
    v_add_f32 v24, v28, v24
    v_add_f32 v25, v29, v25
    v_fmac_f32 v26, v28, v28
    v_fmac_f32 v27, v29, v29
    v_lshlrev_b32 v28, 16, v46
    v_and_b32 v29, 0xffff0000, v46
    v_add_f32 v24, v28, v24
    v_add_f32 v25, v29, v25
    v_fmac_f32 v26, v28, v28
    v_fmac_f32 v27, v29, v29
    v_lshlrev_b32 v28, 16, v47
    v_and_b32 v29, 0xffff0000, v47
    v_add_f32 v24, v28, v24
    v_add_f32 v25, v29, v25
    v_fmac_f32 v26, v28, v28
    v_fmac_f32 v27, v29, v29
    v_add_f32 v24, v24, v25
    v_add_f32 v26, v26, v27
    s_nop 1
    v_add_f32_dpp v24, v24, v24 row_ror:8 row_mask:0xf bank_mask:0xf
    v_add_f32_dpp v26, v26, v26 row_ror:8 row_mask:0xf bank_mask:0xf
    s_nop 1
    v_add_f32_dpp v24, v24, v24 row_ror:4 row_mask:0xf bank_mask:0xf
    v_add_f32_dpp v26, v26, v26 row_ror:4 row_mask:0xf bank_mask:0xf
    s_nop 1
    v_add_f32_dpp v24, v24, v24 row_ror:2 row_mask:0xf bank_mask:0xf
    v_add_f32_dpp v26, v26, v26 row_ror:2 row_mask:0xf bank_mask:0xf
    s_nop 1
    v_add_f32_dpp v24, v24, v24 row_ror:1 row_mask:0xf bank_mask:0xf
    v_add_f32_dpp v26, v26, v26 row_ror:1 row_mask:0xf bank_mask:0xf
    s_mov_b32 s40, 0x3b000000
    v_mul_f32 v24, s40, v24
    v_mul_f32 v28, v24, v24
    v_fma_f32 v28, v26, s40, -v28
    v_max_f32 v28, 0, v28
    v_add_f32 v28, 0x3727c5ac, v28
    v_rsq_f32 v34, v28
    v_mov_b32 v35, s61
    v_mul_f32 v24, -0.5, v24
    v_cvt_pk_bf16_f32 v32, v24, v24
    v_and_b32 v28, 0xffff0000, v32
    v_sub_f32 v28, v24, v28
    v_cvt_pk_bf16_f32 v33, v28, v28
    v_lshlrev_b32 v20, 4, v20
    s_mov_b32 s36, 24379392
    buffer_store_dwordx4 v[32:35], v20, s[28:31], s36 offen sc1
    s_barrier
    s_barrier
    s_barrier
    s_barrier
    s_barrier
    s_lshl_b32 s37, s13, 6
    s_sub_u32 s37, s37, 128
    v_add_u32 v20, s37, v2
    v_lshlrev_b32 v21, 4, v20
    s_lshl_b32 s40, s15, 11
    s_add_u32 s40, s40, 24379392
    buffer_load_dwordx4 v[32:35], v21, s[28:31], s40 offen sc1
    s_lshr_b32 s36, s2, 2
    s_cmp_lt_u32 s36, 32
    s_cselect_b32 s44, s68, s70
    s_cselect_b32 s45, s69, s71
    s_cselect_b32 s37, 0, 32
    s_mov_b32 s46, 704512
    s_cselect_b32 s46, 524288, s46
    s_mov_b32 s47, 0x20000
    s_sub_u32 s37, s36, s37
    s_lshl_b32 s76, s37, 14
    s_add_u32 s77, s76, 8192
    s_lshl_b32 s37, s2, 2
    s_add_u32 s37, s37, s13
    s_and_b32 s37, s37, 15
    s_mul_i32 s78, s37, 75
    s_add_u32 s78, s78, s36
    s_lshl_b32 s78, s78, 10
    s_add_u32 s78, s78, 23068672
    v_lshlrev_b32 v22, 12, v4
    v_lshl_add_u32 v22, v3, 1, v22
    s_lshl_b32 s37, s37, 6
    v_add_u32 v22, s37, v22
    buffer_load_ushort v64, v22, s[44:47], s76 offen offset:0
    buffer_load_short_d16_hi v72, v22, s[44:47], s76 offen offset:1024
    buffer_load_ushort v65, v22, s[44:47], s76 offen offset:2048
    buffer_load_short_d16_hi v73, v22, s[44:47], s76 offen offset:3072
    buffer_load_ushort v66, v22, s[44:47], s77 offen offset:0
    buffer_load_short_d16_hi v74, v22, s[44:47], s77 offen offset:1024
    buffer_load_ushort v67, v22, s[44:47], s77 offen offset:2048
    buffer_load_short_d16_hi v75, v22, s[44:47], s77 offen offset:3072
    s_mov_b32 s48, s70
    s_mov_b32 s49, s71
    s_mov_b32 s50, 704512
    s_mov_b32 s51, 0x20000
    s_add_u32 s76, s36, 32
    s_lshl_b32 s76, s76, 14
    s_add_u32 s77, s76, 8192
    buffer_load_ushort v68, v22, s[48:51], s76 offen offset:0
    buffer_load_short_d16_hi v76, v22, s[48:51], s76 offen offset:1024
    buffer_load_ushort v69, v22, s[48:51], s76 offen offset:2048
    buffer_load_short_d16_hi v77, v22, s[48:51], s76 offen offset:3072
    buffer_load_ushort v70, v22, s[48:51], s77 offen offset:0
    buffer_load_short_d16_hi v78, v22, s[48:51], s77 offen offset:1024
    buffer_load_ushort v71, v22, s[48:51], s77 offen offset:2048
    buffer_load_short_d16_hi v79, v22, s[48:51], s77 offen offset:3072
    s_barrier
    s_waitcnt vmcnt(16)
    s_mov_b32 s37, 0x100000
m_chk10:
    v_xor_b32 v22, s61, v35
    v_cmp_ne_u32 vcc, 0, v22
    s_cbranch_vccz m_ok10
    buffer_load_dwordx4 v[32:35], v21, s[28:31], s40 offen sc1
    s_sub_u32 s37, s37, 1
    s_waitcnt vmcnt(0)
    s_cmp_lg_u32 s37, 0
    s_cbranch_scc1 m_chk10
m_ok10:
    v_rcp_f32 v35, v34
    v_lshlrev_b32 v20, 2, v20
    v_add_u32 v20, 131072, v20
    v_add_u32 v21, 131072, v21
    ds_write_b128 v21, v[32:35] offset:0
    ds_write_b32 v20, v34 offset:4096
    s_waitcnt lgkmcnt(0)
    s_barrier
    s_barrier
    s_barrier
    s_barrier
    s_waitcnt vmcnt(0)
    v_and_b32 v72, 0xffff0000, v72
    v_or_b32 v64, v64, v72
    v_and_b32 v73, 0xffff0000, v73
    v_or_b32 v65, v65, v73
    v_and_b32 v74, 0xffff0000, v74
    v_or_b32 v66, v66, v74
    v_and_b32 v75, 0xffff0000, v75
    v_or_b32 v67, v67, v75
    v_and_b32 v76, 0xffff0000, v76
    v_or_b32 v68, v68, v76
    v_and_b32 v77, 0xffff0000, v77
    v_or_b32 v69, v69, v77
    v_and_b32 v78, 0xffff0000, v78
    v_or_b32 v70, v70, v78
    v_and_b32 v79, 0xffff0000, v79
    v_or_b32 v71, v71, v79
    v_lshlrev_b32 v22, 4, v2
    buffer_store_dwordx4 v[64:67], v22, s[28:31], s78 offen sc1
    s_add_u32 s78, s78, 65536
    s_cmp_ge_u32 s2, 44
    s_cselect_b32 s37, 0x80000000, 0
    v_or_b32 v22, s37, v22
    buffer_store_dwordx4 v[68:71], v22, s[28:31], s78 offen sc1
    s_barrier
m_attn:
    s_setprio 3
    s_sub_u32 s3, s12, 4
    s_and_b32 s13, s3, 3
    s_lshr_b32 s14, s3, 2
    s_and_b32 s15, s2, 7
    s_lshl_b32 s15, s15, 2
    s_bfe_u32 s36, s2, 0x20003
    s_add_u32 s15, s15, s36
    s_lshr_b32 s16, s2, 5
    v_lshlrev_b32 v152, 4, v2
    s_lshl_b32 s19, s14, 14
    s_add_u32 s19, s19, 65536
    s_lshl_b32 s18, s13, 12
    s_add_u32 s18, s18, s19
    s_lshl_b32 s36, s15, 16
    s_lshr_b32 s32, s13, 1
    s_lshl_b32 s32, s32, 21
    s_add_u32 s32, s32, 2097152
    s_add_u32 s32, s32, s36
    s_lshl_b32 s37, s14, 15
    s_add_u32 s32, s32, s37
    s_and_b32 s37, s13, 1
    s_lshl_b32 s37, s37, 12
    s_add_u32 s32, s32, s37
    s_lshl_b32 s37, s16, 13
    s_add_u32 s43, s36, s37
    s_lshl_b32 s37, s13, 11
    s_add_u32 s43, s43, s37
    s_mov_b32 s28, s10
    s_mov_b32 s29, s11
    s_mov_b32 s30, 26214400
    s_mov_b32 s31, 0x20000
    v_and_b32 v163, 27, v2
    v_cmp_eq_u32 vcc, 16, v163
    v_mov_b32 v160, 0x3f803f80
    v_add_u32 v157, s19, v152
    v_mov_b32 v153, v157
    v_cndmask_b32 v136, 0, v160, vcc
    v_and_b32 v165, 15, v2
    v_lshrrev_b32 v166, 5, v2
    v_lshlrev_b32 v166, 8, v166
    v_lshl_add_u32 v155, v165, 4, v166
    v_bfe_u32 v165, v2, 4, 1
    v_add_u32 v156, -1, v165
    s_add_u32 s36, s19, 8192
    v_add_u32 v155, s36, v155
    v_mov_b32 v154, v155
    s_mov_b32 s46, 0xffff
    s_mov_b32 s47, 0xffff
    v_mov_b32 v137, v136
    v_mov_b32 v138, v136
    v_mov_b32 v139, v136
    v_mov_b32 v140, v136
    v_mov_b32 v141, v136
    v_mov_b32 v142, v136
    v_mov_b32 v143, v136
    v_mov_b32 v144, v136
    v_mov_b32 v145, v136
    v_mov_b32 v146, v136
    v_mov_b32 v147, v136
    v_mov_b32 v148, v136
    v_mov_b32 v149, v136
    v_mov_b32 v150, v136
    v_mov_b32 v151, v136
    v_mov_b32 v96, 0
    v_mov_b32 v97, 0
    v_mov_b32 v98, 0
    v_mov_b32 v99, 0
    v_mov_b32 v100, 0
    v_mov_b32 v101, 0
    v_mov_b32 v102, 0
    v_mov_b32 v103, 0
    v_mov_b32 v104, 0
    v_mov_b32 v105, 0
    v_mov_b32 v106, 0
    v_mov_b32 v107, 0
    v_mov_b32 v108, 0
    v_mov_b32 v109, 0
    v_mov_b32 v110, 0
    v_mov_b32 v111, 0
    v_mov_b32 v112, 0
    v_mov_b32 v113, 0
    v_mov_b32 v114, 0
    v_mov_b32 v115, 0
    v_mov_b32 v116, 0
    v_mov_b32 v117, 0
    v_mov_b32 v118, 0
    v_mov_b32 v119, 0
    v_mov_b32 v120, 0
    v_mov_b32 v121, 0
    v_mov_b32 v122, 0
    v_mov_b32 v123, 0
    v_mov_b32 v124, 0
    v_mov_b32 v125, 0
    v_mov_b32 v126, 0
    v_mov_b32 v127, 0
    v_mov_b32 v92, 0
    v_mov_b32 v93, 0
    v_mov_b32 v94, 0
    v_mov_b32 v95, 0
    s_lshl_b32 s36, s16, 3
    s_lshl_b32 s37, s13, 1
    s_add_u32 s36, s36, s37
    s_mul_i32 s36, s36, 75
    s_add_u32 s36, s36, s15
    s_lshl_b32 s36, s36, 10
    s_add_u32 s38, s36, 16777216
    s_add_u32 s39, s38, 76800
    s_mov_b32 s35, 0
    s_mov_b32 s40, 32768
    s_mov_b32 s41, 8
    s_lshr_b32 s42, s15, 1
    s_lshl_b32 s42, s42, 11
    s_add_u32 s42, s42, 25165824
    v_lshlrev_b32 v13, 5, v2
    buffer_load_dword v14, v13, s[28:31], s42 offen sc1
    s_waitcnt vmcnt(1)
    s_barrier
    s_waitcnt vmcnt(0)
    s_mov_b32 s45, 0
    v_cmp_ne_u32 vcc, s61, v14
    s_cbranch_vccnz m_notyet
    s_mov_b32 m0, s18
    s_mov_b32 s45, 1
    buffer_load_dwordx4 v152, s[28:31], s32 offen offset:0 sc1 lds
    buffer_load_dwordx4 v152, s[28:31], s32 offen offset:1024 sc1 lds
    buffer_load_dwordx4 v152, s[28:31], s32 offen offset:2048 sc1 lds
    buffer_load_dwordx4 v152, s[28:31], s32 offen offset:3072 sc1 lds
    s_add_u32 s32, s32, 8192
    buffer_load_dwordx4 v[4:7], v152, s[28:31], s43 offen sc1
    buffer_load_dwordx4 v[8:11], v152, s[28:31], s43 offen offset:1024 sc1
m_notyet:
    s_barrier
    s_cmp_lg_u32 s12, 8
    s_cbranch_scc1 m_nozero
    v_lshlrev_b32 v14, 2, v2
    ds_write_b32 v14, v96 offset:61440
    s_waitcnt lgkmcnt(0)
m_nozero:
    s_barrier
    s_lshl_b32 s36, s14, 2
    v_add_u32 v15, s36, v152
    s_cmp_lg_u32 s45, 0
    s_cbranch_scc1 m_started
    s_mov_b32 s33, 0x100000
m_pollk:
    buffer_load_dword v14, v13, s[28:31], s42 offen sc1
    s_waitcnt vmcnt(0)
    v_xor_b32 v14, s61, v14
    v_cmp_ne_u32 vcc, 0, v14
    s_cbranch_vccz m_pollk_ok
    s_sleep 4
    s_sub_u32 s33, s33, 1
    s_cmp_lg_u32 s33, 0
    s_cbranch_scc1 m_pollk
m_pollk_ok:
    s_mov_b32 m0, s18
    s_mov_b32 s45, 1
    buffer_load_dwordx4 v152, s[28:31], s32 offen offset:0 sc1 lds
    buffer_load_dwordx4 v152, s[28:31], s32 offen offset:1024 sc1 lds
    buffer_load_dwordx4 v152, s[28:31], s32 offen offset:2048 sc1 lds
    buffer_load_dwordx4 v152, s[28:31], s32 offen offset:3072 sc1 lds
    s_add_u32 s32, s32, 8192
    buffer_load_dwordx4 v[4:7], v152, s[28:31], s43 offen sc1
    buffer_load_dwordx4 v[8:11], v152, s[28:31], s43 offen offset:1024 sc1
    s_mov_b32 s45, 2
m_started:
    s_setprio 0
    s_waitcnt vmcnt(0)
    v_mov_b32 v12, 1
    s_mov_b64 exec, 1
    ds_add_u32 v15, v12 offset:61440
    s_mov_b64 exec, -1
    ds_read_b32 v12, v15 offset:61440
m_sy0:
    s_waitcnt lgkmcnt(0)
    v_readfirstlane_b32 s34, v12
    s_cmp_ge_u32 s34, 4
    s_cbranch_scc1 m_sy0_ok
    ds_read_b32 v12, v15 offset:61440
    s_branch m_sy0
m_sy0_ok:
    ds_read_b128 v[128:131], v153
    s_mov_b64 exec, s[46:47]
    ds_read_b128 v[136:139], v154
    ds_read_b128 v[140:143], v154 offset:512
    s_mov_b64 exec, -1
    s_waitcnt lgkmcnt(2)
    v_mfma_f32_32x32x16_bf16 v[48:63], v[128:131], v[4:7], 0
    v_mfma_f32_32x32x16_bf16 v[64:79], v[128:131], v[8:11], 0
    s_nop 10
    v_max3_f32 v158, v48, v49, v50
    v_max3_f32 v159, v51, v52, v53
    v_max3_f32 v158, v158, v54, v55
    v_max3_f32 v159, v159, v56, v57
    v_max3_f32 v158, v158, v58, v59
    v_max3_f32 v159, v159, v60, v61
    v_max3_f32 v158, v158, v62, v63
    v_max_f32 v158, v158, v159
    v_mov_b32 v159, v158
    s_nop 1
    v_permlane32_swap_b32 v158, v159
    v_max_f32 v158, v158, v159
    v_sub_f32 v16, 0xc2c00000, v158
    v_mov_b32 v17, v16
    v_mov_b32 v18, v16
    v_mov_b32 v19, v16
    v_mov_b32 v20, v16
    v_mov_b32 v21, v16
    v_mov_b32 v22, v16
    v_mov_b32 v23, v16
    v_mov_b32 v24, v16
    v_mov_b32 v25, v16
    v_mov_b32 v26, v16
    v_mov_b32 v27, v16
    v_mov_b32 v28, v16
    v_mov_b32 v29, v16
    v_mov_b32 v30, v16
    v_mov_b32 v31, v16
    s_waitcnt lgkmcnt(0)
    s_nop 0
    v_mfma_f32_32x32x16_bf16 v[48:63], v[128:131], v[4:7], v[16:31]
    v_max3_f32 v160, v64, v65, v66
    v_max3_f32 v161, v67, v68, v69
    v_max3_f32 v160, v160, v70, v71
    v_max3_f32 v161, v161, v72, v73
    v_max3_f32 v160, v160, v74, v75
    v_max3_f32 v161, v161, v76, v77
    v_max3_f32 v160, v160, v78, v79
    v_max_f32 v160, v160, v161
    v_mov_b32 v161, v160
    s_nop 1
    v_permlane32_swap_b32 v160, v161
    v_max_f32 v160, v160, v161
    v_sub_f32 v32, 0xc2c00000, v160
    v_mov_b32 v33, v32
    v_mov_b32 v34, v32
    v_mov_b32 v35, v32
    v_mov_b32 v36, v32
    v_mov_b32 v37, v32
    v_mov_b32 v38, v32
    v_mov_b32 v39, v32
    v_mov_b32 v40, v32
    v_mov_b32 v41, v32
    v_mov_b32 v42, v32
    v_mov_b32 v43, v32
    v_mov_b32 v44, v32
    v_mov_b32 v45, v32
    v_mov_b32 v46, v32
    v_mov_b32 v47, v32
    s_setprio 2
.p2align 6
m_attn_loop:
    v_exp_f32 v48, v48
    v_exp_f32 v49, v49
    v_exp_f32 v50, v50
    v_exp_f32 v51, v51
    v_mfma_f32_32x32x16_bf16 v[112:127], v[148:151], v[92:95], v[112:127]
    ds_read_b128 v[132:135], v153 offset:1024
    v_exp_f32 v52, v52
    v_exp_f32 v53, v53
    v_exp_f32 v54, v54
    v_exp_f32 v55, v55
    v_exp_f32 v56, v56
    v_cvt_pk_bf16_f32 v80, v48, v49
    v_cvt_pk_bf16_f32 v81, v50, v51
    v_cvt_pk_bf16_f32 v82, v52, v53
    v_cvt_pk_bf16_f32 v83, v54, v55
    v_mfma_f32_32x32x16_bf16 v[64:79], v[128:131], v[8:11], v[32:47]
    s_mov_b64 exec, s[46:47]
    ds_read_b128 v[144:147], v154 offset:1024
    ds_read_b128 v[148:151], v154 offset:1536
    s_mov_b64 exec, -1
    v_exp_f32 v57, v57
    v_exp_f32 v58, v58
    v_exp_f32 v59, v59
    v_exp_f32 v60, v60
    v_mfma_f32_32x32x16_bf16 v[96:111], v[136:139], v[80:83], v[96:111]
    v_exp_f32 v61, v61
    v_exp_f32 v62, v62
    v_exp_f32 v63, v63
    v_cvt_pk_bf16_f32 v84, v56, v57
    v_cvt_pk_bf16_f32 v85, v58, v59
    v_cvt_pk_bf16_f32 v86, v60, v61
    v_cvt_pk_bf16_f32 v87, v62, v63
    v_exp_f32 v64, v64
    v_exp_f32 v65, v65
    v_exp_f32 v66, v66
    v_exp_f32 v67, v67
    v_mfma_f32_32x32x16_bf16 v[96:111], v[140:143], v[84:87], v[96:111]
    v_exp_f32 v68, v68
    v_exp_f32 v69, v69
    v_exp_f32 v70, v70
    v_exp_f32 v71, v71
    v_exp_f32 v72, v72
    v_cvt_pk_bf16_f32 v88, v64, v65
    v_cvt_pk_bf16_f32 v89, v66, v67
    v_cvt_pk_bf16_f32 v90, v68, v69
    v_cvt_pk_bf16_f32 v91, v70, v71
    s_waitcnt lgkmcnt(0)
    v_mfma_f32_32x32x16_bf16 v[48:63], v[132:135], v[4:7], v[16:31]
    v_exp_f32 v73, v73
    v_exp_f32 v74, v74
    v_exp_f32 v75, v75
    v_exp_f32 v76, v76
    v_mfma_f32_32x32x16_bf16 v[112:127], v[136:139], v[88:91], v[112:127]
    v_exp_f32 v77, v77
    v_exp_f32 v78, v78
    v_exp_f32 v79, v79
    v_cvt_pk_bf16_f32 v92, v72, v73
    v_cvt_pk_bf16_f32 v93, v74, v75
    v_cvt_pk_bf16_f32 v94, v76, v77
    v_cvt_pk_bf16_f32 v95, v78, v79
    v_exp_f32 v48, v48
    v_exp_f32 v49, v49
    v_exp_f32 v50, v50
    v_exp_f32 v51, v51
    v_mfma_f32_32x32x16_bf16 v[112:127], v[140:143], v[92:95], v[112:127]
    ds_read_b128 v[128:131], v153 offset:2048
    v_exp_f32 v52, v52
    v_exp_f32 v53, v53
    v_exp_f32 v54, v54
    v_exp_f32 v55, v55
    v_exp_f32 v56, v56
    v_cvt_pk_bf16_f32 v80, v48, v49
    v_cvt_pk_bf16_f32 v81, v50, v51
    v_cvt_pk_bf16_f32 v82, v52, v53
    v_cvt_pk_bf16_f32 v83, v54, v55
    v_mfma_f32_32x32x16_bf16 v[64:79], v[132:135], v[8:11], v[32:47]
    s_mov_b64 exec, s[46:47]
    ds_read_b128 v[136:139], v154 offset:2048
    ds_read_b128 v[140:143], v154 offset:2560
    s_mov_b64 exec, -1
    v_exp_f32 v57, v57
    v_exp_f32 v58, v58
    v_exp_f32 v59, v59
    v_exp_f32 v60, v60
    v_mfma_f32_32x32x16_bf16 v[96:111], v[144:147], v[80:83], v[96:111]
    v_exp_f32 v61, v61
    v_exp_f32 v62, v62
    v_exp_f32 v63, v63
    v_cvt_pk_bf16_f32 v84, v56, v57
    v_cvt_pk_bf16_f32 v85, v58, v59
    v_cvt_pk_bf16_f32 v86, v60, v61
    v_cvt_pk_bf16_f32 v87, v62, v63
    v_exp_f32 v64, v64
    v_exp_f32 v65, v65
    v_exp_f32 v66, v66
    v_exp_f32 v67, v67
    v_mfma_f32_32x32x16_bf16 v[96:111], v[148:151], v[84:87], v[96:111]
    s_cmp_lg_u32 s35, 0
    s_cbranch_scc1 m_f2
    s_add_u32 m0, s18, 32768
    s_nop 0
    buffer_load_dwordx4 v152, s[28:31], s32 offen offset:0 sc1 lds
    buffer_load_dwordx4 v152, s[28:31], s32 offen offset:1024 sc1 lds
    buffer_load_dwordx4 v152, s[28:31], s32 offen offset:2048 sc1 lds
    buffer_load_dwordx4 v152, s[28:31], s32 offen offset:3072 sc1 lds
    s_add_u32 s32, s32, 8192
m_f2:
    v_exp_f32 v68, v68
    v_exp_f32 v69, v69
    v_exp_f32 v70, v70
    v_exp_f32 v71, v71
    v_exp_f32 v72, v72
    v_cvt_pk_bf16_f32 v88, v64, v65
    v_cvt_pk_bf16_f32 v89, v66, v67
    v_cvt_pk_bf16_f32 v90, v68, v69
    v_cvt_pk_bf16_f32 v91, v70, v71
    s_waitcnt lgkmcnt(0)
    v_mfma_f32_32x32x16_bf16 v[48:63], v[128:131], v[4:7], v[16:31]
    v_exp_f32 v73, v73
    v_exp_f32 v74, v74
    v_exp_f32 v75, v75
    v_exp_f32 v76, v76
    v_mfma_f32_32x32x16_bf16 v[112:127], v[144:147], v[88:91], v[112:127]
    v_exp_f32 v77, v77
    v_exp_f32 v78, v78
    v_exp_f32 v79, v79
    v_cvt_pk_bf16_f32 v92, v72, v73
    v_cvt_pk_bf16_f32 v93, v74, v75
    v_cvt_pk_bf16_f32 v94, v76, v77
    v_cvt_pk_bf16_f32 v95, v78, v79
    v_exp_f32 v48, v48
    v_exp_f32 v49, v49
    v_exp_f32 v50, v50
    v_exp_f32 v51, v51
    v_mfma_f32_32x32x16_bf16 v[112:127], v[148:151], v[92:95], v[112:127]
    ds_read_b128 v[132:135], v153 offset:3072
    v_exp_f32 v52, v52
    v_exp_f32 v53, v53
    v_exp_f32 v54, v54
    v_exp_f32 v55, v55
    v_exp_f32 v56, v56
    v_cvt_pk_bf16_f32 v80, v48, v49
    v_cvt_pk_bf16_f32 v81, v50, v51
    v_cvt_pk_bf16_f32 v82, v52, v53
    v_cvt_pk_bf16_f32 v83, v54, v55
    v_mfma_f32_32x32x16_bf16 v[64:79], v[128:131], v[8:11], v[32:47]
    s_mov_b64 exec, s[46:47]
    ds_read_b128 v[144:147], v154 offset:3072
    ds_read_b128 v[148:151], v154 offset:3584
    s_mov_b64 exec, -1
    v_exp_f32 v57, v57
    v_exp_f32 v58, v58
    v_exp_f32 v59, v59
    v_exp_f32 v60, v60
    v_mfma_f32_32x32x16_bf16 v[96:111], v[136:139], v[80:83], v[96:111]
    v_exp_f32 v61, v61
    v_exp_f32 v62, v62
    v_exp_f32 v63, v63
    v_cvt_pk_bf16_f32 v84, v56, v57
    v_cvt_pk_bf16_f32 v85, v58, v59
    v_cvt_pk_bf16_f32 v86, v60, v61
    v_cvt_pk_bf16_f32 v87, v62, v63
    v_exp_f32 v64, v64
    v_exp_f32 v65, v65
    v_exp_f32 v66, v66
    v_exp_f32 v67, v67
    v_mfma_f32_32x32x16_bf16 v[96:111], v[140:143], v[84:87], v[96:111]
    v_exp_f32 v68, v68
    v_exp_f32 v69, v69
    v_exp_f32 v70, v70
    v_exp_f32 v71, v71
    v_exp_f32 v72, v72
    v_cvt_pk_bf16_f32 v88, v64, v65
    v_cvt_pk_bf16_f32 v89, v66, v67
    v_cvt_pk_bf16_f32 v90, v68, v69
    v_cvt_pk_bf16_f32 v91, v70, v71
    s_waitcnt lgkmcnt(0)
    v_mfma_f32_32x32x16_bf16 v[48:63], v[132:135], v[4:7], v[16:31]
    v_exp_f32 v73, v73
    v_exp_f32 v74, v74
    v_exp_f32 v75, v75
    v_exp_f32 v76, v76
    v_mfma_f32_32x32x16_bf16 v[112:127], v[136:139], v[88:91], v[112:127]
    v_exp_f32 v77, v77
    v_exp_f32 v78, v78
    v_exp_f32 v79, v79
    v_cvt_pk_bf16_f32 v92, v72, v73
    v_cvt_pk_bf16_f32 v93, v74, v75
    v_cvt_pk_bf16_f32 v94, v76, v77
    v_cvt_pk_bf16_f32 v95, v78, v79
    v_exp_f32 v48, v48
    v_exp_f32 v49, v49
    v_exp_f32 v50, v50
    v_exp_f32 v51, v51
    v_mfma_f32_32x32x16_bf16 v[112:127], v[140:143], v[92:95], v[112:127]
    ds_read_b128 v[128:131], v153 offset:4096
    v_exp_f32 v52, v52
    v_exp_f32 v53, v53
    v_exp_f32 v54, v54
    v_exp_f32 v55, v55
    v_exp_f32 v56, v56
    v_cvt_pk_bf16_f32 v80, v48, v49
    v_cvt_pk_bf16_f32 v81, v50, v51
    v_cvt_pk_bf16_f32 v82, v52, v53
    v_cvt_pk_bf16_f32 v83, v54, v55
    v_mfma_f32_32x32x16_bf16 v[64:79], v[132:135], v[8:11], v[32:47]
    s_mov_b64 exec, s[46:47]
    ds_read_b128 v[136:139], v154 offset:4096
    ds_read_b128 v[140:143], v154 offset:4608
    s_mov_b64 exec, -1
    v_exp_f32 v57, v57
    v_exp_f32 v58, v58
    v_exp_f32 v59, v59
    v_exp_f32 v60, v60
    v_mfma_f32_32x32x16_bf16 v[96:111], v[144:147], v[80:83], v[96:111]
    v_exp_f32 v61, v61
    v_exp_f32 v62, v62
    v_exp_f32 v63, v63
    v_cvt_pk_bf16_f32 v84, v56, v57
    v_cvt_pk_bf16_f32 v85, v58, v59
    v_cvt_pk_bf16_f32 v86, v60, v61
    v_cvt_pk_bf16_f32 v87, v62, v63
    v_exp_f32 v64, v64
    v_exp_f32 v65, v65
    v_exp_f32 v66, v66
    v_exp_f32 v67, v67
    v_mfma_f32_32x32x16_bf16 v[96:111], v[148:151], v[84:87], v[96:111]
    v_exp_f32 v68, v68
    v_exp_f32 v69, v69
    v_exp_f32 v70, v70
    v_exp_f32 v71, v71
    v_exp_f32 v72, v72
    v_cvt_pk_bf16_f32 v88, v64, v65
    v_cvt_pk_bf16_f32 v89, v66, v67
    v_cvt_pk_bf16_f32 v90, v68, v69
    v_cvt_pk_bf16_f32 v91, v70, v71
    s_waitcnt lgkmcnt(0)
    v_mfma_f32_32x32x16_bf16 v[48:63], v[128:131], v[4:7], v[16:31]
    v_exp_f32 v73, v73
    v_exp_f32 v74, v74
    v_exp_f32 v75, v75
    v_exp_f32 v76, v76
    v_mfma_f32_32x32x16_bf16 v[112:127], v[144:147], v[88:91], v[112:127]
    v_exp_f32 v77, v77
    v_exp_f32 v78, v78
    v_exp_f32 v79, v79
    v_cvt_pk_bf16_f32 v92, v72, v73
    v_cvt_pk_bf16_f32 v93, v74, v75
    v_cvt_pk_bf16_f32 v94, v76, v77
    v_cvt_pk_bf16_f32 v95, v78, v79
    v_exp_f32 v48, v48
    v_exp_f32 v49, v49
    v_exp_f32 v50, v50
    v_exp_f32 v51, v51
    v_mfma_f32_32x32x16_bf16 v[112:127], v[148:151], v[92:95], v[112:127]
    ds_read_b128 v[132:135], v153 offset:5120
    v_exp_f32 v52, v52
    v_exp_f32 v53, v53
    v_exp_f32 v54, v54
    v_exp_f32 v55, v55
    v_exp_f32 v56, v56
    v_cvt_pk_bf16_f32 v80, v48, v49
    v_cvt_pk_bf16_f32 v81, v50, v51
    v_cvt_pk_bf16_f32 v82, v52, v53
    v_cvt_pk_bf16_f32 v83, v54, v55
    v_mfma_f32_32x32x16_bf16 v[64:79], v[128:131], v[8:11], v[32:47]
    s_mov_b64 exec, s[46:47]
    ds_read_b128 v[144:147], v154 offset:5120
    ds_read_b128 v[148:151], v154 offset:5632
    s_mov_b64 exec, -1
    v_exp_f32 v57, v57
    v_exp_f32 v58, v58
    v_exp_f32 v59, v59
    v_exp_f32 v60, v60
    v_mfma_f32_32x32x16_bf16 v[96:111], v[136:139], v[80:83], v[96:111]
    v_exp_f32 v61, v61
    v_exp_f32 v62, v62
    v_exp_f32 v63, v63
    v_cvt_pk_bf16_f32 v84, v56, v57
    v_cvt_pk_bf16_f32 v85, v58, v59
    v_cvt_pk_bf16_f32 v86, v60, v61
    v_cvt_pk_bf16_f32 v87, v62, v63
    v_exp_f32 v64, v64
    v_exp_f32 v65, v65
    v_exp_f32 v66, v66
    v_exp_f32 v67, v67
    v_mfma_f32_32x32x16_bf16 v[96:111], v[140:143], v[84:87], v[96:111]
    v_exp_f32 v68, v68
    v_exp_f32 v69, v69
    v_exp_f32 v70, v70
    v_exp_f32 v71, v71
    v_exp_f32 v72, v72
    v_cvt_pk_bf16_f32 v88, v64, v65
    v_cvt_pk_bf16_f32 v89, v66, v67
    v_cvt_pk_bf16_f32 v90, v68, v69
    v_cvt_pk_bf16_f32 v91, v70, v71
    s_waitcnt lgkmcnt(0)
    v_mfma_f32_32x32x16_bf16 v[48:63], v[132:135], v[4:7], v[16:31]
    v_exp_f32 v73, v73
    v_exp_f32 v74, v74
    v_exp_f32 v75, v75
    v_exp_f32 v76, v76
    v_mfma_f32_32x32x16_bf16 v[112:127], v[136:139], v[88:91], v[112:127]
    v_exp_f32 v77, v77
    v_exp_f32 v78, v78
    v_exp_f32 v79, v79
    v_cvt_pk_bf16_f32 v92, v72, v73
    v_cvt_pk_bf16_f32 v93, v74, v75
    v_cvt_pk_bf16_f32 v94, v76, v77
    v_cvt_pk_bf16_f32 v95, v78, v79
    v_exp_f32 v48, v48
    v_exp_f32 v49, v49
    v_exp_f32 v50, v50
    v_exp_f32 v51, v51
    v_mfma_f32_32x32x16_bf16 v[112:127], v[140:143], v[92:95], v[112:127]
    ds_read_b128 v[128:131], v153 offset:6144
    v_exp_f32 v52, v52
    v_exp_f32 v53, v53
    v_exp_f32 v54, v54
    v_exp_f32 v55, v55
    v_exp_f32 v56, v56
    v_cvt_pk_bf16_f32 v80, v48, v49
    v_cvt_pk_bf16_f32 v81, v50, v51
    v_cvt_pk_bf16_f32 v82, v52, v53
    v_cvt_pk_bf16_f32 v83, v54, v55
    v_mfma_f32_32x32x16_bf16 v[64:79], v[132:135], v[8:11], v[32:47]
    s_mov_b64 exec, s[46:47]
    ds_read_b128 v[136:139], v154 offset:6144
    ds_read_b128 v[140:143], v154 offset:6656
    s_mov_b64 exec, -1
    v_exp_f32 v57, v57
    v_exp_f32 v58, v58
    v_exp_f32 v59, v59
    v_exp_f32 v60, v60
    v_mfma_f32_32x32x16_bf16 v[96:111], v[144:147], v[80:83], v[96:111]
    v_exp_f32 v61, v61
    v_exp_f32 v62, v62
    v_exp_f32 v63, v63
    v_cvt_pk_bf16_f32 v84, v56, v57
    v_cvt_pk_bf16_f32 v85, v58, v59
    v_cvt_pk_bf16_f32 v86, v60, v61
    v_cvt_pk_bf16_f32 v87, v62, v63
    v_exp_f32 v64, v64
    v_exp_f32 v65, v65
    v_exp_f32 v66, v66
    v_exp_f32 v67, v67
    v_mfma_f32_32x32x16_bf16 v[96:111], v[148:151], v[84:87], v[96:111]
    v_exp_f32 v68, v68
    v_exp_f32 v69, v69
    v_exp_f32 v70, v70
    v_exp_f32 v71, v71
    v_exp_f32 v72, v72
    v_cvt_pk_bf16_f32 v88, v64, v65
    v_cvt_pk_bf16_f32 v89, v66, v67
    v_cvt_pk_bf16_f32 v90, v68, v69
    v_cvt_pk_bf16_f32 v91, v70, v71
    s_waitcnt lgkmcnt(0)
    v_mfma_f32_32x32x16_bf16 v[48:63], v[128:131], v[4:7], v[16:31]
    v_exp_f32 v73, v73
    v_exp_f32 v74, v74
    v_exp_f32 v75, v75
    v_exp_f32 v76, v76
    v_mfma_f32_32x32x16_bf16 v[112:127], v[144:147], v[88:91], v[112:127]
    v_exp_f32 v77, v77
    v_exp_f32 v78, v78
    v_exp_f32 v79, v79
    v_cvt_pk_bf16_f32 v92, v72, v73
    v_cvt_pk_bf16_f32 v93, v74, v75
    v_cvt_pk_bf16_f32 v94, v76, v77
    v_cvt_pk_bf16_f32 v95, v78, v79
    v_exp_f32 v48, v48
    v_exp_f32 v49, v49
    v_exp_f32 v50, v50
    v_exp_f32 v51, v51
    v_mfma_f32_32x32x16_bf16 v[112:127], v[148:151], v[92:95], v[112:127]
    ds_read_b128 v[132:135], v153 offset:7168
    v_exp_f32 v52, v52
    v_exp_f32 v53, v53
    v_exp_f32 v54, v54
    v_exp_f32 v55, v55
    v_exp_f32 v56, v56
    v_cvt_pk_bf16_f32 v80, v48, v49
    v_cvt_pk_bf16_f32 v81, v50, v51
    v_cvt_pk_bf16_f32 v82, v52, v53
    v_cvt_pk_bf16_f32 v83, v54, v55
    v_mfma_f32_32x32x16_bf16 v[64:79], v[128:131], v[8:11], v[32:47]
    s_mov_b64 exec, s[46:47]
    ds_read_b128 v[144:147], v154 offset:7168
    ds_read_b128 v[148:151], v154 offset:7680
    s_mov_b64 exec, -1
    v_exp_f32 v57, v57
    v_exp_f32 v58, v58
    v_exp_f32 v59, v59
    v_exp_f32 v60, v60
    v_mfma_f32_32x32x16_bf16 v[96:111], v[136:139], v[80:83], v[96:111]
    v_exp_f32 v61, v61
    v_exp_f32 v62, v62
    v_exp_f32 v63, v63
    v_cvt_pk_bf16_f32 v84, v56, v57
    v_cvt_pk_bf16_f32 v85, v58, v59
    v_cvt_pk_bf16_f32 v86, v60, v61
    v_cvt_pk_bf16_f32 v87, v62, v63
    v_exp_f32 v64, v64
    v_exp_f32 v65, v65
    v_exp_f32 v66, v66
    v_exp_f32 v67, v67
    v_mfma_f32_32x32x16_bf16 v[96:111], v[140:143], v[84:87], v[96:111]
    v_exp_f32 v68, v68
    v_exp_f32 v69, v69
    v_exp_f32 v70, v70
    v_exp_f32 v71, v71
    v_exp_f32 v72, v72
    v_cvt_pk_bf16_f32 v88, v64, v65
    v_cvt_pk_bf16_f32 v89, v66, v67
    v_cvt_pk_bf16_f32 v90, v68, v69
    v_cvt_pk_bf16_f32 v91, v70, v71
    s_waitcnt lgkmcnt(0)
    v_mfma_f32_32x32x16_bf16 v[48:63], v[132:135], v[4:7], v[16:31]
    s_waitcnt vmcnt(0)
    v_mov_b32 v12, 1
    s_mov_b64 exec, 1
    ds_add_u32 v15, v12 offset:61440
    s_mov_b64 exec, -1
    v_exp_f32 v73, v73
    v_exp_f32 v74, v74
    v_exp_f32 v75, v75
    v_exp_f32 v76, v76
    v_mfma_f32_32x32x16_bf16 v[112:127], v[136:139], v[88:91], v[112:127]
    v_add_u32 v153, s40, v157
    v_add_u32 v154, s40, v155
    s_xor_b32 s40, s40, 32768
    ds_read_b32 v12, v15 offset:61440
    v_exp_f32 v77, v77
    v_exp_f32 v78, v78
    v_exp_f32 v79, v79
    v_cvt_pk_bf16_f32 v92, v72, v73
    v_cvt_pk_bf16_f32 v93, v74, v75
    v_cvt_pk_bf16_f32 v94, v76, v77
    v_cvt_pk_bf16_f32 v95, v78, v79
    v_exp_f32 v48, v48
    v_exp_f32 v49, v49
    v_exp_f32 v50, v50
    v_exp_f32 v51, v51
    v_mfma_f32_32x32x16_bf16 v[112:127], v[140:143], v[92:95], v[112:127]
m_sya:
    s_waitcnt lgkmcnt(0)
    v_readfirstlane_b32 s34, v12
    s_cmp_ge_u32 s34, s41
    s_cbranch_scc1 m_sya_ok
    ds_read_b32 v12, v15 offset:61440
    s_branch m_sya
m_sya_ok:
    ds_read_b128 v[128:131], v153 offset:0
    s_add_u32 s41, s41, 4
    s_add_u32 m0, s18, s40
    v_exp_f32 v52, v52
    v_exp_f32 v53, v53
    v_exp_f32 v54, v54
    v_exp_f32 v55, v55
    v_exp_f32 v56, v56
    v_cvt_pk_bf16_f32 v80, v48, v49
    v_cvt_pk_bf16_f32 v81, v50, v51
    v_cvt_pk_bf16_f32 v82, v52, v53
    v_cvt_pk_bf16_f32 v83, v54, v55
    v_mfma_f32_32x32x16_bf16 v[64:79], v[132:135], v[8:11], v[32:47]
    s_mov_b64 exec, s[46:47]
    ds_read_b128 v[136:139], v154 offset:0
    ds_read_b128 v[140:143], v154 offset:512
    s_mov_b64 exec, -1
    buffer_load_dwordx4 v152, s[28:31], s32 offen offset:0 sc1 lds
    v_exp_f32 v57, v57
    v_exp_f32 v58, v58
    v_exp_f32 v59, v59
    v_exp_f32 v60, v60
    v_mfma_f32_32x32x16_bf16 v[96:111], v[144:147], v[80:83], v[96:111]
    buffer_load_dwordx4 v152, s[28:31], s32 offen offset:1024 sc1 lds
    v_exp_f32 v61, v61
    v_exp_f32 v62, v62
    v_exp_f32 v63, v63
    v_cvt_pk_bf16_f32 v84, v56, v57
    v_cvt_pk_bf16_f32 v85, v58, v59
    v_cvt_pk_bf16_f32 v86, v60, v61
    v_cvt_pk_bf16_f32 v87, v62, v63
    v_exp_f32 v64, v64
    v_exp_f32 v65, v65
    v_exp_f32 v66, v66
    v_exp_f32 v67, v67
    v_mfma_f32_32x32x16_bf16 v[96:111], v[148:151], v[84:87], v[96:111]
    buffer_load_dwordx4 v152, s[28:31], s32 offen offset:2048 sc1 lds
    v_exp_f32 v68, v68
    v_exp_f32 v69, v69
    v_exp_f32 v70, v70
    v_exp_f32 v71, v71
    v_exp_f32 v72, v72
    v_cvt_pk_bf16_f32 v88, v64, v65
    v_cvt_pk_bf16_f32 v89, v66, v67
    v_cvt_pk_bf16_f32 v90, v68, v69
    v_cvt_pk_bf16_f32 v91, v70, v71
    s_waitcnt lgkmcnt(0)
    v_mfma_f32_32x32x16_bf16 v[48:63], v[128:131], v[4:7], v[16:31]
    buffer_load_dwordx4 v152, s[28:31], s32 offen offset:3072 sc1 lds
    s_add_u32 s32, s32, 8192
    v_exp_f32 v73, v73
    v_exp_f32 v74, v74
    v_exp_f32 v75, v75
    v_exp_f32 v76, v76
    v_mfma_f32_32x32x16_bf16 v[112:127], v[144:147], v[88:91], v[112:127]
    s_add_u32 s35, s35, 1
    s_setprio 2
    v_exp_f32 v77, v77
    v_exp_f32 v78, v78
    v_exp_f32 v79, v79
    v_cvt_pk_bf16_f32 v92, v72, v73
    v_cvt_pk_bf16_f32 v93, v74, v75
    v_cvt_pk_bf16_f32 v94, v76, v77
    v_cvt_pk_bf16_f32 v95, v78, v79
    s_cmp_lt_u32 s35, 2
    s_cbranch_scc1 m_attn_loop
    s_setprio 2
m_attn_loop2:
    v_exp_f32 v48, v48
    v_exp_f32 v49, v49
    v_exp_f32 v50, v50
    v_exp_f32 v51, v51
    v_mfma_f32_32x32x16_bf16 v[112:127], v[148:151], v[92:95], v[112:127]
    ds_read_b128 v[132:135], v153 offset:1024
    v_exp_f32 v52, v52
    v_exp_f32 v53, v53
    v_exp_f32 v54, v54
    v_exp_f32 v55, v55
    v_exp_f32 v56, v56
    v_cvt_pk_bf16_f32 v80, v48, v49
    v_cvt_pk_bf16_f32 v81, v50, v51
    v_cvt_pk_bf16_f32 v82, v52, v53
    v_cvt_pk_bf16_f32 v83, v54, v55
    v_mfma_f32_32x32x16_bf16 v[64:79], v[128:131], v[8:11], v[32:47]
    s_mov_b64 exec, s[46:47]
    ds_read_b128 v[144:147], v154 offset:1024
    ds_read_b128 v[148:151], v154 offset:1536
    s_mov_b64 exec, -1
    v_exp_f32 v57, v57
    v_exp_f32 v58, v58
    v_exp_f32 v59, v59
    v_exp_f32 v60, v60
    v_mfma_f32_32x32x16_bf16 v[96:111], v[136:139], v[80:83], v[96:111]
    v_exp_f32 v61, v61
    v_exp_f32 v62, v62
    v_exp_f32 v63, v63
    v_cvt_pk_bf16_f32 v84, v56, v57
    v_cvt_pk_bf16_f32 v85, v58, v59
    v_cvt_pk_bf16_f32 v86, v60, v61
    v_cvt_pk_bf16_f32 v87, v62, v63
    v_exp_f32 v64, v64
    v_exp_f32 v65, v65
    v_exp_f32 v66, v66
    v_exp_f32 v67, v67
    v_mfma_f32_32x32x16_bf16 v[96:111], v[140:143], v[84:87], v[96:111]
    v_exp_f32 v68, v68
    v_exp_f32 v69, v69
    v_exp_f32 v70, v70
    v_exp_f32 v71, v71
    v_exp_f32 v72, v72
    v_cvt_pk_bf16_f32 v88, v64, v65
    v_cvt_pk_bf16_f32 v89, v66, v67
    v_cvt_pk_bf16_f32 v90, v68, v69
    v_cvt_pk_bf16_f32 v91, v70, v71
    s_waitcnt lgkmcnt(0)
    v_mfma_f32_32x32x16_bf16 v[48:63], v[132:135], v[4:7], v[16:31]
    v_exp_f32 v73, v73
    v_exp_f32 v74, v74
    v_exp_f32 v75, v75
    v_exp_f32 v76, v76
    v_mfma_f32_32x32x16_bf16 v[112:127], v[136:139], v[88:91], v[112:127]
    v_exp_f32 v77, v77
    v_exp_f32 v78, v78
    v_exp_f32 v79, v79
    v_cvt_pk_bf16_f32 v92, v72, v73
    v_cvt_pk_bf16_f32 v93, v74, v75
    v_cvt_pk_bf16_f32 v94, v76, v77
    v_cvt_pk_bf16_f32 v95, v78, v79
    v_exp_f32 v48, v48
    v_exp_f32 v49, v49
    v_exp_f32 v50, v50
    v_exp_f32 v51, v51
    v_mfma_f32_32x32x16_bf16 v[112:127], v[140:143], v[92:95], v[112:127]
    ds_read_b128 v[128:131], v153 offset:2048
    v_exp_f32 v52, v52
    v_exp_f32 v53, v53
    v_exp_f32 v54, v54
    v_exp_f32 v55, v55
    v_exp_f32 v56, v56
    v_cvt_pk_bf16_f32 v80, v48, v49
    v_cvt_pk_bf16_f32 v81, v50, v51
    v_cvt_pk_bf16_f32 v82, v52, v53
    v_cvt_pk_bf16_f32 v83, v54, v55
    v_mfma_f32_32x32x16_bf16 v[64:79], v[132:135], v[8:11], v[32:47]
    s_mov_b64 exec, s[46:47]
    ds_read_b128 v[136:139], v154 offset:2048
    ds_read_b128 v[140:143], v154 offset:2560
    s_mov_b64 exec, -1
    v_exp_f32 v57, v57
    v_exp_f32 v58, v58
    v_exp_f32 v59, v59
    v_exp_f32 v60, v60
    v_mfma_f32_32x32x16_bf16 v[96:111], v[144:147], v[80:83], v[96:111]
    v_exp_f32 v61, v61
    v_exp_f32 v62, v62
    v_exp_f32 v63, v63
    v_cvt_pk_bf16_f32 v84, v56, v57
    v_cvt_pk_bf16_f32 v85, v58, v59
    v_cvt_pk_bf16_f32 v86, v60, v61
    v_cvt_pk_bf16_f32 v87, v62, v63
    v_exp_f32 v64, v64
    v_exp_f32 v65, v65
    v_exp_f32 v66, v66
    v_exp_f32 v67, v67
    v_mfma_f32_32x32x16_bf16 v[96:111], v[148:151], v[84:87], v[96:111]
    v_exp_f32 v68, v68
    v_exp_f32 v69, v69
    v_exp_f32 v70, v70
    v_exp_f32 v71, v71
    v_exp_f32 v72, v72
    v_cvt_pk_bf16_f32 v88, v64, v65
    v_cvt_pk_bf16_f32 v89, v66, v67
    v_cvt_pk_bf16_f32 v90, v68, v69
    v_cvt_pk_bf16_f32 v91, v70, v71
    s_waitcnt lgkmcnt(0)
    v_mfma_f32_32x32x16_bf16 v[48:63], v[128:131], v[4:7], v[16:31]
    v_exp_f32 v73, v73
    v_exp_f32 v74, v74
    v_exp_f32 v75, v75
    v_exp_f32 v76, v76
    v_mfma_f32_32x32x16_bf16 v[112:127], v[144:147], v[88:91], v[112:127]
    v_exp_f32 v77, v77
    v_exp_f32 v78, v78
    v_exp_f32 v79, v79
    v_cvt_pk_bf16_f32 v92, v72, v73
    v_cvt_pk_bf16_f32 v93, v74, v75
    v_cvt_pk_bf16_f32 v94, v76, v77
    v_cvt_pk_bf16_f32 v95, v78, v79
    v_exp_f32 v48, v48
    v_exp_f32 v49, v49
    v_exp_f32 v50, v50
    v_exp_f32 v51, v51
    v_mfma_f32_32x32x16_bf16 v[112:127], v[148:151], v[92:95], v[112:127]
    ds_read_b128 v[132:135], v153 offset:3072
    v_exp_f32 v52, v52
    v_exp_f32 v53, v53
    v_exp_f32 v54, v54
    v_exp_f32 v55, v55
    v_exp_f32 v56, v56
    v_cvt_pk_bf16_f32 v80, v48, v49
    v_cvt_pk_bf16_f32 v81, v50, v51
    v_cvt_pk_bf16_f32 v82, v52, v53
    v_cvt_pk_bf16_f32 v83, v54, v55
    v_mfma_f32_32x32x16_bf16 v[64:79], v[128:131], v[8:11], v[32:47]
    s_mov_b64 exec, s[46:47]
    ds_read_b128 v[144:147], v154 offset:3072
    ds_read_b128 v[148:151], v154 offset:3584
    s_mov_b64 exec, -1
    v_exp_f32 v57, v57
    v_exp_f32 v58, v58
    v_exp_f32 v59, v59
    v_exp_f32 v60, v60
    v_mfma_f32_32x32x16_bf16 v[96:111], v[136:139], v[80:83], v[96:111]
    v_exp_f32 v61, v61
    v_exp_f32 v62, v62
    v_exp_f32 v63, v63
    v_cvt_pk_bf16_f32 v84, v56, v57
    v_cvt_pk_bf16_f32 v85, v58, v59
    v_cvt_pk_bf16_f32 v86, v60, v61
    v_cvt_pk_bf16_f32 v87, v62, v63
    v_exp_f32 v64, v64
    v_exp_f32 v65, v65
    v_exp_f32 v66, v66
    v_exp_f32 v67, v67
    v_mfma_f32_32x32x16_bf16 v[96:111], v[140:143], v[84:87], v[96:111]
    v_exp_f32 v68, v68
    v_exp_f32 v69, v69
    v_exp_f32 v70, v70
    v_exp_f32 v71, v71
    v_exp_f32 v72, v72
    v_cvt_pk_bf16_f32 v88, v64, v65
    v_cvt_pk_bf16_f32 v89, v66, v67
    v_cvt_pk_bf16_f32 v90, v68, v69
    v_cvt_pk_bf16_f32 v91, v70, v71
    s_waitcnt lgkmcnt(0)
    v_mfma_f32_32x32x16_bf16 v[48:63], v[132:135], v[4:7], v[16:31]
    v_exp_f32 v73, v73
    v_exp_f32 v74, v74
    v_exp_f32 v75, v75
    v_exp_f32 v76, v76
    v_mfma_f32_32x32x16_bf16 v[112:127], v[136:139], v[88:91], v[112:127]
    v_exp_f32 v77, v77
    v_exp_f32 v78, v78
    v_exp_f32 v79, v79
    v_cvt_pk_bf16_f32 v92, v72, v73
    v_cvt_pk_bf16_f32 v93, v74, v75
    v_cvt_pk_bf16_f32 v94, v76, v77
    v_cvt_pk_bf16_f32 v95, v78, v79
    v_exp_f32 v48, v48
    v_exp_f32 v49, v49
    v_exp_f32 v50, v50
    v_exp_f32 v51, v51
    v_mfma_f32_32x32x16_bf16 v[112:127], v[140:143], v[92:95], v[112:127]
    ds_read_b128 v[128:131], v153 offset:4096
    v_exp_f32 v52, v52
    v_exp_f32 v53, v53
    v_exp_f32 v54, v54
    v_exp_f32 v55, v55
    v_exp_f32 v56, v56
    v_cvt_pk_bf16_f32 v80, v48, v49
    v_cvt_pk_bf16_f32 v81, v50, v51
    v_cvt_pk_bf16_f32 v82, v52, v53
    v_cvt_pk_bf16_f32 v83, v54, v55
    v_mfma_f32_32x32x16_bf16 v[64:79], v[132:135], v[8:11], v[32:47]
    s_mov_b64 exec, s[46:47]
    ds_read_b128 v[136:139], v154 offset:4096
    ds_read_b128 v[140:143], v154 offset:4608
    s_mov_b64 exec, -1
    v_exp_f32 v57, v57
    v_exp_f32 v58, v58
    v_exp_f32 v59, v59
    v_exp_f32 v60, v60
    v_mfma_f32_32x32x16_bf16 v[96:111], v[144:147], v[80:83], v[96:111]
    v_exp_f32 v61, v61
    v_exp_f32 v62, v62
    v_exp_f32 v63, v63
    v_cvt_pk_bf16_f32 v84, v56, v57
    v_cvt_pk_bf16_f32 v85, v58, v59
    v_cvt_pk_bf16_f32 v86, v60, v61
    v_cvt_pk_bf16_f32 v87, v62, v63
    v_exp_f32 v64, v64
    v_exp_f32 v65, v65
    v_exp_f32 v66, v66
    v_exp_f32 v67, v67
    v_mfma_f32_32x32x16_bf16 v[96:111], v[148:151], v[84:87], v[96:111]
    v_exp_f32 v68, v68
    v_exp_f32 v69, v69
    v_exp_f32 v70, v70
    v_exp_f32 v71, v71
    v_exp_f32 v72, v72
    v_cvt_pk_bf16_f32 v88, v64, v65
    v_cvt_pk_bf16_f32 v89, v66, v67
    v_cvt_pk_bf16_f32 v90, v68, v69
    v_cvt_pk_bf16_f32 v91, v70, v71
    s_waitcnt lgkmcnt(0)
    v_mfma_f32_32x32x16_bf16 v[48:63], v[128:131], v[4:7], v[16:31]
    v_exp_f32 v73, v73
    v_exp_f32 v74, v74
    v_exp_f32 v75, v75
    v_exp_f32 v76, v76
    v_mfma_f32_32x32x16_bf16 v[112:127], v[144:147], v[88:91], v[112:127]
    v_exp_f32 v77, v77
    v_exp_f32 v78, v78
    v_exp_f32 v79, v79
    v_cvt_pk_bf16_f32 v92, v72, v73
    v_cvt_pk_bf16_f32 v93, v74, v75
    v_cvt_pk_bf16_f32 v94, v76, v77
    v_cvt_pk_bf16_f32 v95, v78, v79
    v_exp_f32 v48, v48
    v_exp_f32 v49, v49
    v_exp_f32 v50, v50
    v_exp_f32 v51, v51
    v_mfma_f32_32x32x16_bf16 v[112:127], v[148:151], v[92:95], v[112:127]
    ds_read_b128 v[132:135], v153 offset:5120
    v_exp_f32 v52, v52
    v_exp_f32 v53, v53
    v_exp_f32 v54, v54
    v_exp_f32 v55, v55
    v_exp_f32 v56, v56
    v_cvt_pk_bf16_f32 v80, v48, v49
    v_cvt_pk_bf16_f32 v81, v50, v51
    v_cvt_pk_bf16_f32 v82, v52, v53
    v_cvt_pk_bf16_f32 v83, v54, v55
    v_mfma_f32_32x32x16_bf16 v[64:79], v[128:131], v[8:11], v[32:47]
    s_mov_b64 exec, s[46:47]
    ds_read_b128 v[144:147], v154 offset:5120
    ds_read_b128 v[148:151], v154 offset:5632
    s_mov_b64 exec, -1
    v_exp_f32 v57, v57
    v_exp_f32 v58, v58
    v_exp_f32 v59, v59
    v_exp_f32 v60, v60
    v_mfma_f32_32x32x16_bf16 v[96:111], v[136:139], v[80:83], v[96:111]
    v_exp_f32 v61, v61
    v_exp_f32 v62, v62
    v_exp_f32 v63, v63
    v_cvt_pk_bf16_f32 v84, v56, v57
    v_cvt_pk_bf16_f32 v85, v58, v59
    v_cvt_pk_bf16_f32 v86, v60, v61
    v_cvt_pk_bf16_f32 v87, v62, v63
    v_exp_f32 v64, v64
    v_exp_f32 v65, v65
    v_exp_f32 v66, v66
    v_exp_f32 v67, v67
    v_mfma_f32_32x32x16_bf16 v[96:111], v[140:143], v[84:87], v[96:111]
    v_exp_f32 v68, v68
    v_exp_f32 v69, v69
    v_exp_f32 v70, v70
    v_exp_f32 v71, v71
    v_exp_f32 v72, v72
    v_cvt_pk_bf16_f32 v88, v64, v65
    v_cvt_pk_bf16_f32 v89, v66, v67
    v_cvt_pk_bf16_f32 v90, v68, v69
    v_cvt_pk_bf16_f32 v91, v70, v71
    s_waitcnt lgkmcnt(0)
    v_mfma_f32_32x32x16_bf16 v[48:63], v[132:135], v[4:7], v[16:31]
    v_exp_f32 v73, v73
    v_exp_f32 v74, v74
    v_exp_f32 v75, v75
    v_exp_f32 v76, v76
    v_mfma_f32_32x32x16_bf16 v[112:127], v[136:139], v[88:91], v[112:127]
    v_exp_f32 v77, v77
    v_exp_f32 v78, v78
    v_exp_f32 v79, v79
    v_cvt_pk_bf16_f32 v92, v72, v73
    v_cvt_pk_bf16_f32 v93, v74, v75
    v_cvt_pk_bf16_f32 v94, v76, v77
    v_cvt_pk_bf16_f32 v95, v78, v79
    v_exp_f32 v48, v48
    v_exp_f32 v49, v49
    v_exp_f32 v50, v50
    v_exp_f32 v51, v51
    v_mfma_f32_32x32x16_bf16 v[112:127], v[140:143], v[92:95], v[112:127]
    ds_read_b128 v[128:131], v153 offset:6144
    v_exp_f32 v52, v52
    v_exp_f32 v53, v53
    v_exp_f32 v54, v54
    v_exp_f32 v55, v55
    v_exp_f32 v56, v56
    v_cvt_pk_bf16_f32 v80, v48, v49
    v_cvt_pk_bf16_f32 v81, v50, v51
    v_cvt_pk_bf16_f32 v82, v52, v53
    v_cvt_pk_bf16_f32 v83, v54, v55
    v_mfma_f32_32x32x16_bf16 v[64:79], v[132:135], v[8:11], v[32:47]
    s_mov_b64 exec, s[46:47]
    ds_read_b128 v[136:139], v154 offset:6144
    ds_read_b128 v[140:143], v154 offset:6656
    s_mov_b64 exec, -1
    v_exp_f32 v57, v57
    v_exp_f32 v58, v58
    v_exp_f32 v59, v59
    v_exp_f32 v60, v60
    v_mfma_f32_32x32x16_bf16 v[96:111], v[144:147], v[80:83], v[96:111]
    v_exp_f32 v61, v61
    v_exp_f32 v62, v62
    v_exp_f32 v63, v63
    v_cvt_pk_bf16_f32 v84, v56, v57
    v_cvt_pk_bf16_f32 v85, v58, v59
    v_cvt_pk_bf16_f32 v86, v60, v61
    v_cvt_pk_bf16_f32 v87, v62, v63
    v_exp_f32 v64, v64
    v_exp_f32 v65, v65
    v_exp_f32 v66, v66
    v_exp_f32 v67, v67
    v_mfma_f32_32x32x16_bf16 v[96:111], v[148:151], v[84:87], v[96:111]
    v_exp_f32 v68, v68
    v_exp_f32 v69, v69
    v_exp_f32 v70, v70
    v_exp_f32 v71, v71
    v_exp_f32 v72, v72
    v_cvt_pk_bf16_f32 v88, v64, v65
    v_cvt_pk_bf16_f32 v89, v66, v67
    v_cvt_pk_bf16_f32 v90, v68, v69
    v_cvt_pk_bf16_f32 v91, v70, v71
    s_waitcnt lgkmcnt(0)
    v_mfma_f32_32x32x16_bf16 v[48:63], v[128:131], v[4:7], v[16:31]
    v_exp_f32 v73, v73
    v_exp_f32 v74, v74
    v_exp_f32 v75, v75
    v_exp_f32 v76, v76
    v_mfma_f32_32x32x16_bf16 v[112:127], v[144:147], v[88:91], v[112:127]
    v_exp_f32 v77, v77
    v_exp_f32 v78, v78
    v_exp_f32 v79, v79
    v_cvt_pk_bf16_f32 v92, v72, v73
    v_cvt_pk_bf16_f32 v93, v74, v75
    v_cvt_pk_bf16_f32 v94, v76, v77
    v_cvt_pk_bf16_f32 v95, v78, v79
    v_exp_f32 v48, v48
    v_exp_f32 v49, v49
    v_exp_f32 v50, v50
    v_exp_f32 v51, v51
    v_mfma_f32_32x32x16_bf16 v[112:127], v[148:151], v[92:95], v[112:127]
    ds_read_b128 v[132:135], v153 offset:7168
    v_exp_f32 v52, v52
    v_exp_f32 v53, v53
    v_exp_f32 v54, v54
    v_exp_f32 v55, v55
    v_exp_f32 v56, v56
    v_cvt_pk_bf16_f32 v80, v48, v49
    v_cvt_pk_bf16_f32 v81, v50, v51
    v_cvt_pk_bf16_f32 v82, v52, v53
    v_cvt_pk_bf16_f32 v83, v54, v55
    v_mfma_f32_32x32x16_bf16 v[64:79], v[128:131], v[8:11], v[32:47]
    s_mov_b64 exec, s[46:47]
    ds_read_b128 v[144:147], v154 offset:7168
    ds_read_b128 v[148:151], v154 offset:7680
    s_mov_b64 exec, -1
    v_exp_f32 v57, v57
    v_exp_f32 v58, v58
    v_exp_f32 v59, v59
    v_exp_f32 v60, v60
    v_mfma_f32_32x32x16_bf16 v[96:111], v[136:139], v[80:83], v[96:111]
    v_exp_f32 v61, v61
    v_exp_f32 v62, v62
    v_exp_f32 v63, v63
    v_cvt_pk_bf16_f32 v84, v56, v57
    v_cvt_pk_bf16_f32 v85, v58, v59
    v_cvt_pk_bf16_f32 v86, v60, v61
    v_cvt_pk_bf16_f32 v87, v62, v63
    v_exp_f32 v64, v64
    v_exp_f32 v65, v65
    v_exp_f32 v66, v66
    v_exp_f32 v67, v67
    v_mfma_f32_32x32x16_bf16 v[96:111], v[140:143], v[84:87], v[96:111]
    v_exp_f32 v68, v68
    v_exp_f32 v69, v69
    v_exp_f32 v70, v70
    v_exp_f32 v71, v71
    v_exp_f32 v72, v72
    v_cvt_pk_bf16_f32 v88, v64, v65
    v_cvt_pk_bf16_f32 v89, v66, v67
    v_cvt_pk_bf16_f32 v90, v68, v69
    v_cvt_pk_bf16_f32 v91, v70, v71
    s_waitcnt lgkmcnt(0)
    v_mfma_f32_32x32x16_bf16 v[48:63], v[132:135], v[4:7], v[16:31]
    s_waitcnt vmcnt(0)
    v_mov_b32 v12, 1
    s_mov_b64 exec, 1
    ds_add_u32 v15, v12 offset:61440
    s_mov_b64 exec, -1
    v_exp_f32 v73, v73
    v_exp_f32 v74, v74
    v_exp_f32 v75, v75
    v_exp_f32 v76, v76
    v_mfma_f32_32x32x16_bf16 v[112:127], v[136:139], v[88:91], v[112:127]
    v_add_u32 v153, s40, v157
    v_add_u32 v154, s40, v155
    s_xor_b32 s40, s40, 32768
    ds_read_b32 v12, v15 offset:61440
    v_exp_f32 v77, v77
    v_exp_f32 v78, v78
    v_exp_f32 v79, v79
    v_cvt_pk_bf16_f32 v92, v72, v73
    v_cvt_pk_bf16_f32 v93, v74, v75
    v_cvt_pk_bf16_f32 v94, v76, v77
    v_cvt_pk_bf16_f32 v95, v78, v79
    v_exp_f32 v48, v48
    v_exp_f32 v49, v49
    v_exp_f32 v50, v50
    v_exp_f32 v51, v51
    v_mfma_f32_32x32x16_bf16 v[112:127], v[140:143], v[92:95], v[112:127]
m_syb:
    s_waitcnt lgkmcnt(0)
    v_readfirstlane_b32 s34, v12
    s_cmp_ge_u32 s34, s41
    s_cbranch_scc1 m_syb_ok
    ds_read_b32 v12, v15 offset:61440
    s_branch m_syb
m_syb_ok:
    ds_read_b128 v[128:131], v153 offset:0
    s_add_u32 s41, s41, 4
    v_exp_f32 v52, v52
    v_exp_f32 v53, v53
    v_exp_f32 v54, v54
    v_exp_f32 v55, v55
    v_exp_f32 v56, v56
    v_cvt_pk_bf16_f32 v80, v48, v49
    v_cvt_pk_bf16_f32 v81, v50, v51
    v_cvt_pk_bf16_f32 v82, v52, v53
    v_cvt_pk_bf16_f32 v83, v54, v55
    v_mfma_f32_32x32x16_bf16 v[64:79], v[132:135], v[8:11], v[32:47]
    s_mov_b64 exec, s[46:47]
    ds_read_b128 v[136:139], v154 offset:0
    ds_read_b128 v[140:143], v154 offset:512
    s_mov_b64 exec, -1
    v_exp_f32 v57, v57
    v_exp_f32 v58, v58
    v_exp_f32 v59, v59
    v_exp_f32 v60, v60
    v_mfma_f32_32x32x16_bf16 v[96:111], v[144:147], v[80:83], v[96:111]
    v_exp_f32 v61, v61
    v_exp_f32 v62, v62
    v_exp_f32 v63, v63
    v_cvt_pk_bf16_f32 v84, v56, v57
    v_cvt_pk_bf16_f32 v85, v58, v59
    v_cvt_pk_bf16_f32 v86, v60, v61
    v_cvt_pk_bf16_f32 v87, v62, v63
    v_exp_f32 v64, v64
    v_exp_f32 v65, v65
    v_exp_f32 v66, v66
    v_exp_f32 v67, v67
    v_mfma_f32_32x32x16_bf16 v[96:111], v[148:151], v[84:87], v[96:111]
    v_exp_f32 v68, v68
    v_exp_f32 v69, v69
    v_exp_f32 v70, v70
    v_exp_f32 v71, v71
    v_exp_f32 v72, v72
    v_cvt_pk_bf16_f32 v88, v64, v65
    v_cvt_pk_bf16_f32 v89, v66, v67
    v_cvt_pk_bf16_f32 v90, v68, v69
    v_cvt_pk_bf16_f32 v91, v70, v71
    s_waitcnt lgkmcnt(0)
    v_mfma_f32_32x32x16_bf16 v[48:63], v[128:131], v[4:7], v[16:31]
    v_exp_f32 v73, v73
    v_exp_f32 v74, v74
    v_exp_f32 v75, v75
    v_exp_f32 v76, v76
    v_mfma_f32_32x32x16_bf16 v[112:127], v[144:147], v[88:91], v[112:127]
    s_add_u32 s35, s35, 1
    s_setprio 1
    v_exp_f32 v77, v77
    v_exp_f32 v78, v78
    v_exp_f32 v79, v79
    v_cvt_pk_bf16_f32 v92, v72, v73
    v_cvt_pk_bf16_f32 v93, v74, v75
    v_cvt_pk_bf16_f32 v94, v76, v77
    v_cvt_pk_bf16_f32 v95, v78, v79
    s_cmp_lt_u32 s35, 4
    s_cbranch_scc1 m_attn_loop2
    s_nop 0
    v_mfma_f32_32x32x16_bf16 v[112:127], v[148:151], v[92:95], v[112:127]
    s_setprio 3
    s_lshr_b32 s36, s13, 1
    s_lshl_b32 s36, s36, 15
    s_and_b32 s37, s13, 1
    s_lshl_b32 s37, s37, 13
    s_add_u32 s36, s36, s37
    s_add_u32 s36, s36, 81920
    v_add_u32 v153, s36, v152
    s_lshl_b32 s36, s13, 2
    v_add_u32 v15, s36, v152
    v_mov_b32 v160, 0x7f000000
    s_cmp_eq_u32 s14, 0
    s_cbranch_scc1 m_attn_comb
    s_nop 4
    v_mov_b32 v105, v16
    v_mov_b32 v121, v32
    ds_write_b128 v153, v[96:99] offset:0
    ds_write_b128 v153, v[100:103] offset:1024
    ds_write_b128 v153, v[104:107] offset:2048
    ds_write_b128 v153, v[112:115] offset:3072
    ds_write_b128 v153, v[116:119] offset:4096
    ds_write_b128 v153, v[120:123] offset:5120
    s_waitcnt lgkmcnt(0)
    v_mov_b32 v12, 1
    s_mov_b64 exec, 1
    ds_add_u32 v15, v12 offset:61456
    s_mov_b64 exec, -1
    s_endpgm
m_attn_comb:
    ds_read_b32 v12, v15 offset:61456
m_syc:
    s_waitcnt lgkmcnt(0)
    v_readfirstlane_b32 s34, v12
    s_cmp_ge_u32 s34, 1
    s_cbranch_scc1 m_syc_ok
    ds_read_b32 v12, v15 offset:61456
    s_branch m_syc
m_syc_ok:
    ds_read_b128 v[48:51], v153 offset:0
    ds_read_b128 v[52:55], v153 offset:1024
    ds_read_b128 v[56:59], v153 offset:2048
    ds_read_b128 v[64:67], v153 offset:3072
    ds_read_b128 v[68:71], v153 offset:4096
    ds_read_b128 v[72:75], v153 offset:5120
    s_waitcnt lgkmcnt(0)
    v_min_f32 v162, v16, v57
    v_sub_f32 v164, v162, v16
    v_sub_f32 v162, v162, v57
    v_exp_f32 v164, v164
    v_exp_f32 v162, v162
    v_pk_mul_f32 v[96:97], v[96:97], v[164:165] op_sel_hi:[1,0]
    v_pk_mul_f32 v[98:99], v[98:99], v[164:165] op_sel_hi:[1,0]
    v_pk_mul_f32 v[100:101], v[100:101], v[164:165] op_sel_hi:[1,0]
    v_pk_mul_f32 v[102:103], v[102:103], v[164:165] op_sel_hi:[1,0]
    v_pk_mul_f32 v[104:105], v[104:105], v[164:165] op_sel_hi:[1,0]
    v_pk_fma_f32 v[96:97], v[48:49], v[162:163], v[96:97] op_sel_hi:[1,0,1]
    v_pk_fma_f32 v[98:99], v[50:51], v[162:163], v[98:99] op_sel_hi:[1,0,1]
    v_pk_fma_f32 v[100:101], v[52:53], v[162:163], v[100:101] op_sel_hi:[1,0,1]
    v_pk_fma_f32 v[102:103], v[54:55], v[162:163], v[102:103] op_sel_hi:[1,0,1]
    v_pk_fma_f32 v[104:105], v[56:57], v[162:163], v[104:105] op_sel_hi:[1,0,1]
    v_min_f32 v162, v32, v73
    v_sub_f32 v164, v162, v32
    v_sub_f32 v162, v162, v73
    v_exp_f32 v164, v164
    v_exp_f32 v162, v162
    v_pk_mul_f32 v[112:113], v[112:113], v[164:165] op_sel_hi:[1,0]
    v_pk_mul_f32 v[114:115], v[114:115], v[164:165] op_sel_hi:[1,0]
    v_pk_mul_f32 v[116:117], v[116:117], v[164:165] op_sel_hi:[1,0]
    v_pk_mul_f32 v[118:119], v[118:119], v[164:165] op_sel_hi:[1,0]
    v_pk_mul_f32 v[120:121], v[120:121], v[164:165] op_sel_hi:[1,0]
    v_pk_fma_f32 v[112:113], v[64:65], v[162:163], v[112:113] op_sel_hi:[1,0,1]
    v_pk_fma_f32 v[114:115], v[66:67], v[162:163], v[114:115] op_sel_hi:[1,0,1]
    v_pk_fma_f32 v[116:117], v[68:69], v[162:163], v[116:117] op_sel_hi:[1,0,1]
    v_pk_fma_f32 v[118:119], v[70:71], v[162:163], v[118:119] op_sel_hi:[1,0,1]
    v_pk_fma_f32 v[120:121], v[72:73], v[162:163], v[120:121] op_sel_hi:[1,0,1]
    v_add_f32 v158, abs(v96), abs(v97)
    v_add_f32 v158, abs(v98), v158
    v_add_f32 v158, abs(v99), v158
    v_add_f32 v158, abs(v100), v158
    v_add_f32 v158, abs(v101), v158
    v_add_f32 v158, abs(v102), v158
    v_add_f32 v158, abs(v103), v158
    v_add_f32 v158, abs(v104), v158
    v_add_f32 v159, abs(v112), abs(v113)
    v_add_f32 v159, abs(v114), v159
    v_add_f32 v159, abs(v115), v159
    v_add_f32 v159, abs(v116), v159
    v_add_f32 v159, abs(v117), v159
    v_add_f32 v159, abs(v118), v159
    v_add_f32 v159, abs(v119), v159
    v_add_f32 v159, abs(v120), v159
    v_add_f32 v158, v158, v159
    v_cmp_nlt_f32 vcc, v158, v160
    s_cbranch_vccnz m_attn_slow
m_attn_fin:
    v_rcp_f32 v162, v104
    v_rcp_f32 v164, v120
    v_pk_mul_f32 v[96:97], v[96:97], v[162:163] op_sel_hi:[1,0]
    v_pk_mul_f32 v[98:99], v[98:99], v[162:163] op_sel_hi:[1,0]
    v_pk_mul_f32 v[100:101], v[100:101], v[162:163] op_sel_hi:[1,0]
    v_pk_mul_f32 v[102:103], v[102:103], v[162:163] op_sel_hi:[1,0]
    v_cvt_pk_bf16_f32 v80, v96, v97
    v_cvt_pk_bf16_f32 v81, v98, v99
    v_cvt_pk_bf16_f32 v82, v100, v101
    v_cvt_pk_bf16_f32 v83, v102, v103
    buffer_store_dwordx4 v[80:83], v152, s[28:31], s38 offen sc1
    v_pk_mul_f32 v[112:113], v[112:113], v[164:165] op_sel_hi:[1,0]
    v_pk_mul_f32 v[114:115], v[114:115], v[164:165] op_sel_hi:[1,0]
    v_pk_mul_f32 v[116:117], v[116:117], v[164:165] op_sel_hi:[1,0]
    v_pk_mul_f32 v[118:119], v[118:119], v[164:165] op_sel_hi:[1,0]
    v_cvt_pk_bf16_f32 v88, v112, v113
    v_cvt_pk_bf16_f32 v89, v114, v115
    v_cvt_pk_bf16_f32 v90, v116, v117
    v_cvt_pk_bf16_f32 v91, v118, v119
    buffer_store_dwordx4 v[88:91], v152, s[28:31], s39 offen sc1
    s_lshl_b32 s36, s16, 2
    s_add_u32 s36, s36, s13
    s_lshl_b32 s36, s36, 5
    s_add_u32 s36, s36, s15
    s_lshl_b32 s36, s36, 5
    s_add_u32 s36, s36, 24903680
    v_mov_b32 v158, s61
    s_waitcnt vmcnt(0)
    buffer_store_dword v158, off, s[28:31], s36 sc1
    s_endpgm
m_attn_slow:
    s_lshl_b32 s36, s15, 16
    s_add_u32 s32, s36, 2097152
    s_add_u32 s33, s36, 4194304
    v_and_b32 v154, 0x1ff, v155
    v_not_b32 v161, v156
    v_and_b32 v162, 0x80000000, v161
    v_or_b32 v154, v154, v162
    v_and_b32 v161, 0x3f803f80, v161
    v_mov_b32 v164, 0xff7fffff
    v_mov_b32 v165, 0xff7fffff
    s_mov_b32 s35, 0
    v_mov_b32 v96, 0
    v_mov_b32 v97, 0
    v_mov_b32 v98, 0
    v_mov_b32 v99, 0
    v_mov_b32 v100, 0
    v_mov_b32 v101, 0
    v_mov_b32 v102, 0
    v_mov_b32 v103, 0
    v_mov_b32 v104, 0
    v_mov_b32 v105, 0
    v_mov_b32 v106, 0
    v_mov_b32 v107, 0
    v_mov_b32 v108, 0
    v_mov_b32 v109, 0
    v_mov_b32 v110, 0
    v_mov_b32 v111, 0
    v_mov_b32 v112, 0
    v_mov_b32 v113, 0
    v_mov_b32 v114, 0
    v_mov_b32 v115, 0
    v_mov_b32 v116, 0
    v_mov_b32 v117, 0
    v_mov_b32 v118, 0
    v_mov_b32 v119, 0
    v_mov_b32 v120, 0
    v_mov_b32 v121, 0
    v_mov_b32 v122, 0
    v_mov_b32 v123, 0
    v_mov_b32 v124, 0
    v_mov_b32 v125, 0
    v_mov_b32 v126, 0
    v_mov_b32 v127, 0
m_attn_slow_loop:
    buffer_load_dwordx4 v[128:131], v152, s[28:31], s32 offen sc1
    buffer_load_dwordx4 v[136:139], v154, s[28:31], s33 offen sc1
    buffer_load_dwordx4 v[140:143], v154, s[28:31], s33 offen offset:512 sc1
    s_add_u32 s32, s32, 1024
    s_add_u32 s33, s33, 1024
    s_waitcnt vmcnt(0)
    v_or_b32 v136, v136, v161
    v_or_b32 v137, v137, v161
    v_or_b32 v138, v138, v161
    v_or_b32 v139, v139, v161
    v_or_b32 v140, v140, v161
    v_or_b32 v141, v141, v161
    v_or_b32 v142, v142, v161
    v_or_b32 v143, v143, v161
    v_mfma_f32_32x32x16_bf16 v[48:63], v[128:131], v[4:7], 0
    v_mfma_f32_32x32x16_bf16 v[64:79], v[128:131], v[8:11], 0
    s_nop 15
    v_max3_f32 v162, v48, v49, v164
    v_max3_f32 v162, v162, v50, v51
    v_max3_f32 v162, v162, v52, v53
    v_max3_f32 v162, v162, v54, v55
    v_max3_f32 v162, v162, v56, v57
    v_max3_f32 v162, v162, v58, v59
    v_max3_f32 v162, v162, v60, v61
    v_max3_f32 v162, v162, v62, v63
    v_mov_b32 v163, v162
    s_nop 1
    v_permlane32_swap_b32 v162, v163
    v_max_f32 v162, v162, v163
    v_sub_f32 v163, v164, v162
    v_exp_f32 v163, v163
    v_mov_b32 v164, v162
    v_mul_f32 v96, v96, v163
    v_mul_f32 v97, v97, v163
    v_mul_f32 v98, v98, v163
    v_mul_f32 v99, v99, v163
    v_mul_f32 v100, v100, v163
    v_mul_f32 v101, v101, v163
    v_mul_f32 v102, v102, v163
    v_mul_f32 v103, v103, v163
    v_mul_f32 v104, v104, v163
    v_mul_f32 v105, v105, v163
    v_mul_f32 v106, v106, v163
    v_mul_f32 v107, v107, v163
    v_mul_f32 v108, v108, v163
    v_mul_f32 v109, v109, v163
    v_mul_f32 v110, v110, v163
    v_mul_f32 v111, v111, v163
    v_sub_f32 v48, v48, v162
    v_sub_f32 v49, v49, v162
    v_sub_f32 v50, v50, v162
    v_sub_f32 v51, v51, v162
    v_sub_f32 v52, v52, v162
    v_sub_f32 v53, v53, v162
    v_sub_f32 v54, v54, v162
    v_sub_f32 v55, v55, v162
    v_sub_f32 v56, v56, v162
    v_sub_f32 v57, v57, v162
    v_sub_f32 v58, v58, v162
    v_sub_f32 v59, v59, v162
    v_sub_f32 v60, v60, v162
    v_sub_f32 v61, v61, v162
    v_sub_f32 v62, v62, v162
    v_sub_f32 v63, v63, v162
    v_exp_f32 v48, v48
    v_exp_f32 v49, v49
    v_exp_f32 v50, v50
    v_exp_f32 v51, v51
    v_exp_f32 v52, v52
    v_exp_f32 v53, v53
    v_exp_f32 v54, v54
    v_exp_f32 v55, v55
    v_exp_f32 v56, v56
    v_exp_f32 v57, v57
    v_exp_f32 v58, v58
    v_exp_f32 v59, v59
    v_exp_f32 v60, v60
    v_exp_f32 v61, v61
    v_exp_f32 v62, v62
    v_exp_f32 v63, v63
    s_nop 0
    v_cvt_pk_bf16_f32 v80, v48, v49
    v_cvt_pk_bf16_f32 v81, v50, v51
    v_cvt_pk_bf16_f32 v82, v52, v53
    v_cvt_pk_bf16_f32 v83, v54, v55
    v_cvt_pk_bf16_f32 v84, v56, v57
    v_cvt_pk_bf16_f32 v85, v58, v59
    v_cvt_pk_bf16_f32 v86, v60, v61
    v_cvt_pk_bf16_f32 v87, v62, v63
    s_nop 1
    v_mfma_f32_32x32x16_bf16 v[96:111], v[136:139], v[80:83], v[96:111]
    v_mfma_f32_32x32x16_bf16 v[96:111], v[140:143], v[84:87], v[96:111]
    v_max3_f32 v162, v64, v65, v165
    v_max3_f32 v162, v162, v66, v67
    v_max3_f32 v162, v162, v68, v69
    v_max3_f32 v162, v162, v70, v71
    v_max3_f32 v162, v162, v72, v73
    v_max3_f32 v162, v162, v74, v75
    v_max3_f32 v162, v162, v76, v77
    v_max3_f32 v162, v162, v78, v79
    v_mov_b32 v163, v162
    s_nop 1
    v_permlane32_swap_b32 v162, v163
    v_max_f32 v162, v162, v163
    v_sub_f32 v163, v165, v162
    v_exp_f32 v163, v163
    v_mov_b32 v165, v162
    v_mul_f32 v112, v112, v163
    v_mul_f32 v113, v113, v163
    v_mul_f32 v114, v114, v163
    v_mul_f32 v115, v115, v163
    v_mul_f32 v116, v116, v163
    v_mul_f32 v117, v117, v163
    v_mul_f32 v118, v118, v163
    v_mul_f32 v119, v119, v163
    v_mul_f32 v120, v120, v163
    v_mul_f32 v121, v121, v163
    v_mul_f32 v122, v122, v163
    v_mul_f32 v123, v123, v163
    v_mul_f32 v124, v124, v163
    v_mul_f32 v125, v125, v163
    v_mul_f32 v126, v126, v163
    v_mul_f32 v127, v127, v163
    v_sub_f32 v64, v64, v162
    v_sub_f32 v65, v65, v162
    v_sub_f32 v66, v66, v162
    v_sub_f32 v67, v67, v162
    v_sub_f32 v68, v68, v162
    v_sub_f32 v69, v69, v162
    v_sub_f32 v70, v70, v162
    v_sub_f32 v71, v71, v162
    v_sub_f32 v72, v72, v162
    v_sub_f32 v73, v73, v162
    v_sub_f32 v74, v74, v162
    v_sub_f32 v75, v75, v162
    v_sub_f32 v76, v76, v162
    v_sub_f32 v77, v77, v162
    v_sub_f32 v78, v78, v162
    v_sub_f32 v79, v79, v162
    v_exp_f32 v64, v64
    v_exp_f32 v65, v65
    v_exp_f32 v66, v66
    v_exp_f32 v67, v67
    v_exp_f32 v68, v68
    v_exp_f32 v69, v69
    v_exp_f32 v70, v70
    v_exp_f32 v71, v71
    v_exp_f32 v72, v72
    v_exp_f32 v73, v73
    v_exp_f32 v74, v74
    v_exp_f32 v75, v75
    v_exp_f32 v76, v76
    v_exp_f32 v77, v77
    v_exp_f32 v78, v78
    v_exp_f32 v79, v79
    s_nop 0
    v_cvt_pk_bf16_f32 v88, v64, v65
    v_cvt_pk_bf16_f32 v89, v66, v67
    v_cvt_pk_bf16_f32 v90, v68, v69
    v_cvt_pk_bf16_f32 v91, v70, v71
    v_cvt_pk_bf16_f32 v92, v72, v73
    v_cvt_pk_bf16_f32 v93, v74, v75
    v_cvt_pk_bf16_f32 v94, v76, v77
    v_cvt_pk_bf16_f32 v95, v78, v79
    s_nop 1
    v_mfma_f32_32x32x16_bf16 v[112:127], v[136:139], v[88:91], v[112:127]
    v_mfma_f32_32x32x16_bf16 v[112:127], v[140:143], v[92:95], v[112:127]
    s_nop 15
    s_add_u32 s35, s35, 1
    s_cmp_lt_u32 s35, 64
    s_cbranch_scc1 m_attn_slow_loop
    s_branch m_attn_fin
m_compute:
    s_setprio 0
    s_and_b32 s13, s12, 1
    s_lshr_b32 s14, s12, 1
    s_lshl_b32 s36, s13, 6
    v_add_u32 v5, s36, v3
    v_bfe_u32 v6, v3, 1, 3
    v_xor_b32 v6, v6, v4
    v_lshlrev_b32 v7, 7, v5
    v_lshl_add_u32 v144, v6, 4, v7
    v_xor_b32 v145, 32, v144
    v_xor_b32 v146, 64, v144
    v_xor_b32 v147, 96, v144
    v_bfe_u32 v6, v2, 2, 2
    v_lshl_add_u32 v6, v4, 3, v6
    v_lshlrev_b32 v6, 7, v6
    v_bfe_u32 v7, v2, 3, 1
    v_xor_b32 v7, s14, v7
    v_lshl_add_u32 v6, v7, 6, v6
    v_bfe_u32 v7, v2, 4, 1
    v_lshl_add_u32 v6, v7, 5, v6
    v_and_b32 v7, 3, v2
    v_lshl_add_u32 v6, v7, 3, v6
    v_add_u32 v148, 65536, v6
    v_lshlrev_b32 v1, 4, v2
    s_mov_b32 s36, 131072
    v_lshl_add_u32 v6, v5, 4, s36
    s_lshl_b32 s36, s14, 9
    s_add_u32 s36, s36, 131072
    v_lshl_add_u32 v7, v3, 4, s36
    s_lshl_b32 s36, s13, 8
    s_add_u32 s36, s36, 131072
    v_lshl_add_u32 v0, v4, 4, s36
    s_lshl_b32 s36, s15, 1
    s_add_u32 s18, s36, s13
    s_mul_i32 s48, s18, 12288
    s_add_u32 s48, s48, 15728640
    s_lshl_b32 s36, s16, 1
    s_add_u32 s36, s36, s14
    s_lshl_b32 s19, s36, 1
    s_add_u32 s19, s19, s17
    s_lshl_b32 s19, s19, 5
    s_add_u32 s19, s19, s18
    s_lshl_b32 s19, s19, 5
    s_add_u32 s19, s19, 25165824
    s_lshl_b32 s36, s36, 17
    s_lshl_b32 s37, s18, 1
    s_lshl_b32 s38, s37, 10
    s_add_u32 s39, s36, s38
    s_mul_i32 s41, s37, 88064
    s_add_u32 s41, s41, 6291456
    s_lshl_b32 s44, s37, 11
    s_add_u32 s44, s44, 12582912
    s_lshl_b32 s52, s74, 1
    s_add_u32 s52, s52, s14
    s_lshl_b32 s53, s73, 1
    s_add_u32 s53, s53, s14
    s_lshl_b32 s18, s18, 5
    s_add_u32 s18, s18, 25231360
    s_waitcnt lgkmcnt(0)
    s_mov_b32 s36, 24444928
    s_load_dword s61, s[10:11], s36
    s_mov_b32 s28, s10
    s_mov_b32 s29, s11
    s_mov_b32 s30, 26214400
    s_mov_b32 s31, 0x20000
    s_waitcnt lgkmcnt(0)
    s_mul_i32 s61, s61, 1664525
    s_add_u32 s61, s61, 1013904223
    s_bfe_u32 s63, s61, 0xc000c
    s_and_b32 s60, s61, 0xfff
    s_cmp_eq_u32 s17, 0
    s_cbranch_scc0 m_ty1
    s_barrier
    ds_read_b128 v[104:107], v144 offset:0
    ds_read_b64_tr_b16 v[112:113], v148 offset:0
    ds_read_b64_tr_b16 v[114:115], v148 offset:512
    ds_read_b128 v[108:111], v144 offset:4096
    ds_read_b64_tr_b16 v[116:117], v148 offset:2048
    ds_read_b64_tr_b16 v[118:119], v148 offset:2560
    ds_read_b128 v[120:123], v145 offset:0
    ds_read_b64_tr_b16 v[128:129], v148 offset:4096
    ds_read_b64_tr_b16 v[130:131], v148 offset:4608
    ds_read_b128 v[124:127], v145 offset:4096
    ds_read_b64_tr_b16 v[132:133], v148 offset:6144
    ds_read_b64_tr_b16 v[134:135], v148 offset:6656
    s_waitcnt lgkmcnt(6)
    v_mfma_f32_32x32x16_bf16 v[8:23], v[112:115], v[104:107], 0
    ds_read_b128 v[88:91], v146 offset:0
    ds_read_b64_tr_b16 v[96:97], v148 offset:8192
    ds_read_b64_tr_b16 v[98:99], v148 offset:8704
    v_mfma_f32_32x32x16_bf16 v[56:71], v[112:115], v[108:111], 0
    ds_read_b128 v[92:95], v146 offset:4096
    ds_read_b64_tr_b16 v[100:101], v148 offset:10240
    ds_read_b64_tr_b16 v[102:103], v148 offset:10752
    v_mfma_f32_32x32x16_bf16 v[24:39], v[116:119], v[104:107], 0
    v_mfma_f32_32x32x16_bf16 v[72:87], v[116:119], v[108:111], 0
    s_waitcnt lgkmcnt(6)
    v_mfma_f32_32x32x16_bf16 v[8:23], v[128:131], v[120:123], v[8:23]
    ds_read_b128 v[104:107], v147 offset:0
    ds_read_b64_tr_b16 v[112:113], v148 offset:12288
    ds_read_b64_tr_b16 v[114:115], v148 offset:12800
    v_mfma_f32_32x32x16_bf16 v[56:71], v[128:131], v[124:127], v[56:71]
    ds_read_b128 v[108:111], v147 offset:4096
    ds_read_b64_tr_b16 v[116:117], v148 offset:14336
    ds_read_b64_tr_b16 v[118:119], v148 offset:14848
    v_mfma_f32_32x32x16_bf16 v[24:39], v[132:135], v[120:123], v[24:39]
    v_mfma_f32_32x32x16_bf16 v[72:87], v[132:135], v[124:127], v[72:87]
    s_waitcnt lgkmcnt(0)
    s_barrier
    v_mfma_f32_32x32x16_bf16 v[8:23], v[96:99], v[88:91], v[8:23]
    ds_read_b128 v[120:123], v144 offset:16384
    ds_read_b64_tr_b16 v[128:129], v148 offset:16384
    ds_read_b64_tr_b16 v[130:131], v148 offset:16896
    v_mfma_f32_32x32x16_bf16 v[56:71], v[96:99], v[92:95], v[56:71]
    ds_read_b128 v[124:127], v144 offset:20480
    ds_read_b64_tr_b16 v[132:133], v148 offset:18432
    ds_read_b64_tr_b16 v[134:135], v148 offset:18944
    v_mfma_f32_32x32x16_bf16 v[24:39], v[100:103], v[88:91], v[24:39]
    v_mfma_f32_32x32x16_bf16 v[72:87], v[100:103], v[92:95], v[72:87]
    v_mfma_f32_32x32x16_bf16 v[8:23], v[112:115], v[104:107], v[8:23]
    ds_read_b128 v[88:91], v145 offset:16384
    ds_read_b64_tr_b16 v[96:97], v148 offset:20480
    ds_read_b64_tr_b16 v[98:99], v148 offset:20992
    v_mfma_f32_32x32x16_bf16 v[56:71], v[112:115], v[108:111], v[56:71]
    ds_read_b128 v[92:95], v145 offset:20480
    ds_read_b64_tr_b16 v[100:101], v148 offset:22528
    ds_read_b64_tr_b16 v[102:103], v148 offset:23040
    v_mfma_f32_32x32x16_bf16 v[24:39], v[116:119], v[104:107], v[24:39]
    v_mfma_f32_32x32x16_bf16 v[72:87], v[116:119], v[108:111], v[72:87]
    s_waitcnt lgkmcnt(6)
    v_mfma_f32_32x32x16_bf16 v[8:23], v[128:131], v[120:123], v[8:23]
    ds_read_b128 v[104:107], v146 offset:16384
    ds_read_b64_tr_b16 v[112:113], v148 offset:24576
    ds_read_b64_tr_b16 v[114:115], v148 offset:25088
    v_mfma_f32_32x32x16_bf16 v[56:71], v[128:131], v[124:127], v[56:71]
    ds_read_b128 v[108:111], v146 offset:20480
    ds_read_b64_tr_b16 v[116:117], v148 offset:26624
    ds_read_b64_tr_b16 v[118:119], v148 offset:27136
    v_mfma_f32_32x32x16_bf16 v[24:39], v[132:135], v[120:123], v[24:39]
    v_mfma_f32_32x32x16_bf16 v[72:87], v[132:135], v[124:127], v[72:87]
    s_waitcnt lgkmcnt(6)
    v_mfma_f32_32x32x16_bf16 v[8:23], v[96:99], v[88:91], v[8:23]
    ds_read_b128 v[120:123], v147 offset:16384
    ds_read_b64_tr_b16 v[128:129], v148 offset:28672
    ds_read_b64_tr_b16 v[130:131], v148 offset:29184
    v_mfma_f32_32x32x16_bf16 v[56:71], v[96:99], v[92:95], v[56:71]
    ds_read_b128 v[124:127], v147 offset:20480
    ds_read_b64_tr_b16 v[132:133], v148 offset:30720
    ds_read_b64_tr_b16 v[134:135], v148 offset:31232
    v_mfma_f32_32x32x16_bf16 v[24:39], v[100:103], v[88:91], v[24:39]
    v_mfma_f32_32x32x16_bf16 v[72:87], v[100:103], v[92:95], v[72:87]
    s_waitcnt lgkmcnt(0)
    s_barrier
    v_mfma_f32_32x32x16_bf16 v[8:23], v[112:115], v[104:107], v[8:23]
    ds_read_b128 v[88:91], v144 offset:32768
    ds_read_b64_tr_b16 v[96:97], v148 offset:32768
    ds_read_b64_tr_b16 v[98:99], v148 offset:33280
    v_mfma_f32_32x32x16_bf16 v[56:71], v[112:115], v[108:111], v[56:71]
    ds_read_b128 v[92:95], v144 offset:36864
    ds_read_b64_tr_b16 v[100:101], v148 offset:34816
    ds_read_b64_tr_b16 v[102:103], v148 offset:35328
    v_mfma_f32_32x32x16_bf16 v[24:39], v[116:119], v[104:107], v[24:39]
    v_mfma_f32_32x32x16_bf16 v[72:87], v[116:119], v[108:111], v[72:87]
    v_mfma_f32_32x32x16_bf16 v[8:23], v[128:131], v[120:123], v[8:23]
    ds_read_b128 v[104:107], v145 offset:32768
    ds_read_b64_tr_b16 v[112:113], v148 offset:36864
    ds_read_b64_tr_b16 v[114:115], v148 offset:37376
    v_mfma_f32_32x32x16_bf16 v[56:71], v[128:131], v[124:127], v[56:71]
    ds_read_b128 v[108:111], v145 offset:36864
    ds_read_b64_tr_b16 v[116:117], v148 offset:38912
    ds_read_b64_tr_b16 v[118:119], v148 offset:39424
    v_mfma_f32_32x32x16_bf16 v[24:39], v[132:135], v[120:123], v[24:39]
    v_mfma_f32_32x32x16_bf16 v[72:87], v[132:135], v[124:127], v[72:87]
    s_waitcnt lgkmcnt(6)
    v_mfma_f32_32x32x16_bf16 v[8:23], v[96:99], v[88:91], v[8:23]
    ds_read_b128 v[120:123], v146 offset:32768
    ds_read_b64_tr_b16 v[128:129], v148 offset:40960
    ds_read_b64_tr_b16 v[130:131], v148 offset:41472
    v_mfma_f32_32x32x16_bf16 v[56:71], v[96:99], v[92:95], v[56:71]
    ds_read_b128 v[124:127], v146 offset:36864
    ds_read_b64_tr_b16 v[132:133], v148 offset:43008
    ds_read_b64_tr_b16 v[134:135], v148 offset:43520
    v_mfma_f32_32x32x16_bf16 v[24:39], v[100:103], v[88:91], v[24:39]
    v_mfma_f32_32x32x16_bf16 v[72:87], v[100:103], v[92:95], v[72:87]
    s_waitcnt lgkmcnt(6)
    v_mfma_f32_32x32x16_bf16 v[8:23], v[112:115], v[104:107], v[8:23]
    ds_read_b128 v[88:91], v147 offset:32768
    ds_read_b64_tr_b16 v[96:97], v148 offset:45056
    ds_read_b64_tr_b16 v[98:99], v148 offset:45568
    v_mfma_f32_32x32x16_bf16 v[56:71], v[112:115], v[108:111], v[56:71]
    ds_read_b128 v[92:95], v147 offset:36864
    ds_read_b64_tr_b16 v[100:101], v148 offset:47104
    ds_read_b64_tr_b16 v[102:103], v148 offset:47616
    v_mfma_f32_32x32x16_bf16 v[24:39], v[116:119], v[104:107], v[24:39]
    v_mfma_f32_32x32x16_bf16 v[72:87], v[116:119], v[108:111], v[72:87]
    s_waitcnt lgkmcnt(0)
    s_barrier
    v_mfma_f32_32x32x16_bf16 v[8:23], v[128:131], v[120:123], v[8:23]
    ds_read_b128 v[104:107], v144 offset:49152
    ds_read_b64_tr_b16 v[112:113], v148 offset:49152
    ds_read_b64_tr_b16 v[114:115], v148 offset:49664
    v_mfma_f32_32x32x16_bf16 v[56:71], v[128:131], v[124:127], v[56:71]
    ds_read_b128 v[108:111], v144 offset:53248
    ds_read_b64_tr_b16 v[116:117], v148 offset:51200
    ds_read_b64_tr_b16 v[118:119], v148 offset:51712
    v_mfma_f32_32x32x16_bf16 v[24:39], v[132:135], v[120:123], v[24:39]
    v_mfma_f32_32x32x16_bf16 v[72:87], v[132:135], v[124:127], v[72:87]
    v_mfma_f32_32x32x16_bf16 v[8:23], v[96:99], v[88:91], v[8:23]
    ds_read_b128 v[120:123], v145 offset:49152
    ds_read_b64_tr_b16 v[128:129], v148 offset:53248
    ds_read_b64_tr_b16 v[130:131], v148 offset:53760
    v_mfma_f32_32x32x16_bf16 v[56:71], v[96:99], v[92:95], v[56:71]
    ds_read_b128 v[124:127], v145 offset:53248
    ds_read_b64_tr_b16 v[132:133], v148 offset:55296
    ds_read_b64_tr_b16 v[134:135], v148 offset:55808
    v_mfma_f32_32x32x16_bf16 v[24:39], v[100:103], v[88:91], v[24:39]
    v_mfma_f32_32x32x16_bf16 v[72:87], v[100:103], v[92:95], v[72:87]
    s_waitcnt lgkmcnt(6)
    v_mfma_f32_32x32x16_bf16 v[8:23], v[112:115], v[104:107], v[8:23]
    ds_read_b128 v[88:91], v146 offset:49152
    ds_read_b64_tr_b16 v[96:97], v148 offset:57344
    ds_read_b64_tr_b16 v[98:99], v148 offset:57856
    v_mfma_f32_32x32x16_bf16 v[56:71], v[112:115], v[108:111], v[56:71]
    ds_read_b128 v[92:95], v146 offset:53248
    ds_read_b64_tr_b16 v[100:101], v148 offset:59392
    ds_read_b64_tr_b16 v[102:103], v148 offset:59904
    v_mfma_f32_32x32x16_bf16 v[24:39], v[116:119], v[104:107], v[24:39]
    v_mfma_f32_32x32x16_bf16 v[72:87], v[116:119], v[108:111], v[72:87]
    s_waitcnt lgkmcnt(6)
    v_mfma_f32_32x32x16_bf16 v[8:23], v[128:131], v[120:123], v[8:23]
    ds_read_b128 v[104:107], v147 offset:49152
    ds_read_b64_tr_b16 v[112:113], v148 offset:61440
    ds_read_b64_tr_b16 v[114:115], v148 offset:61952
    v_mfma_f32_32x32x16_bf16 v[56:71], v[128:131], v[124:127], v[56:71]
    ds_read_b128 v[108:111], v147 offset:53248
    ds_read_b64_tr_b16 v[116:117], v148 offset:63488
    ds_read_b64_tr_b16 v[118:119], v148 offset:64000
    v_mfma_f32_32x32x16_bf16 v[24:39], v[132:135], v[120:123], v[24:39]
    v_mfma_f32_32x32x16_bf16 v[72:87], v[132:135], v[124:127], v[72:87]
    s_waitcnt lgkmcnt(0)
    s_barrier
    v_mfma_f32_32x32x16_bf16 v[8:23], v[96:99], v[88:91], v[8:23]
    ds_read_b128 v[120:123], v144 offset:0
    ds_read_b64_tr_b16 v[128:129], v148 offset:0
    ds_read_b64_tr_b16 v[130:131], v148 offset:512
    v_mfma_f32_32x32x16_bf16 v[56:71], v[96:99], v[92:95], v[56:71]
    ds_read_b128 v[124:127], v144 offset:4096
    ds_read_b64_tr_b16 v[132:133], v148 offset:2048
    ds_read_b64_tr_b16 v[134:135], v148 offset:2560
    v_mfma_f32_32x32x16_bf16 v[24:39], v[100:103], v[88:91], v[24:39]
    v_mfma_f32_32x32x16_bf16 v[72:87], v[100:103], v[92:95], v[72:87]
    v_mfma_f32_32x32x16_bf16 v[8:23], v[112:115], v[104:107], v[8:23]
    ds_read_b128 v[88:91], v145 offset:0
    ds_read_b64_tr_b16 v[96:97], v148 offset:4096
    ds_read_b64_tr_b16 v[98:99], v148 offset:4608
    v_mfma_f32_32x32x16_bf16 v[56:71], v[112:115], v[108:111], v[56:71]
    ds_read_b128 v[92:95], v145 offset:4096
    ds_read_b64_tr_b16 v[100:101], v148 offset:6144
    ds_read_b64_tr_b16 v[102:103], v148 offset:6656
    v_mfma_f32_32x32x16_bf16 v[24:39], v[116:119], v[104:107], v[24:39]
    v_mfma_f32_32x32x16_bf16 v[72:87], v[116:119], v[108:111], v[72:87]
    s_waitcnt lgkmcnt(6)
    v_mfma_f32_32x32x16_bf16 v[8:23], v[128:131], v[120:123], v[8:23]
    ds_read_b128 v[104:107], v146 offset:0
    ds_read_b64_tr_b16 v[112:113], v148 offset:8192
    ds_read_b64_tr_b16 v[114:115], v148 offset:8704
    v_mfma_f32_32x32x16_bf16 v[56:71], v[128:131], v[124:127], v[56:71]
    ds_read_b128 v[108:111], v146 offset:4096
    ds_read_b64_tr_b16 v[116:117], v148 offset:10240
    ds_read_b64_tr_b16 v[118:119], v148 offset:10752
    v_mfma_f32_32x32x16_bf16 v[24:39], v[132:135], v[120:123], v[24:39]
    v_mfma_f32_32x32x16_bf16 v[72:87], v[132:135], v[124:127], v[72:87]
    s_waitcnt lgkmcnt(6)
    v_mfma_f32_32x32x16_bf16 v[8:23], v[96:99], v[88:91], v[8:23]
    ds_read_b128 v[120:123], v147 offset:0
    ds_read_b64_tr_b16 v[128:129], v148 offset:12288
    ds_read_b64_tr_b16 v[130:131], v148 offset:12800
    v_mfma_f32_32x32x16_bf16 v[56:71], v[96:99], v[92:95], v[56:71]
    ds_read_b128 v[124:127], v147 offset:4096
    ds_read_b64_tr_b16 v[132:133], v148 offset:14336
    ds_read_b64_tr_b16 v[134:135], v148 offset:14848
    v_mfma_f32_32x32x16_bf16 v[24:39], v[100:103], v[88:91], v[24:39]
    v_mfma_f32_32x32x16_bf16 v[72:87], v[100:103], v[92:95], v[72:87]
    s_waitcnt lgkmcnt(0)
    s_barrier
    v_mfma_f32_32x32x16_bf16 v[8:23], v[112:115], v[104:107], v[8:23]
    ds_read_b128 v[88:91], v144 offset:16384
    ds_read_b64_tr_b16 v[96:97], v148 offset:16384
    ds_read_b64_tr_b16 v[98:99], v148 offset:16896
    v_mfma_f32_32x32x16_bf16 v[56:71], v[112:115], v[108:111], v[56:71]
    ds_read_b128 v[92:95], v144 offset:20480
    ds_read_b64_tr_b16 v[100:101], v148 offset:18432
    ds_read_b64_tr_b16 v[102:103], v148 offset:18944
    v_mfma_f32_32x32x16_bf16 v[24:39], v[116:119], v[104:107], v[24:39]
    v_mfma_f32_32x32x16_bf16 v[72:87], v[116:119], v[108:111], v[72:87]
    v_mfma_f32_32x32x16_bf16 v[8:23], v[128:131], v[120:123], v[8:23]
    ds_read_b128 v[104:107], v145 offset:16384
    ds_read_b64_tr_b16 v[112:113], v148 offset:20480
    ds_read_b64_tr_b16 v[114:115], v148 offset:20992
    v_mfma_f32_32x32x16_bf16 v[56:71], v[128:131], v[124:127], v[56:71]
    ds_read_b128 v[108:111], v145 offset:20480
    ds_read_b64_tr_b16 v[116:117], v148 offset:22528
    ds_read_b64_tr_b16 v[118:119], v148 offset:23040
    v_mfma_f32_32x32x16_bf16 v[24:39], v[132:135], v[120:123], v[24:39]
    v_mfma_f32_32x32x16_bf16 v[72:87], v[132:135], v[124:127], v[72:87]
    s_waitcnt lgkmcnt(6)
    v_mfma_f32_32x32x16_bf16 v[8:23], v[96:99], v[88:91], v[8:23]
    ds_read_b128 v[120:123], v146 offset:16384
    ds_read_b64_tr_b16 v[128:129], v148 offset:24576
    ds_read_b64_tr_b16 v[130:131], v148 offset:25088
    v_mfma_f32_32x32x16_bf16 v[56:71], v[96:99], v[92:95], v[56:71]
    ds_read_b128 v[124:127], v146 offset:20480
    ds_read_b64_tr_b16 v[132:133], v148 offset:26624
    ds_read_b64_tr_b16 v[134:135], v148 offset:27136
    v_mfma_f32_32x32x16_bf16 v[24:39], v[100:103], v[88:91], v[24:39]
    v_mfma_f32_32x32x16_bf16 v[72:87], v[100:103], v[92:95], v[72:87]
    s_waitcnt lgkmcnt(6)
    v_mfma_f32_32x32x16_bf16 v[8:23], v[112:115], v[104:107], v[8:23]
    ds_read_b128 v[88:91], v147 offset:16384
    ds_read_b64_tr_b16 v[96:97], v148 offset:28672
    ds_read_b64_tr_b16 v[98:99], v148 offset:29184
    v_mfma_f32_32x32x16_bf16 v[56:71], v[112:115], v[108:111], v[56:71]
    ds_read_b128 v[92:95], v147 offset:20480
    ds_read_b64_tr_b16 v[100:101], v148 offset:30720
    ds_read_b64_tr_b16 v[102:103], v148 offset:31232
    v_mfma_f32_32x32x16_bf16 v[24:39], v[116:119], v[104:107], v[24:39]
    v_mfma_f32_32x32x16_bf16 v[72:87], v[116:119], v[108:111], v[72:87]
    s_waitcnt lgkmcnt(0)
    s_barrier
    v_mfma_f32_32x32x16_bf16 v[8:23], v[128:131], v[120:123], v[8:23]
    ds_read_b128 v[104:107], v144 offset:32768
    ds_read_b64_tr_b16 v[112:113], v148 offset:32768
    ds_read_b64_tr_b16 v[114:115], v148 offset:33280
    v_mfma_f32_32x32x16_bf16 v[56:71], v[128:131], v[124:127], v[56:71]
    ds_read_b128 v[108:111], v144 offset:36864
    ds_read_b64_tr_b16 v[116:117], v148 offset:34816
    ds_read_b64_tr_b16 v[118:119], v148 offset:35328
    v_mfma_f32_32x32x16_bf16 v[24:39], v[132:135], v[120:123], v[24:39]
    v_mfma_f32_32x32x16_bf16 v[72:87], v[132:135], v[124:127], v[72:87]
    v_mfma_f32_32x32x16_bf16 v[8:23], v[96:99], v[88:91], v[8:23]
    ds_read_b128 v[120:123], v145 offset:32768
    ds_read_b64_tr_b16 v[128:129], v148 offset:36864
    ds_read_b64_tr_b16 v[130:131], v148 offset:37376
    v_mfma_f32_32x32x16_bf16 v[56:71], v[96:99], v[92:95], v[56:71]
    ds_read_b128 v[124:127], v145 offset:36864
    ds_read_b64_tr_b16 v[132:133], v148 offset:38912
    ds_read_b64_tr_b16 v[134:135], v148 offset:39424
    v_mfma_f32_32x32x16_bf16 v[24:39], v[100:103], v[88:91], v[24:39]
    v_mfma_f32_32x32x16_bf16 v[72:87], v[100:103], v[92:95], v[72:87]
    s_waitcnt lgkmcnt(6)
    v_mfma_f32_32x32x16_bf16 v[8:23], v[112:115], v[104:107], v[8:23]
    ds_read_b128 v[88:91], v146 offset:32768
    ds_read_b64_tr_b16 v[96:97], v148 offset:40960
    ds_read_b64_tr_b16 v[98:99], v148 offset:41472
    v_mfma_f32_32x32x16_bf16 v[56:71], v[112:115], v[108:111], v[56:71]
    ds_read_b128 v[92:95], v146 offset:36864
    ds_read_b64_tr_b16 v[100:101], v148 offset:43008
    ds_read_b64_tr_b16 v[102:103], v148 offset:43520
    v_mfma_f32_32x32x16_bf16 v[24:39], v[116:119], v[104:107], v[24:39]
    v_mfma_f32_32x32x16_bf16 v[72:87], v[116:119], v[108:111], v[72:87]
    s_waitcnt lgkmcnt(6)
    v_mfma_f32_32x32x16_bf16 v[8:23], v[128:131], v[120:123], v[8:23]
    ds_read_b128 v[104:107], v147 offset:32768
    ds_read_b64_tr_b16 v[112:113], v148 offset:45056
    ds_read_b64_tr_b16 v[114:115], v148 offset:45568
    v_mfma_f32_32x32x16_bf16 v[56:71], v[128:131], v[124:127], v[56:71]
    ds_read_b128 v[108:111], v147 offset:36864
    ds_read_b64_tr_b16 v[116:117], v148 offset:47104
    ds_read_b64_tr_b16 v[118:119], v148 offset:47616
    v_mfma_f32_32x32x16_bf16 v[24:39], v[132:135], v[120:123], v[24:39]
    v_mfma_f32_32x32x16_bf16 v[72:87], v[132:135], v[124:127], v[72:87]
    s_waitcnt lgkmcnt(0)
    s_barrier
    v_mfma_f32_32x32x16_bf16 v[8:23], v[96:99], v[88:91], v[8:23]
    ds_read_b128 v[120:123], v144 offset:49152
    ds_read_b64_tr_b16 v[128:129], v148 offset:49152
    ds_read_b64_tr_b16 v[130:131], v148 offset:49664
    v_mfma_f32_32x32x16_bf16 v[56:71], v[96:99], v[92:95], v[56:71]
    ds_read_b128 v[124:127], v144 offset:53248
    ds_read_b64_tr_b16 v[132:133], v148 offset:51200
    ds_read_b64_tr_b16 v[134:135], v148 offset:51712
    v_mfma_f32_32x32x16_bf16 v[24:39], v[100:103], v[88:91], v[24:39]
    v_mfma_f32_32x32x16_bf16 v[72:87], v[100:103], v[92:95], v[72:87]
    v_mfma_f32_32x32x16_bf16 v[8:23], v[112:115], v[104:107], v[8:23]
    ds_read_b128 v[88:91], v145 offset:49152
    ds_read_b64_tr_b16 v[96:97], v148 offset:53248
    ds_read_b64_tr_b16 v[98:99], v148 offset:53760
    v_mfma_f32_32x32x16_bf16 v[56:71], v[112:115], v[108:111], v[56:71]
    ds_read_b128 v[92:95], v145 offset:53248
    ds_read_b64_tr_b16 v[100:101], v148 offset:55296
    ds_read_b64_tr_b16 v[102:103], v148 offset:55808
    v_mfma_f32_32x32x16_bf16 v[24:39], v[116:119], v[104:107], v[24:39]
    v_mfma_f32_32x32x16_bf16 v[72:87], v[116:119], v[108:111], v[72:87]
    s_waitcnt lgkmcnt(6)
    v_mfma_f32_32x32x16_bf16 v[8:23], v[128:131], v[120:123], v[8:23]
    ds_read_b128 v[104:107], v146 offset:49152
    ds_read_b64_tr_b16 v[112:113], v148 offset:57344
    ds_read_b64_tr_b16 v[114:115], v148 offset:57856
    v_mfma_f32_32x32x16_bf16 v[56:71], v[128:131], v[124:127], v[56:71]
    ds_read_b128 v[108:111], v146 offset:53248
    ds_read_b64_tr_b16 v[116:117], v148 offset:59392
    ds_read_b64_tr_b16 v[118:119], v148 offset:59904
    v_mfma_f32_32x32x16_bf16 v[24:39], v[132:135], v[120:123], v[24:39]
    ds_read_b64 v[152:153], v7 offset:2048
    ds_read_b128 v[160:163], v6 offset:0
    ds_read_b128 v[164:167], v6 offset:512
    v_mfma_f32_32x32x16_bf16 v[72:87], v[132:135], v[124:127], v[72:87]
    s_waitcnt lgkmcnt(9)
    v_mfma_f32_32x32x16_bf16 v[8:23], v[96:99], v[88:91], v[8:23]
    ds_read_b128 v[120:123], v147 offset:49152
    ds_read_b64_tr_b16 v[128:129], v148 offset:61440
    ds_read_b64_tr_b16 v[130:131], v148 offset:61952
    v_mfma_f32_32x32x16_bf16 v[56:71], v[96:99], v[92:95], v[56:71]
    ds_read_b128 v[124:127], v147 offset:53248
    ds_read_b64_tr_b16 v[132:133], v148 offset:63488
    ds_read_b64_tr_b16 v[134:135], v148 offset:64000
    v_mfma_f32_32x32x16_bf16 v[24:39], v[100:103], v[88:91], v[24:39]
    v_mfma_f32_32x32x16_bf16 v[72:87], v[100:103], v[92:95], v[72:87]
    s_waitcnt lgkmcnt(0)
    s_barrier
    v_mfma_f32_32x32x16_bf16 v[8:23], v[112:115], v[104:107], v[8:23]
    v_cvt_pk_bf16_f32 v154, v152, v152
    v_mov_b32 v42, 0
    v_and_b32 v154, 0xffff0000, v154
    v_sub_f32 v154, v152, v154
    v_cvt_pk_bf16_f32 v40, v152, v154
    v_mfma_f32_32x32x16_bf16 v[56:71], v[112:115], v[108:111], v[56:71]
    v_mov_b32 v43, 0
    v_mov_b32 v41, v40
    v_cvt_pk_bf16_f32 v154, v153, v153
    v_mov_b32 v46, 0
    v_and_b32 v154, 0xffff0000, v154
    v_sub_f32 v154, v153, v154
    v_mfma_f32_32x32x16_bf16 v[24:39], v[116:119], v[104:107], v[24:39]
    v_cvt_pk_bf16_f32 v44, v153, v154
    v_mov_b32 v47, 0
    v_mov_b32 v45, v44
    v_mov_b32 v48, v160
    v_mov_b32 v49, v161
    v_mfma_f32_32x32x16_bf16 v[72:87], v[116:119], v[108:111], v[72:87]
    v_mov_b32 v50, 0
    v_mov_b32 v51, 0
    v_mov_b32 v52, v164
    v_mov_b32 v53, v165
    v_mov_b32 v54, 0
    v_mov_b32 v55, 0
    v_mfma_f32_32x32x16_bf16 v[8:23], v[128:131], v[120:123], v[8:23]
    ds_read_b128 v[104:107], v144 offset:0
    ds_read_b64_tr_b16 v[112:113], v148 offset:0
    ds_read_b64_tr_b16 v[114:115], v148 offset:512
    v_mfma_f32_32x32x16_bf16 v[56:71], v[128:131], v[124:127], v[56:71]
    ds_read_b128 v[108:111], v144 offset:4096
    v_mul_f32 v150, 0x3eb8aa3b, v162
    v_mfma_f32_32x32x16_bf16 v[24:39], v[132:135], v[120:123], v[24:39]
    v_mul_f32 v151, 0x3eb8aa3b, v166
    v_mfma_f32_32x32x16_bf16 v[72:87], v[132:135], v[124:127], v[72:87]
    v_mov_b32 v156, s61
    v_mfma_f32_32x32x16_bf16 v[8:23], v[40:43], v[48:51], v[8:23]
    v_mfma_f32_32x32x16_bf16 v[56:71], v[40:43], v[52:55], v[56:71]
    v_mfma_f32_32x32x16_bf16 v[24:39], v[44:47], v[48:51], v[24:39]
    v_mfma_f32_32x32x16_bf16 v[72:87], v[44:47], v[52:55], v[72:87]
    ds_read_b128 v[120:123], v145 offset:0
    ds_read_b64_tr_b16 v[128:129], v148 offset:4096
    ds_read_b64_tr_b16 v[130:131], v148 offset:4608
    ds_read_b128 v[124:127], v145 offset:4096
    s_add_u32 s36, s39, 0
    s_add_u32 s37, s39, 65536
    s_add_u32 s38, s39, 2097152
    s_add_u32 s39, s39, 2162688
    s_nop 4
    v_pk_mul_f32 v[8:9], v[8:9], v[150:151] op_sel_hi:[1,0]
    v_pk_mul_f32 v[10:11], v[10:11], v[150:151] op_sel_hi:[1,0]
    v_pk_mul_f32 v[12:13], v[12:13], v[150:151] op_sel_hi:[1,0]
    v_pk_mul_f32 v[14:15], v[14:15], v[150:151] op_sel_hi:[1,0]
    v_cvt_pk_bf16_f32 v8, v8, v9
    v_cvt_pk_bf16_f32 v9, v10, v11
    v_cvt_pk_bf16_f32 v10, v12, v13
    v_cvt_pk_bf16_f32 v11, v14, v15
    buffer_store_dwordx4 v[8:11], v1, s[28:31], s36 offen offset:0 sc1
    v_pk_mul_f32 v[16:17], v[16:17], v[150:151] op_sel_hi:[1,0]
    v_pk_mul_f32 v[18:19], v[18:19], v[150:151] op_sel_hi:[1,0]
    v_pk_mul_f32 v[20:21], v[20:21], v[150:151] op_sel_hi:[1,0]
    v_pk_mul_f32 v[22:23], v[22:23], v[150:151] op_sel_hi:[1,0]
    v_cvt_pk_bf16_f32 v16, v16, v17
    v_cvt_pk_bf16_f32 v17, v18, v19
    v_cvt_pk_bf16_f32 v18, v20, v21
    v_cvt_pk_bf16_f32 v19, v22, v23
    buffer_store_dwordx4 v[16:19], v1, s[28:31], s37 offen offset:0 sc1
    v_pk_mul_f32 v[56:57], v[56:57], v[150:151] op_sel:[0,1] op_sel_hi:[1,1]
    v_pk_mul_f32 v[58:59], v[58:59], v[150:151] op_sel:[0,1] op_sel_hi:[1,1]
    v_pk_mul_f32 v[60:61], v[60:61], v[150:151] op_sel:[0,1] op_sel_hi:[1,1]
    v_pk_mul_f32 v[62:63], v[62:63], v[150:151] op_sel:[0,1] op_sel_hi:[1,1]
    v_cvt_pk_bf16_f32 v56, v56, v57
    v_cvt_pk_bf16_f32 v57, v58, v59
    v_cvt_pk_bf16_f32 v58, v60, v61
    v_cvt_pk_bf16_f32 v59, v62, v63
    buffer_store_dwordx4 v[56:59], v1, s[28:31], s36 offen offset:1024 sc1
    v_pk_mul_f32 v[64:65], v[64:65], v[150:151] op_sel:[0,1] op_sel_hi:[1,1]
    v_pk_mul_f32 v[66:67], v[66:67], v[150:151] op_sel:[0,1] op_sel_hi:[1,1]
    v_pk_mul_f32 v[68:69], v[68:69], v[150:151] op_sel:[0,1] op_sel_hi:[1,1]
    v_pk_mul_f32 v[70:71], v[70:71], v[150:151] op_sel:[0,1] op_sel_hi:[1,1]
    v_cvt_pk_bf16_f32 v64, v64, v65
    v_cvt_pk_bf16_f32 v65, v66, v67
    v_cvt_pk_bf16_f32 v66, v68, v69
    v_cvt_pk_bf16_f32 v67, v70, v71
    buffer_store_dwordx4 v[64:67], v1, s[28:31], s37 offen offset:1024 sc1
    v_pk_mul_f32 v[24:25], v[24:25], v[162:163] op_sel_hi:[1,0]
    v_pk_mul_f32 v[26:27], v[26:27], v[162:163] op_sel_hi:[1,0]
    v_pk_mul_f32 v[28:29], v[28:29], v[162:163] op_sel_hi:[1,0]
    v_pk_mul_f32 v[30:31], v[30:31], v[162:163] op_sel_hi:[1,0]
    v_cvt_pk_bf16_f32 v24, v24, v25
    v_cvt_pk_bf16_f32 v25, v26, v27
    v_cvt_pk_bf16_f32 v26, v28, v29
    v_cvt_pk_bf16_f32 v27, v30, v31
    buffer_store_dwordx4 v[24:27], v1, s[28:31], s38 offen offset:0 sc1
    v_pk_mul_f32 v[32:33], v[32:33], v[162:163] op_sel_hi:[1,0]
    v_pk_mul_f32 v[34:35], v[34:35], v[162:163] op_sel_hi:[1,0]
    v_pk_mul_f32 v[36:37], v[36:37], v[162:163] op_sel_hi:[1,0]
    v_pk_mul_f32 v[38:39], v[38:39], v[162:163] op_sel_hi:[1,0]
    v_cvt_pk_bf16_f32 v32, v32, v33
    v_cvt_pk_bf16_f32 v33, v34, v35
    v_cvt_pk_bf16_f32 v34, v36, v37
    v_cvt_pk_bf16_f32 v35, v38, v39
    buffer_store_dwordx4 v[32:35], v1, s[28:31], s39 offen offset:0 sc1
    v_pk_mul_f32 v[72:73], v[72:73], v[166:167] op_sel_hi:[1,0]
    v_pk_mul_f32 v[74:75], v[74:75], v[166:167] op_sel_hi:[1,0]
    v_pk_mul_f32 v[76:77], v[76:77], v[166:167] op_sel_hi:[1,0]
    v_pk_mul_f32 v[78:79], v[78:79], v[166:167] op_sel_hi:[1,0]
    v_cvt_pk_bf16_f32 v72, v72, v73
    v_cvt_pk_bf16_f32 v73, v74, v75
    v_cvt_pk_bf16_f32 v74, v76, v77
    v_cvt_pk_bf16_f32 v75, v78, v79
    buffer_store_dwordx4 v[72:75], v1, s[28:31], s38 offen offset:1024 sc1
    v_pk_mul_f32 v[80:81], v[80:81], v[166:167] op_sel_hi:[1,0]
    v_pk_mul_f32 v[82:83], v[82:83], v[166:167] op_sel_hi:[1,0]
    v_pk_mul_f32 v[84:85], v[84:85], v[166:167] op_sel_hi:[1,0]
    v_pk_mul_f32 v[86:87], v[86:87], v[166:167] op_sel_hi:[1,0]
    v_cvt_pk_bf16_f32 v80, v80, v81
    v_cvt_pk_bf16_f32 v81, v82, v83
    v_cvt_pk_bf16_f32 v82, v84, v85
    v_cvt_pk_bf16_f32 v83, v86, v87
    buffer_store_dwordx4 v[80:83], v1, s[28:31], s39 offen offset:1024 sc1
    s_waitcnt lgkmcnt(4)
    v_mfma_f32_32x32x16_bf16 v[40:55], v[112:115], v[104:107], 0
    ds_read_b128 v[8:11], v146 offset:0
    ds_read_b64_tr_b16 v[16:17], v148 offset:8192
    ds_read_b64_tr_b16 v[18:19], v148 offset:8704
    ds_read_b128 v[12:15], v146 offset:4096
    v_mfma_f32_32x32x16_bf16 v[88:103], v[112:115], v[108:111], 0
    s_waitcnt lgkmcnt(4)
    v_mfma_f32_32x32x16_bf16 v[40:55], v[128:131], v[120:123], v[40:55]
    ds_read_b128 v[104:107], v147 offset:0
    ds_read_b64_tr_b16 v[112:113], v148 offset:12288
    ds_read_b64_tr_b16 v[114:115], v148 offset:12800
    ds_read_b128 v[108:111], v147 offset:4096
    v_mfma_f32_32x32x16_bf16 v[88:103], v[128:131], v[124:127], v[88:103]
    s_waitcnt lgkmcnt(4)
    v_mfma_f32_32x32x16_bf16 v[40:55], v[16:19], v[8:11], v[40:55]
    ds_read_b128 v[120:123], v144 offset:16384
    ds_read_b64_tr_b16 v[128:129], v148 offset:16384
    ds_read_b64_tr_b16 v[130:131], v148 offset:16896
    ds_read_b128 v[124:127], v144 offset:20480
    v_mfma_f32_32x32x16_bf16 v[88:103], v[16:19], v[12:15], v[88:103]
    s_waitcnt lgkmcnt(4)
    v_mfma_f32_32x32x16_bf16 v[40:55], v[112:115], v[104:107], v[40:55]
    ds_read_b128 v[8:11], v145 offset:16384
    ds_read_b64_tr_b16 v[16:17], v148 offset:20480
    ds_read_b64_tr_b16 v[18:19], v148 offset:20992
    ds_read_b128 v[12:15], v145 offset:20480
    v_mfma_f32_32x32x16_bf16 v[88:103], v[112:115], v[108:111], v[88:103]
    s_waitcnt lgkmcnt(4)
    v_mfma_f32_32x32x16_bf16 v[40:55], v[128:131], v[120:123], v[40:55]
    ds_read_b128 v[104:107], v146 offset:16384
    ds_read_b64_tr_b16 v[112:113], v148 offset:24576
    ds_read_b64_tr_b16 v[114:115], v148 offset:25088
    ds_read_b128 v[108:111], v146 offset:20480
    s_waitcnt vmcnt(0)
    v_mfma_f32_32x32x16_bf16 v[88:103], v[128:131], v[124:127], v[88:103]
    buffer_store_dword v156, off, s[28:31], s19 sc1
    s_waitcnt lgkmcnt(4)
    v_mfma_f32_32x32x16_bf16 v[40:55], v[16:19], v[8:11], v[40:55]
    ds_read_b128 v[120:123], v147 offset:16384
    ds_read_b64_tr_b16 v[128:129], v148 offset:28672
    ds_read_b64_tr_b16 v[130:131], v148 offset:29184
    ds_read_b128 v[124:127], v147 offset:20480
    v_mfma_f32_32x32x16_bf16 v[88:103], v[16:19], v[12:15], v[88:103]
    s_waitcnt lgkmcnt(0)
    s_barrier
    v_mfma_f32_32x32x16_bf16 v[40:55], v[112:115], v[104:107], v[40:55]
    ds_read_b128 v[8:11], v144 offset:32768
    ds_read_b64_tr_b16 v[16:17], v148 offset:32768
    ds_read_b64_tr_b16 v[18:19], v148 offset:33280
    ds_read_b128 v[12:15], v144 offset:36864
    v_mfma_f32_32x32x16_bf16 v[88:103], v[112:115], v[108:111], v[88:103]
    v_mfma_f32_32x32x16_bf16 v[40:55], v[128:131], v[120:123], v[40:55]
    ds_read_b128 v[104:107], v145 offset:32768
    ds_read_b64_tr_b16 v[112:113], v148 offset:36864
    ds_read_b64_tr_b16 v[114:115], v148 offset:37376
    ds_read_b128 v[108:111], v145 offset:36864
    v_mfma_f32_32x32x16_bf16 v[88:103], v[128:131], v[124:127], v[88:103]
    s_waitcnt lgkmcnt(4)
    v_mfma_f32_32x32x16_bf16 v[40:55], v[16:19], v[8:11], v[40:55]
    ds_read_b128 v[120:123], v146 offset:32768
    ds_read_b64_tr_b16 v[128:129], v148 offset:40960
    ds_read_b64_tr_b16 v[130:131], v148 offset:41472
    ds_read_b128 v[124:127], v146 offset:36864
    v_mfma_f32_32x32x16_bf16 v[88:103], v[16:19], v[12:15], v[88:103]
    s_waitcnt lgkmcnt(4)
    v_mfma_f32_32x32x16_bf16 v[40:55], v[112:115], v[104:107], v[40:55]
    ds_read_b128 v[8:11], v147 offset:32768
    ds_read_b64_tr_b16 v[16:17], v148 offset:45056
    ds_read_b64_tr_b16 v[18:19], v148 offset:45568
    ds_read_b128 v[12:15], v147 offset:36864
    v_mfma_f32_32x32x16_bf16 v[88:103], v[112:115], v[108:111], v[88:103]
    s_waitcnt lgkmcnt(4)
    v_mfma_f32_32x32x16_bf16 v[40:55], v[128:131], v[120:123], v[40:55]
    ds_read_b128 v[104:107], v144 offset:49152
    ds_read_b64_tr_b16 v[112:113], v148 offset:49152
    ds_read_b64_tr_b16 v[114:115], v148 offset:49664
    ds_read_b128 v[108:111], v144 offset:53248
    v_mfma_f32_32x32x16_bf16 v[88:103], v[128:131], v[124:127], v[88:103]
    s_waitcnt lgkmcnt(4)
    v_mfma_f32_32x32x16_bf16 v[40:55], v[16:19], v[8:11], v[40:55]
    ds_read_b128 v[120:123], v145 offset:49152
    ds_read_b64_tr_b16 v[128:129], v148 offset:53248
    ds_read_b64_tr_b16 v[130:131], v148 offset:53760
    ds_read_b128 v[124:127], v145 offset:53248
    v_mfma_f32_32x32x16_bf16 v[88:103], v[16:19], v[12:15], v[88:103]
    s_waitcnt lgkmcnt(4)
    v_mfma_f32_32x32x16_bf16 v[40:55], v[112:115], v[104:107], v[40:55]
    ds_read_b128 v[8:11], v146 offset:49152
    ds_read_b64_tr_b16 v[16:17], v148 offset:57344
    ds_read_b64_tr_b16 v[18:19], v148 offset:57856
    ds_read_b128 v[12:15], v146 offset:53248
    v_mfma_f32_32x32x16_bf16 v[88:103], v[112:115], v[108:111], v[88:103]
    s_waitcnt lgkmcnt(4)
    v_mfma_f32_32x32x16_bf16 v[40:55], v[128:131], v[120:123], v[40:55]
    ds_read_b128 v[104:107], v147 offset:49152
    ds_read_b64_tr_b16 v[112:113], v148 offset:61440
    ds_read_b64_tr_b16 v[114:115], v148 offset:61952
    ds_read_b128 v[108:111], v147 offset:53248
    v_mfma_f32_32x32x16_bf16 v[88:103], v[128:131], v[124:127], v[88:103]
    s_waitcnt lgkmcnt(0)
    s_barrier
    v_mfma_f32_32x32x16_bf16 v[40:55], v[16:19], v[8:11], v[40:55]
    ds_read_b128 v[120:123], v144 offset:0
    ds_read_b64_tr_b16 v[128:129], v148 offset:0
    ds_read_b64_tr_b16 v[130:131], v148 offset:512
    ds_read_b128 v[124:127], v144 offset:4096
    v_mfma_f32_32x32x16_bf16 v[88:103], v[16:19], v[12:15], v[88:103]
    v_mfma_f32_32x32x16_bf16 v[40:55], v[112:115], v[104:107], v[40:55]
    ds_read_b128 v[8:11], v145 offset:0
    ds_read_b64_tr_b16 v[16:17], v148 offset:4096
    ds_read_b64_tr_b16 v[18:19], v148 offset:4608
    ds_read_b128 v[12:15], v145 offset:4096
    v_mfma_f32_32x32x16_bf16 v[88:103], v[112:115], v[108:111], v[88:103]
    s_waitcnt lgkmcnt(4)
    v_mfma_f32_32x32x16_bf16 v[40:55], v[128:131], v[120:123], v[40:55]
    ds_read_b128 v[104:107], v146 offset:0
    ds_read_b64_tr_b16 v[112:113], v148 offset:8192
    ds_read_b64_tr_b16 v[114:115], v148 offset:8704
    ds_read_b128 v[108:111], v146 offset:4096
    v_mfma_f32_32x32x16_bf16 v[88:103], v[128:131], v[124:127], v[88:103]
    s_waitcnt lgkmcnt(4)
    v_mfma_f32_32x32x16_bf16 v[40:55], v[16:19], v[8:11], v[40:55]
    ds_read_b128 v[120:123], v147 offset:0
    ds_read_b64_tr_b16 v[128:129], v148 offset:12288
    ds_read_b64_tr_b16 v[130:131], v148 offset:12800
    ds_read_b128 v[124:127], v147 offset:4096
    v_mfma_f32_32x32x16_bf16 v[88:103], v[16:19], v[12:15], v[88:103]
    s_waitcnt lgkmcnt(4)
    v_mfma_f32_32x32x16_bf16 v[40:55], v[112:115], v[104:107], v[40:55]
    ds_read_b128 v[8:11], v144 offset:16384
    ds_read_b64_tr_b16 v[16:17], v148 offset:16384
    ds_read_b64_tr_b16 v[18:19], v148 offset:16896
    ds_read_b128 v[12:15], v144 offset:20480
    v_mfma_f32_32x32x16_bf16 v[88:103], v[112:115], v[108:111], v[88:103]
    s_waitcnt lgkmcnt(4)
    v_mfma_f32_32x32x16_bf16 v[40:55], v[128:131], v[120:123], v[40:55]
    ds_read_b128 v[104:107], v145 offset:16384
    ds_read_b64_tr_b16 v[112:113], v148 offset:20480
    ds_read_b64_tr_b16 v[114:115], v148 offset:20992
    ds_read_b128 v[108:111], v145 offset:20480
    v_mfma_f32_32x32x16_bf16 v[88:103], v[128:131], v[124:127], v[88:103]
    s_waitcnt lgkmcnt(4)
    v_mfma_f32_32x32x16_bf16 v[40:55], v[16:19], v[8:11], v[40:55]
    ds_read_b128 v[120:123], v146 offset:16384
    ds_read_b64_tr_b16 v[128:129], v148 offset:24576
    ds_read_b64_tr_b16 v[130:131], v148 offset:25088
    ds_read_b128 v[124:127], v146 offset:20480
    v_mfma_f32_32x32x16_bf16 v[88:103], v[16:19], v[12:15], v[88:103]
    s_waitcnt lgkmcnt(4)
    v_mfma_f32_32x32x16_bf16 v[40:55], v[112:115], v[104:107], v[40:55]
    ds_read_b128 v[8:11], v147 offset:16384
    ds_read_b64_tr_b16 v[16:17], v148 offset:28672
    ds_read_b64_tr_b16 v[18:19], v148 offset:29184
    ds_read_b128 v[12:15], v147 offset:20480
    v_mfma_f32_32x32x16_bf16 v[88:103], v[112:115], v[108:111], v[88:103]
    s_waitcnt lgkmcnt(0)
    s_barrier
    v_mfma_f32_32x32x16_bf16 v[40:55], v[128:131], v[120:123], v[40:55]
    ds_read_b128 v[104:107], v144 offset:32768
    ds_read_b64_tr_b16 v[112:113], v148 offset:32768
    ds_read_b64_tr_b16 v[114:115], v148 offset:33280
    ds_read_b128 v[108:111], v144 offset:36864
    v_mfma_f32_32x32x16_bf16 v[88:103], v[128:131], v[124:127], v[88:103]
    v_mfma_f32_32x32x16_bf16 v[40:55], v[16:19], v[8:11], v[40:55]
    ds_read_b128 v[120:123], v145 offset:32768
    ds_read_b64_tr_b16 v[128:129], v148 offset:36864
    ds_read_b64_tr_b16 v[130:131], v148 offset:37376
    ds_read_b128 v[124:127], v145 offset:36864
    v_mfma_f32_32x32x16_bf16 v[88:103], v[16:19], v[12:15], v[88:103]
    s_waitcnt lgkmcnt(4)
    v_mfma_f32_32x32x16_bf16 v[40:55], v[112:115], v[104:107], v[40:55]
    ds_read_b128 v[8:11], v146 offset:32768
    ds_read_b64_tr_b16 v[16:17], v148 offset:40960
    ds_read_b64_tr_b16 v[18:19], v148 offset:41472
    ds_read_b128 v[12:15], v146 offset:36864
    v_mfma_f32_32x32x16_bf16 v[88:103], v[112:115], v[108:111], v[88:103]
    s_waitcnt lgkmcnt(4)
    v_mfma_f32_32x32x16_bf16 v[40:55], v[128:131], v[120:123], v[40:55]
    ds_read_b128 v[104:107], v147 offset:32768
    ds_read_b64_tr_b16 v[112:113], v148 offset:45056
    ds_read_b64_tr_b16 v[114:115], v148 offset:45568
    ds_read_b128 v[108:111], v147 offset:36864
    v_mfma_f32_32x32x16_bf16 v[88:103], v[128:131], v[124:127], v[88:103]
    s_waitcnt lgkmcnt(4)
    v_mfma_f32_32x32x16_bf16 v[40:55], v[16:19], v[8:11], v[40:55]
    ds_read_b128 v[120:123], v144 offset:49152
    ds_read_b64_tr_b16 v[128:129], v148 offset:49152
    ds_read_b64_tr_b16 v[130:131], v148 offset:49664
    ds_read_b128 v[124:127], v144 offset:53248
    v_mfma_f32_32x32x16_bf16 v[88:103], v[16:19], v[12:15], v[88:103]
    s_waitcnt lgkmcnt(4)
    v_mfma_f32_32x32x16_bf16 v[40:55], v[112:115], v[104:107], v[40:55]
    ds_read_b128 v[8:11], v145 offset:49152
    ds_read_b64_tr_b16 v[16:17], v148 offset:53248
    ds_read_b64_tr_b16 v[18:19], v148 offset:53760
    ds_read_b128 v[12:15], v145 offset:53248
    v_mfma_f32_32x32x16_bf16 v[88:103], v[112:115], v[108:111], v[88:103]
    s_waitcnt lgkmcnt(4)
    v_mfma_f32_32x32x16_bf16 v[40:55], v[128:131], v[120:123], v[40:55]
    ds_read_b128 v[104:107], v146 offset:49152
    ds_read_b64_tr_b16 v[112:113], v148 offset:57344
    ds_read_b64_tr_b16 v[114:115], v148 offset:57856
    ds_read_b128 v[108:111], v146 offset:53248
    v_mfma_f32_32x32x16_bf16 v[88:103], v[128:131], v[124:127], v[88:103]
    ds_read_b64 v[152:153], v7 offset:3072
    s_waitcnt lgkmcnt(5)
    v_mfma_f32_32x32x16_bf16 v[40:55], v[16:19], v[8:11], v[40:55]
    ds_read_b128 v[120:123], v147 offset:49152
    ds_read_b64_tr_b16 v[128:129], v148 offset:61440
    ds_read_b64_tr_b16 v[130:131], v148 offset:61952
    ds_read_b128 v[124:127], v147 offset:53248
    v_mfma_f32_32x32x16_bf16 v[88:103], v[16:19], v[12:15], v[88:103]
    s_waitcnt lgkmcnt(4)
    v_mfma_f32_32x32x16_bf16 v[40:55], v[112:115], v[104:107], v[40:55]
    v_cvt_pk_bf16_f32 v154, v152, v152
    v_mov_b32 v58, 0
    v_and_b32 v154, 0xffff0000, v154
    v_sub_f32 v154, v152, v154
    v_cvt_pk_bf16_f32 v56, v152, v154
    v_mov_b32 v59, 0
    v_mov_b32 v57, v56
    v_mfma_f32_32x32x16_bf16 v[88:103], v[112:115], v[108:111], v[88:103]
    v_mov_b32 v64, v160
    v_mov_b32 v65, v161
    v_mov_b32 v66, 0
    v_mov_b32 v67, 0
    v_mov_b32 v68, v164
    v_mov_b32 v69, v165
    v_mov_b32 v70, 0
    v_mov_b32 v71, 0
    s_waitcnt lgkmcnt(0)
    s_barrier
    v_mfma_f32_32x32x16_bf16 v[40:55], v[128:131], v[120:123], v[40:55]
    v_mov_b32 v136, v163
    v_mul_f32 v137, 0xc0135761, v162
    v_mul_f32 v138, v162, v162
    v_mul_f32 v138, v138, v137
    v_mul_f32 v138, 0x3d372713, v138
    v_mfma_f32_32x32x16_bf16 v[88:103], v[128:131], v[124:127], v[88:103]
    v_mov_b32 v140, v167
    v_mul_f32 v141, 0xc0135761, v166
    v_mul_f32 v142, v166, v166
    v_mul_f32 v142, v142, v141
    v_mul_f32 v142, 0x3d372713, v142
    s_barrier
    s_setprio 3
    v_mfma_f32_32x32x16_bf16 v[40:55], v[56:59], v[64:67], v[40:55]
    v_mfma_f32_32x32x16_bf16 v[88:103], v[56:59], v[68:71], v[88:103]
    s_nop 10
    v_pk_mul_f32 v[160:161], v[40:41], v[40:41]
    v_pk_mul_f32 v[162:163], v[42:43], v[42:43]
    v_pk_mul_f32 v[164:165], v[44:45], v[44:45]
    v_pk_mul_f32 v[166:167], v[46:47], v[46:47]
    v_pk_fma_f32 v[160:161], v[160:161], v[138:139], v[136:137] op_sel:[0,0,1] op_sel_hi:[1,0,1]
    v_pk_fma_f32 v[162:163], v[162:163], v[138:139], v[136:137] op_sel:[0,0,1] op_sel_hi:[1,0,1]
    v_pk_fma_f32 v[164:165], v[164:165], v[138:139], v[136:137] op_sel:[0,0,1] op_sel_hi:[1,0,1]
    v_pk_fma_f32 v[166:167], v[166:167], v[138:139], v[136:137] op_sel:[0,0,1] op_sel_hi:[1,0,1]
    v_pk_mul_f32 v[160:161], v[160:161], v[40:41]
    v_pk_mul_f32 v[162:163], v[162:163], v[42:43]
    v_pk_mul_f32 v[164:165], v[164:165], v[44:45]
    v_pk_mul_f32 v[166:167], v[166:167], v[46:47]
    v_exp_f32 v160, v160
    v_exp_f32 v161, v161
    v_exp_f32 v162, v162
    v_exp_f32 v163, v163
    v_exp_f32 v164, v164
    v_exp_f32 v165, v165
    v_exp_f32 v166, v166
    v_exp_f32 v167, v167
    v_pk_fma_f32 v[160:161], v[160:161], v[136:137], v[136:137] op_sel_hi:[1,0,0]
    v_pk_fma_f32 v[162:163], v[162:163], v[136:137], v[136:137] op_sel_hi:[1,0,0]
    v_pk_fma_f32 v[164:165], v[164:165], v[136:137], v[136:137] op_sel_hi:[1,0,0]
    v_pk_fma_f32 v[166:167], v[166:167], v[136:137], v[136:137] op_sel_hi:[1,0,0]
    v_rcp_f32 v160, v160
    v_rcp_f32 v161, v161
    v_rcp_f32 v162, v162
    v_rcp_f32 v163, v163
    v_rcp_f32 v164, v164
    v_rcp_f32 v165, v165
    v_rcp_f32 v166, v166
    v_rcp_f32 v167, v167
    v_pk_mul_f32 v[40:41], v[40:41], v[160:161]
    v_pk_mul_f32 v[42:43], v[42:43], v[162:163]
    v_pk_mul_f32 v[44:45], v[44:45], v[164:165]
    v_pk_mul_f32 v[46:47], v[46:47], v[166:167]
    v_pk_mul_f32 v[160:161], v[48:49], v[48:49]
    v_pk_mul_f32 v[162:163], v[50:51], v[50:51]
    v_pk_mul_f32 v[164:165], v[52:53], v[52:53]
    v_pk_mul_f32 v[166:167], v[54:55], v[54:55]
    v_pk_fma_f32 v[160:161], v[160:161], v[138:139], v[136:137] op_sel:[0,0,1] op_sel_hi:[1,0,1]
    v_pk_fma_f32 v[162:163], v[162:163], v[138:139], v[136:137] op_sel:[0,0,1] op_sel_hi:[1,0,1]
    v_pk_fma_f32 v[164:165], v[164:165], v[138:139], v[136:137] op_sel:[0,0,1] op_sel_hi:[1,0,1]
    v_pk_fma_f32 v[166:167], v[166:167], v[138:139], v[136:137] op_sel:[0,0,1] op_sel_hi:[1,0,1]
    v_pk_mul_f32 v[160:161], v[160:161], v[48:49]
    v_pk_mul_f32 v[162:163], v[162:163], v[50:51]
    v_pk_mul_f32 v[164:165], v[164:165], v[52:53]
    v_pk_mul_f32 v[166:167], v[166:167], v[54:55]
    v_exp_f32 v160, v160
    v_exp_f32 v161, v161
    v_exp_f32 v162, v162
    v_exp_f32 v163, v163
    v_exp_f32 v164, v164
    v_exp_f32 v165, v165
    v_exp_f32 v166, v166
    v_exp_f32 v167, v167
    v_pk_fma_f32 v[160:161], v[160:161], v[136:137], v[136:137] op_sel_hi:[1,0,0]
    v_pk_fma_f32 v[162:163], v[162:163], v[136:137], v[136:137] op_sel_hi:[1,0,0]
    v_pk_fma_f32 v[164:165], v[164:165], v[136:137], v[136:137] op_sel_hi:[1,0,0]
    v_pk_fma_f32 v[166:167], v[166:167], v[136:137], v[136:137] op_sel_hi:[1,0,0]
    v_rcp_f32 v160, v160
    v_rcp_f32 v161, v161
    v_rcp_f32 v162, v162
    v_rcp_f32 v163, v163
    v_rcp_f32 v164, v164
    v_rcp_f32 v165, v165
    v_rcp_f32 v166, v166
    v_rcp_f32 v167, v167
    v_pk_mul_f32 v[48:49], v[48:49], v[160:161]
    v_pk_mul_f32 v[50:51], v[50:51], v[162:163]
    v_pk_mul_f32 v[52:53], v[52:53], v[164:165]
    v_pk_mul_f32 v[54:55], v[54:55], v[166:167]
    v_pk_mul_f32 v[160:161], v[88:89], v[88:89]
    v_pk_mul_f32 v[162:163], v[90:91], v[90:91]
    v_pk_mul_f32 v[164:165], v[92:93], v[92:93]
    v_pk_mul_f32 v[166:167], v[94:95], v[94:95]
    v_pk_fma_f32 v[160:161], v[160:161], v[142:143], v[140:141] op_sel:[0,0,1] op_sel_hi:[1,0,1]
    v_pk_fma_f32 v[162:163], v[162:163], v[142:143], v[140:141] op_sel:[0,0,1] op_sel_hi:[1,0,1]
    v_pk_fma_f32 v[164:165], v[164:165], v[142:143], v[140:141] op_sel:[0,0,1] op_sel_hi:[1,0,1]
    v_pk_fma_f32 v[166:167], v[166:167], v[142:143], v[140:141] op_sel:[0,0,1] op_sel_hi:[1,0,1]
    v_pk_mul_f32 v[160:161], v[160:161], v[88:89]
    v_pk_mul_f32 v[162:163], v[162:163], v[90:91]
    v_pk_mul_f32 v[164:165], v[164:165], v[92:93]
    v_pk_mul_f32 v[166:167], v[166:167], v[94:95]
    v_exp_f32 v160, v160
    v_exp_f32 v161, v161
    v_exp_f32 v162, v162
    v_exp_f32 v163, v163
    v_exp_f32 v164, v164
    v_exp_f32 v165, v165
    v_exp_f32 v166, v166
    v_exp_f32 v167, v167
    v_pk_fma_f32 v[160:161], v[160:161], v[140:141], v[140:141] op_sel_hi:[1,0,0]
    v_pk_fma_f32 v[162:163], v[162:163], v[140:141], v[140:141] op_sel_hi:[1,0,0]
    v_pk_fma_f32 v[164:165], v[164:165], v[140:141], v[140:141] op_sel_hi:[1,0,0]
    v_pk_fma_f32 v[166:167], v[166:167], v[140:141], v[140:141] op_sel_hi:[1,0,0]
    v_rcp_f32 v160, v160
    v_rcp_f32 v161, v161
    v_rcp_f32 v162, v162
    v_rcp_f32 v163, v163
    v_rcp_f32 v164, v164
    v_rcp_f32 v165, v165
    v_rcp_f32 v166, v166
    v_rcp_f32 v167, v167
    v_pk_mul_f32 v[88:89], v[88:89], v[160:161]
    v_pk_mul_f32 v[90:91], v[90:91], v[162:163]
    v_pk_mul_f32 v[92:93], v[92:93], v[164:165]
    v_pk_mul_f32 v[94:95], v[94:95], v[166:167]
    v_pk_mul_f32 v[160:161], v[96:97], v[96:97]
    v_pk_mul_f32 v[162:163], v[98:99], v[98:99]
    v_pk_mul_f32 v[164:165], v[100:101], v[100:101]
    v_pk_mul_f32 v[166:167], v[102:103], v[102:103]
    v_pk_fma_f32 v[160:161], v[160:161], v[142:143], v[140:141] op_sel:[0,0,1] op_sel_hi:[1,0,1]
    v_pk_fma_f32 v[162:163], v[162:163], v[142:143], v[140:141] op_sel:[0,0,1] op_sel_hi:[1,0,1]
    v_pk_fma_f32 v[164:165], v[164:165], v[142:143], v[140:141] op_sel:[0,0,1] op_sel_hi:[1,0,1]
    v_pk_fma_f32 v[166:167], v[166:167], v[142:143], v[140:141] op_sel:[0,0,1] op_sel_hi:[1,0,1]
    v_pk_mul_f32 v[160:161], v[160:161], v[96:97]
    v_pk_mul_f32 v[162:163], v[162:163], v[98:99]
    v_pk_mul_f32 v[164:165], v[164:165], v[100:101]
    v_pk_mul_f32 v[166:167], v[166:167], v[102:103]
    v_exp_f32 v160, v160
    v_exp_f32 v161, v161
    v_exp_f32 v162, v162
    v_exp_f32 v163, v163
    v_exp_f32 v164, v164
    v_exp_f32 v165, v165
    v_exp_f32 v166, v166
    v_exp_f32 v167, v167
    v_pk_fma_f32 v[160:161], v[160:161], v[140:141], v[140:141] op_sel_hi:[1,0,0]
    v_pk_fma_f32 v[162:163], v[162:163], v[140:141], v[140:141] op_sel_hi:[1,0,0]
    v_pk_fma_f32 v[164:165], v[164:165], v[140:141], v[140:141] op_sel_hi:[1,0,0]
    v_pk_fma_f32 v[166:167], v[166:167], v[140:141], v[140:141] op_sel_hi:[1,0,0]
    v_rcp_f32 v160, v160
    v_rcp_f32 v161, v161
    v_rcp_f32 v162, v162
    v_rcp_f32 v163, v163
    v_rcp_f32 v164, v164
    v_rcp_f32 v165, v165
    v_rcp_f32 v166, v166
    v_rcp_f32 v167, v167
    v_pk_mul_f32 v[96:97], v[96:97], v[160:161]
    v_pk_mul_f32 v[98:99], v[98:99], v[162:163]
    v_pk_mul_f32 v[100:101], v[100:101], v[164:165]
    v_pk_mul_f32 v[102:103], v[102:103], v[166:167]
    v_pk_add_f32 v[160:161], v[40:41], v[42:43]
    v_pk_mul_f32 v[162:163], v[40:41], v[40:41]
    v_pk_fma_f32 v[162:163], v[42:43], v[42:43], v[162:163]
    v_pk_add_f32 v[160:161], v[160:161], v[44:45]
    v_pk_fma_f32 v[162:163], v[44:45], v[44:45], v[162:163]
    v_pk_add_f32 v[160:161], v[160:161], v[46:47]
    v_pk_fma_f32 v[162:163], v[46:47], v[46:47], v[162:163]
    v_pk_add_f32 v[160:161], v[160:161], v[48:49]
    v_pk_fma_f32 v[162:163], v[48:49], v[48:49], v[162:163]
    v_pk_add_f32 v[160:161], v[160:161], v[50:51]
    v_pk_fma_f32 v[162:163], v[50:51], v[50:51], v[162:163]
    v_pk_add_f32 v[160:161], v[160:161], v[52:53]
    v_pk_fma_f32 v[162:163], v[52:53], v[52:53], v[162:163]
    v_pk_add_f32 v[160:161], v[160:161], v[54:55]
    v_pk_fma_f32 v[162:163], v[54:55], v[54:55], v[162:163]
    v_add_f32 v152, v160, v161
    v_add_f32 v153, v162, v163
    v_mov_b32 v156, v152
    v_mov_b32 v157, v153
    v_pk_add_f32 v[164:165], v[88:89], v[90:91]
    v_pk_mul_f32 v[166:167], v[88:89], v[88:89]
    v_pk_fma_f32 v[166:167], v[90:91], v[90:91], v[166:167]
    v_pk_add_f32 v[164:165], v[164:165], v[92:93]
    v_pk_fma_f32 v[166:167], v[92:93], v[92:93], v[166:167]
    v_pk_add_f32 v[164:165], v[164:165], v[94:95]
    v_pk_fma_f32 v[166:167], v[94:95], v[94:95], v[166:167]
    v_pk_add_f32 v[164:165], v[164:165], v[96:97]
    v_pk_fma_f32 v[166:167], v[96:97], v[96:97], v[166:167]
    v_pk_add_f32 v[164:165], v[164:165], v[98:99]
    v_pk_fma_f32 v[166:167], v[98:99], v[98:99], v[166:167]
    v_pk_add_f32 v[164:165], v[164:165], v[100:101]
    v_pk_fma_f32 v[166:167], v[100:101], v[100:101], v[166:167]
    v_pk_add_f32 v[164:165], v[164:165], v[102:103]
    v_pk_fma_f32 v[166:167], v[102:103], v[102:103], v[166:167]
    v_add_f32 v154, v164, v165
    v_add_f32 v155, v166, v167
    v_mov_b32 v158, v154
    v_mov_b32 v159, v155
    v_mov_b32 v116, 0xfff
    v_lshlrev_b32 v117, 4, v3
    s_lshl_b32 s45, s52, 9
    s_add_u32 s45, s45, s48
    s_sub_u32 s45, s45, 10240
    v_permlane32_swap_b32 v152, v156
    v_permlane32_swap_b32 v153, v157
    v_permlane32_swap_b32 v154, v158
    v_permlane32_swap_b32 v155, v159
    v_pk_add_f32 v[152:153], v[152:153], v[156:157]
    v_bfi_b32 v153, v116, s60, v153
    v_pk_add_f32 v[154:155], v[154:155], v[158:159]
    v_bfi_b32 v155, v116, s63, v155
    buffer_store_dwordx4 v[152:155], v117, s[28:31], s45 offen sc1
m_t0_rest:
    v_mul_u32_u24 v119, 5632, v4
    v_add_u32 v119, v119, v117
    s_add_u32 s48, s48, 512
    s_add_u32 s49, s48, 4096
    s_mov_b32 s47, 0x100000
m_t0_gather:
    buffer_load_dwordx4 v[8:11], v119, s[28:31], s48 offen offset:0 sc1
    buffer_load_dwordx4 v[12:15], v119, s[28:31], s48 offen offset:512 sc1
    buffer_load_dwordx4 v[16:19], v119, s[28:31], s48 offen offset:1024 sc1
    buffer_load_dwordx4 v[20:23], v119, s[28:31], s48 offen offset:1536 sc1
    buffer_load_dwordx4 v[64:67], v119, s[28:31], s48 offen offset:2048 sc1
    buffer_load_dwordx4 v[68:71], v119, s[28:31], s48 offen offset:2560 sc1
    buffer_load_dwordx4 v[104:107], v119, s[28:31], s48 offen offset:3072 sc1
    buffer_load_dwordx4 v[108:111], v119, s[28:31], s48 offen offset:3584 sc1
    buffer_load_dwordx4 v[112:115], v119, s[28:31], s49 offen offset:0 sc1
    buffer_load_dwordx4 v[124:127], v119, s[28:31], s49 offen offset:512 sc1
    buffer_load_dwordx4 v[128:131], v119, s[28:31], s49 offen offset:1024 sc1
    v_bfe_u32 v160, v2, 4, 1
    v_and_b32 v161, 15, v2
    v_lshlrev_b32 v120, 10, v4
    v_lshl_add_u32 v120, v160, 9, v120
    v_lshl_add_u32 v120, v161, 4, v120
    s_lshl_b32 s36, s12, 12
    s_add_u32 s36, s36, 139264
    v_lshlrev_b32 v121, 5, v3
    v_lshl_add_u32 v121, v4, 3, v121
    v_add_u32 v121, s36, v121
    v_lshrrev_b32 v160, 4, v2
    v_lshlrev_b32 v122, 8, v160
    v_lshl_add_u32 v122, v161, 3, v122
    v_add_u32 v122, s36, v122
    s_waitcnt vmcnt(0)
    v_xor_b32 v9, s60, v9
    v_xor_b32 v11, s63, v11
    v_xor_b32 v13, s60, v13
    v_xor_b32 v15, s63, v15
    v_xor_b32 v17, s60, v17
    v_xor_b32 v19, s63, v19
    v_xor_b32 v21, s60, v21
    v_xor_b32 v23, s63, v23
    v_xor_b32 v65, s60, v65
    v_xor_b32 v67, s63, v67
    v_xor_b32 v69, s60, v69
    v_xor_b32 v71, s63, v71
    v_xor_b32 v105, s60, v105
    v_xor_b32 v107, s63, v107
    v_xor_b32 v109, s60, v109
    v_xor_b32 v111, s63, v111
    v_xor_b32 v113, s60, v113
    v_xor_b32 v115, s63, v115
    v_xor_b32 v125, s60, v125
    v_xor_b32 v127, s63, v127
    v_xor_b32 v129, s60, v129
    v_xor_b32 v131, s63, v131
    v_or_b32 v160, v9, v11
    v_or3_b32 v160, v160, v13, v15
    v_or3_b32 v160, v160, v17, v19
    v_or3_b32 v160, v160, v21, v23
    v_or3_b32 v160, v160, v65, v67
    v_or3_b32 v160, v160, v69, v71
    v_or3_b32 v160, v160, v105, v107
    v_or3_b32 v160, v160, v109, v111
    v_or3_b32 v160, v160, v113, v115
    v_or3_b32 v160, v160, v125, v127
    v_or3_b32 v160, v160, v129, v131
    v_and_b32 v160, v160, v116
    v_cmp_ne_u32 vcc, 0, v160
    s_cbranch_vccz m_t0_have
    s_sleep 6
    s_sub_u32 s47, s47, 1
    s_cmp_lg_u32 s47, 0
    s_cbranch_scc1 m_t0_gather
m_t0_have:
    s_mov_b32 s36, 0x3abe82fa
    v_pk_add_f32 v[8:9], v[8:9], v[104:105]
    v_pk_add_f32 v[10:11], v[10:11], v[106:107]
    v_pk_add_f32 v[12:13], v[12:13], v[108:109]
    v_pk_add_f32 v[14:15], v[14:15], v[110:111]
    v_pk_add_f32 v[16:17], v[16:17], v[112:113]
    v_pk_add_f32 v[18:19], v[18:19], v[114:115]
    v_pk_add_f32 v[20:21], v[20:21], v[124:125]
    v_pk_add_f32 v[22:23], v[22:23], v[126:127]
    v_pk_add_f32 v[64:65], v[64:65], v[128:129]
    v_pk_add_f32 v[66:67], v[66:67], v[130:131]
    v_pk_add_f32 v[8:9], v[8:9], v[20:21]
    v_pk_add_f32 v[10:11], v[10:11], v[22:23]
    v_pk_add_f32 v[12:13], v[12:13], v[64:65]
    v_pk_add_f32 v[14:15], v[14:15], v[66:67]
    v_pk_add_f32 v[16:17], v[16:17], v[68:69]
    v_pk_add_f32 v[18:19], v[18:19], v[70:71]
    v_pk_add_f32 v[8:9], v[8:9], v[12:13]
    v_pk_add_f32 v[10:11], v[10:11], v[14:15]
    v_pk_add_f32 v[8:9], v[8:9], v[16:17]
    v_pk_add_f32 v[10:11], v[10:11], v[18:19]
    v_mov_b32 v12, v8
    v_mov_b32 v13, v9
    v_mov_b32 v14, v10
    v_mov_b32 v15, v11
    s_sub_u32 s37, s52, 22
    s_lshl_b32 s37, s37, 17
    v_permlane32_swap_b32 v8, v12
    v_permlane32_swap_b32 v9, v13
    v_permlane32_swap_b32 v10, v14
    v_permlane32_swap_b32 v11, v15
    s_add_u32 s37, s37, s44
    s_add_u32 s38, s37, 131072
    s_add_u32 s37, s37, 256
    v_pk_add_f32 v[8:9], v[8:9], v[12:13]
    v_mul_f32 v8, s36, v8
    v_mul_f32 v16, v8, v8
    v_fma_f32 v16, v9, s36, -v16
    v_max_f32 v16, 0, v16
    v_add_f32 v16, 0x3727c5ac, v16
    v_rsq_f32 v16, v16
    s_nop 0
    v_mul_f32 v18, -v8, v16
    v_pk_add_f32 v[10:11], v[10:11], v[14:15]
    v_mul_f32 v10, s36, v10
    v_mul_f32 v20, v10, v10
    v_fma_f32 v20, v11, s36, -v20
    v_max_f32 v20, 0, v20
    v_add_f32 v20, 0x3727c5ac, v20
    v_rsq_f32 v20, v20
    s_nop 0
    v_mul_f32 v22, -v10, v20
    v_pk_fma_f32 v[40:41], v[40:41], v[16:17], v[18:19] op_sel_hi:[1,0,0]
    v_pk_fma_f32 v[42:43], v[42:43], v[16:17], v[18:19] op_sel_hi:[1,0,0]
    v_pk_fma_f32 v[44:45], v[44:45], v[16:17], v[18:19] op_sel_hi:[1,0,0]
    v_pk_fma_f32 v[46:47], v[46:47], v[16:17], v[18:19] op_sel_hi:[1,0,0]
    v_pk_fma_f32 v[48:49], v[48:49], v[16:17], v[18:19] op_sel_hi:[1,0,0]
    v_pk_fma_f32 v[50:51], v[50:51], v[16:17], v[18:19] op_sel_hi:[1,0,0]
    v_pk_fma_f32 v[52:53], v[52:53], v[16:17], v[18:19] op_sel_hi:[1,0,0]
    v_pk_fma_f32 v[54:55], v[54:55], v[16:17], v[18:19] op_sel_hi:[1,0,0]
    v_cvt_pk_bf16_f32 v40, v40, v41
    v_cvt_pk_bf16_f32 v41, v42, v43
    v_cvt_pk_bf16_f32 v42, v44, v45
    v_cvt_pk_bf16_f32 v43, v46, v47
    v_cvt_pk_bf16_f32 v44, v48, v49
    v_cvt_pk_bf16_f32 v45, v50, v51
    v_cvt_pk_bf16_f32 v46, v52, v53
    v_cvt_pk_bf16_f32 v47, v54, v55
    ds_write_b64 v121, v[40:41] offset:0
    ds_write_b64 v121, v[42:43] offset:16
    ds_write_b64 v121, v[44:45] offset:1024
    ds_write_b64 v121, v[46:47] offset:1040
    v_pk_fma_f32 v[88:89], v[88:89], v[20:21], v[22:23] op_sel_hi:[1,0,0]
    v_pk_fma_f32 v[90:91], v[90:91], v[20:21], v[22:23] op_sel_hi:[1,0,0]
    v_pk_fma_f32 v[92:93], v[92:93], v[20:21], v[22:23] op_sel_hi:[1,0,0]
    v_pk_fma_f32 v[94:95], v[94:95], v[20:21], v[22:23] op_sel_hi:[1,0,0]
    v_pk_fma_f32 v[96:97], v[96:97], v[20:21], v[22:23] op_sel_hi:[1,0,0]
    v_pk_fma_f32 v[98:99], v[98:99], v[20:21], v[22:23] op_sel_hi:[1,0,0]
    v_pk_fma_f32 v[100:101], v[100:101], v[20:21], v[22:23] op_sel_hi:[1,0,0]
    v_pk_fma_f32 v[102:103], v[102:103], v[20:21], v[22:23] op_sel_hi:[1,0,0]
    v_cvt_pk_bf16_f32 v88, v88, v89
    v_cvt_pk_bf16_f32 v89, v90, v91
    v_cvt_pk_bf16_f32 v90, v92, v93
    v_cvt_pk_bf16_f32 v91, v94, v95
    v_cvt_pk_bf16_f32 v92, v96, v97
    v_cvt_pk_bf16_f32 v93, v98, v99
    v_cvt_pk_bf16_f32 v94, v100, v101
    v_cvt_pk_bf16_f32 v95, v102, v103
    ds_write_b64 v121, v[88:89] offset:2048
    ds_write_b64 v121, v[90:91] offset:2064
    ds_write_b64 v121, v[92:93] offset:3072
    ds_write_b64 v121, v[94:95] offset:3088
    s_waitcnt lgkmcnt(0)
    ds_read_b64_tr_b16 v[104:105], v122 offset:0
    ds_read_b64_tr_b16 v[106:107], v122 offset:128
    ds_read_b64_tr_b16 v[108:109], v122 offset:1024
    ds_read_b64_tr_b16 v[110:111], v122 offset:1152
    ds_read_b64_tr_b16 v[112:113], v122 offset:2048
    ds_read_b64_tr_b16 v[114:115], v122 offset:2176
    ds_read_b64_tr_b16 v[116:117], v122 offset:3072
    ds_read_b64_tr_b16 v[118:119], v122 offset:3200
    s_waitcnt lgkmcnt(0)
    buffer_store_dwordx4 v[108:111], v120, s[28:31], s38 offen offset:0 sc1
    buffer_store_dwordx4 v[116:119], v120, s[28:31], s38 offen offset:2048 sc1
    buffer_store_dwordx4 v[104:107], v120, s[28:31], s37 offen offset:0 sc1
    buffer_store_dwordx4 v[112:115], v120, s[28:31], s37 offen offset:2048 sc1
m_t0_flags:
    s_branch m_gemm
m_ty1:
    s_barrier
    ds_read_b128 v[104:107], v144 offset:0
    ds_read_b64_tr_b16 v[112:113], v148 offset:0
    ds_read_b64_tr_b16 v[114:115], v148 offset:512
    ds_read_b128 v[108:111], v144 offset:4096
    ds_read_b128 v[120:123], v145 offset:0
    ds_read_b64_tr_b16 v[128:129], v148 offset:4096
    ds_read_b64_tr_b16 v[130:131], v148 offset:4608
    ds_read_b128 v[124:127], v145 offset:4096
    s_waitcnt lgkmcnt(4)
    v_mfma_f32_32x32x16_bf16 v[8:23], v[104:107], v[112:115], 0
    ds_read_b128 v[88:91], v146 offset:0
    ds_read_b64_tr_b16 v[96:97], v148 offset:8192
    ds_read_b64_tr_b16 v[98:99], v148 offset:8704
    ds_read_b128 v[92:95], v146 offset:4096
    v_mfma_f32_32x32x16_bf16 v[56:71], v[108:111], v[112:115], 0
    s_waitcnt lgkmcnt(4)
    v_mfma_f32_32x32x16_bf16 v[8:23], v[120:123], v[128:131], v[8:23]
    ds_read_b128 v[104:107], v147 offset:0
    ds_read_b64_tr_b16 v[112:113], v148 offset:12288
    ds_read_b64_tr_b16 v[114:115], v148 offset:12800
    ds_read_b128 v[108:111], v147 offset:4096
    v_mfma_f32_32x32x16_bf16 v[56:71], v[124:127], v[128:131], v[56:71]
    s_waitcnt lgkmcnt(0)
    s_barrier
    v_mfma_f32_32x32x16_bf16 v[8:23], v[88:91], v[96:99], v[8:23]
    ds_read_b128 v[120:123], v144 offset:16384
    ds_read_b64_tr_b16 v[128:129], v148 offset:16384
    ds_read_b64_tr_b16 v[130:131], v148 offset:16896
    ds_read_b128 v[124:127], v144 offset:20480
    v_mfma_f32_32x32x16_bf16 v[56:71], v[92:95], v[96:99], v[56:71]
    v_mfma_f32_32x32x16_bf16 v[8:23], v[104:107], v[112:115], v[8:23]
    ds_read_b128 v[88:91], v145 offset:16384
    ds_read_b64_tr_b16 v[96:97], v148 offset:20480
    ds_read_b64_tr_b16 v[98:99], v148 offset:20992
    ds_read_b128 v[92:95], v145 offset:20480
    v_mfma_f32_32x32x16_bf16 v[56:71], v[108:111], v[112:115], v[56:71]
    s_waitcnt lgkmcnt(4)
    v_mfma_f32_32x32x16_bf16 v[8:23], v[120:123], v[128:131], v[8:23]
    ds_read_b128 v[104:107], v146 offset:16384
    ds_read_b64_tr_b16 v[112:113], v148 offset:24576
    ds_read_b64_tr_b16 v[114:115], v148 offset:25088
    ds_read_b128 v[108:111], v146 offset:20480
    v_mfma_f32_32x32x16_bf16 v[56:71], v[124:127], v[128:131], v[56:71]
    s_waitcnt lgkmcnt(4)
    v_mfma_f32_32x32x16_bf16 v[8:23], v[88:91], v[96:99], v[8:23]
    ds_read_b128 v[120:123], v147 offset:16384
    ds_read_b64_tr_b16 v[128:129], v148 offset:28672
    ds_read_b64_tr_b16 v[130:131], v148 offset:29184
    ds_read_b128 v[124:127], v147 offset:20480
    v_mfma_f32_32x32x16_bf16 v[56:71], v[92:95], v[96:99], v[56:71]
    s_waitcnt lgkmcnt(0)
    s_barrier
    v_mfma_f32_32x32x16_bf16 v[8:23], v[104:107], v[112:115], v[8:23]
    ds_read_b128 v[88:91], v144 offset:32768
    ds_read_b64_tr_b16 v[96:97], v148 offset:32768
    ds_read_b64_tr_b16 v[98:99], v148 offset:33280
    ds_read_b128 v[92:95], v144 offset:36864
    v_mfma_f32_32x32x16_bf16 v[56:71], v[108:111], v[112:115], v[56:71]
    v_mfma_f32_32x32x16_bf16 v[8:23], v[120:123], v[128:131], v[8:23]
    ds_read_b128 v[104:107], v145 offset:32768
    ds_read_b64_tr_b16 v[112:113], v148 offset:36864
    ds_read_b64_tr_b16 v[114:115], v148 offset:37376
    ds_read_b128 v[108:111], v145 offset:36864
    v_mfma_f32_32x32x16_bf16 v[56:71], v[124:127], v[128:131], v[56:71]
    s_waitcnt lgkmcnt(4)
    v_mfma_f32_32x32x16_bf16 v[8:23], v[88:91], v[96:99], v[8:23]
    ds_read_b128 v[120:123], v146 offset:32768
    ds_read_b64_tr_b16 v[128:129], v148 offset:40960
    ds_read_b64_tr_b16 v[130:131], v148 offset:41472
    ds_read_b128 v[124:127], v146 offset:36864
    v_mfma_f32_32x32x16_bf16 v[56:71], v[92:95], v[96:99], v[56:71]
    s_waitcnt lgkmcnt(4)
    v_mfma_f32_32x32x16_bf16 v[8:23], v[104:107], v[112:115], v[8:23]
    ds_read_b128 v[88:91], v147 offset:32768
    ds_read_b64_tr_b16 v[96:97], v148 offset:45056
    ds_read_b64_tr_b16 v[98:99], v148 offset:45568
    ds_read_b128 v[92:95], v147 offset:36864
    v_mfma_f32_32x32x16_bf16 v[56:71], v[108:111], v[112:115], v[56:71]
    s_waitcnt lgkmcnt(0)
    s_barrier
    v_mfma_f32_32x32x16_bf16 v[8:23], v[120:123], v[128:131], v[8:23]
    ds_read_b128 v[104:107], v144 offset:49152
    ds_read_b64_tr_b16 v[112:113], v148 offset:49152
    ds_read_b64_tr_b16 v[114:115], v148 offset:49664
    ds_read_b128 v[108:111], v144 offset:53248
    v_mfma_f32_32x32x16_bf16 v[56:71], v[124:127], v[128:131], v[56:71]
    v_mfma_f32_32x32x16_bf16 v[8:23], v[88:91], v[96:99], v[8:23]
    ds_read_b128 v[120:123], v145 offset:49152
    ds_read_b64_tr_b16 v[128:129], v148 offset:53248
    ds_read_b64_tr_b16 v[130:131], v148 offset:53760
    ds_read_b128 v[124:127], v145 offset:53248
    v_mfma_f32_32x32x16_bf16 v[56:71], v[92:95], v[96:99], v[56:71]
    s_waitcnt lgkmcnt(4)
    v_mfma_f32_32x32x16_bf16 v[8:23], v[104:107], v[112:115], v[8:23]
    ds_read_b128 v[88:91], v146 offset:49152
    ds_read_b64_tr_b16 v[96:97], v148 offset:57344
    ds_read_b64_tr_b16 v[98:99], v148 offset:57856
    ds_read_b128 v[92:95], v146 offset:53248
    v_mfma_f32_32x32x16_bf16 v[56:71], v[108:111], v[112:115], v[56:71]
    s_waitcnt lgkmcnt(4)
    v_mfma_f32_32x32x16_bf16 v[8:23], v[120:123], v[128:131], v[8:23]
    ds_read_b128 v[104:107], v147 offset:49152
    ds_read_b64_tr_b16 v[112:113], v148 offset:61440
    ds_read_b64_tr_b16 v[114:115], v148 offset:61952
    ds_read_b128 v[108:111], v147 offset:53248
    v_mfma_f32_32x32x16_bf16 v[56:71], v[124:127], v[128:131], v[56:71]
    s_waitcnt lgkmcnt(0)
    s_barrier
    v_mfma_f32_32x32x16_bf16 v[8:23], v[88:91], v[96:99], v[8:23]
    ds_read_b128 v[120:123], v144 offset:0
    ds_read_b64_tr_b16 v[128:129], v148 offset:0
    ds_read_b64_tr_b16 v[130:131], v148 offset:512
    ds_read_b128 v[124:127], v144 offset:4096
    v_mfma_f32_32x32x16_bf16 v[56:71], v[92:95], v[96:99], v[56:71]
    v_mfma_f32_32x32x16_bf16 v[8:23], v[104:107], v[112:115], v[8:23]
    ds_read_b128 v[88:91], v145 offset:0
    ds_read_b64_tr_b16 v[96:97], v148 offset:4096
    ds_read_b64_tr_b16 v[98:99], v148 offset:4608
    ds_read_b128 v[92:95], v145 offset:4096
    v_mfma_f32_32x32x16_bf16 v[56:71], v[108:111], v[112:115], v[56:71]
    s_waitcnt lgkmcnt(4)
    v_mfma_f32_32x32x16_bf16 v[8:23], v[120:123], v[128:131], v[8:23]
    ds_read_b128 v[104:107], v146 offset:0
    ds_read_b64_tr_b16 v[112:113], v148 offset:8192
    ds_read_b64_tr_b16 v[114:115], v148 offset:8704
    ds_read_b128 v[108:111], v146 offset:4096
    v_mfma_f32_32x32x16_bf16 v[56:71], v[124:127], v[128:131], v[56:71]
    s_waitcnt lgkmcnt(4)
    v_mfma_f32_32x32x16_bf16 v[8:23], v[88:91], v[96:99], v[8:23]
    ds_read_b128 v[120:123], v147 offset:0
    ds_read_b64_tr_b16 v[128:129], v148 offset:12288
    ds_read_b64_tr_b16 v[130:131], v148 offset:12800
    ds_read_b128 v[124:127], v147 offset:4096
    v_mfma_f32_32x32x16_bf16 v[56:71], v[92:95], v[96:99], v[56:71]
    s_waitcnt lgkmcnt(0)
    s_barrier
    v_mfma_f32_32x32x16_bf16 v[8:23], v[104:107], v[112:115], v[8:23]
    ds_read_b128 v[88:91], v144 offset:16384
    ds_read_b64_tr_b16 v[96:97], v148 offset:16384
    ds_read_b64_tr_b16 v[98:99], v148 offset:16896
    ds_read_b128 v[92:95], v144 offset:20480
    v_mfma_f32_32x32x16_bf16 v[56:71], v[108:111], v[112:115], v[56:71]
    v_mfma_f32_32x32x16_bf16 v[8:23], v[120:123], v[128:131], v[8:23]
    ds_read_b128 v[104:107], v145 offset:16384
    ds_read_b64_tr_b16 v[112:113], v148 offset:20480
    ds_read_b64_tr_b16 v[114:115], v148 offset:20992
    ds_read_b128 v[108:111], v145 offset:20480
    v_mfma_f32_32x32x16_bf16 v[56:71], v[124:127], v[128:131], v[56:71]
    s_waitcnt lgkmcnt(4)
    v_mfma_f32_32x32x16_bf16 v[8:23], v[88:91], v[96:99], v[8:23]
    ds_read_b128 v[120:123], v146 offset:16384
    ds_read_b64_tr_b16 v[128:129], v148 offset:24576
    ds_read_b64_tr_b16 v[130:131], v148 offset:25088
    ds_read_b128 v[124:127], v146 offset:20480
    v_mfma_f32_32x32x16_bf16 v[56:71], v[92:95], v[96:99], v[56:71]
    s_waitcnt lgkmcnt(4)
    v_mfma_f32_32x32x16_bf16 v[8:23], v[104:107], v[112:115], v[8:23]
    ds_read_b128 v[88:91], v147 offset:16384
    ds_read_b64_tr_b16 v[96:97], v148 offset:28672
    ds_read_b64_tr_b16 v[98:99], v148 offset:29184
    ds_read_b128 v[92:95], v147 offset:20480
    v_mfma_f32_32x32x16_bf16 v[56:71], v[108:111], v[112:115], v[56:71]
    s_waitcnt lgkmcnt(0)
    s_barrier
    v_mfma_f32_32x32x16_bf16 v[8:23], v[120:123], v[128:131], v[8:23]
    ds_read_b128 v[104:107], v144 offset:32768
    ds_read_b64_tr_b16 v[112:113], v148 offset:32768
    ds_read_b64_tr_b16 v[114:115], v148 offset:33280
    ds_read_b128 v[108:111], v144 offset:36864
    v_mfma_f32_32x32x16_bf16 v[56:71], v[124:127], v[128:131], v[56:71]
    v_mfma_f32_32x32x16_bf16 v[8:23], v[88:91], v[96:99], v[8:23]
    ds_read_b128 v[120:123], v145 offset:32768
    ds_read_b64_tr_b16 v[128:129], v148 offset:36864
    ds_read_b64_tr_b16 v[130:131], v148 offset:37376
    ds_read_b128 v[124:127], v145 offset:36864
    v_mfma_f32_32x32x16_bf16 v[56:71], v[92:95], v[96:99], v[56:71]
    s_waitcnt lgkmcnt(4)
    v_mfma_f32_32x32x16_bf16 v[8:23], v[104:107], v[112:115], v[8:23]
    ds_read_b128 v[88:91], v146 offset:32768
    ds_read_b64_tr_b16 v[96:97], v148 offset:40960
    ds_read_b64_tr_b16 v[98:99], v148 offset:41472
    ds_read_b128 v[92:95], v146 offset:36864
    v_mfma_f32_32x32x16_bf16 v[56:71], v[108:111], v[112:115], v[56:71]
    s_waitcnt lgkmcnt(4)
    v_mfma_f32_32x32x16_bf16 v[8:23], v[120:123], v[128:131], v[8:23]
    ds_read_b128 v[104:107], v147 offset:32768
    ds_read_b64_tr_b16 v[112:113], v148 offset:45056
    ds_read_b64_tr_b16 v[114:115], v148 offset:45568
    ds_read_b128 v[108:111], v147 offset:36864
    v_mfma_f32_32x32x16_bf16 v[56:71], v[124:127], v[128:131], v[56:71]
    s_waitcnt lgkmcnt(0)
    s_barrier
    v_mfma_f32_32x32x16_bf16 v[8:23], v[88:91], v[96:99], v[8:23]
    ds_read_b128 v[120:123], v144 offset:49152
    ds_read_b64_tr_b16 v[128:129], v148 offset:49152
    ds_read_b64_tr_b16 v[130:131], v148 offset:49664
    ds_read_b128 v[124:127], v144 offset:53248
    v_mfma_f32_32x32x16_bf16 v[56:71], v[92:95], v[96:99], v[56:71]
    v_mfma_f32_32x32x16_bf16 v[8:23], v[104:107], v[112:115], v[8:23]
    ds_read_b128 v[88:91], v145 offset:49152
    ds_read_b64_tr_b16 v[96:97], v148 offset:53248
    ds_read_b64_tr_b16 v[98:99], v148 offset:53760
    ds_read_b128 v[92:95], v145 offset:53248
    v_mfma_f32_32x32x16_bf16 v[56:71], v[108:111], v[112:115], v[56:71]
    s_waitcnt lgkmcnt(4)
    v_mfma_f32_32x32x16_bf16 v[8:23], v[120:123], v[128:131], v[8:23]
    ds_read_b128 v[104:107], v146 offset:49152
    ds_read_b64_tr_b16 v[112:113], v148 offset:57344
    ds_read_b64_tr_b16 v[114:115], v148 offset:57856
    ds_read_b128 v[108:111], v146 offset:53248
    v_mfma_f32_32x32x16_bf16 v[56:71], v[124:127], v[128:131], v[56:71]
    ds_read_b64 v[152:153], v7 offset:2048
    ds_read_b128 v[160:163], v6 offset:0
    ds_read_b128 v[164:167], v6 offset:512
    s_waitcnt lgkmcnt(7)
    v_mfma_f32_32x32x16_bf16 v[8:23], v[88:91], v[96:99], v[8:23]
    ds_read_b128 v[120:123], v147 offset:49152
    ds_read_b64_tr_b16 v[128:129], v148 offset:61440
    ds_read_b64_tr_b16 v[130:131], v148 offset:61952
    ds_read_b128 v[124:127], v147 offset:53248
    v_mfma_f32_32x32x16_bf16 v[56:71], v[92:95], v[96:99], v[56:71]
    s_waitcnt lgkmcnt(0)
    s_barrier
    v_mfma_f32_32x32x16_bf16 v[8:23], v[104:107], v[112:115], v[8:23]
    ds_read_b128 v[24:27], v0 offset:4096
    ds_read_b128 v[28:31], v0 offset:4128
    ds_read_b128 v[32:35], v0 offset:4160
    ds_read_b128 v[36:39], v0 offset:4192
    v_cvt_pk_bf16_f32 v154, v152, v152
    v_mov_b32 v42, 0
    v_and_b32 v154, 0xffff0000, v154
    v_sub_f32 v154, v152, v154
    v_cvt_pk_bf16_f32 v40, v152, v154
    v_mov_b32 v43, 0
    v_mov_b32 v41, v40
    v_mfma_f32_32x32x16_bf16 v[56:71], v[108:111], v[112:115], v[56:71]
    ds_read_b128 v[72:75], v0 offset:4224
    ds_read_b128 v[76:79], v0 offset:4256
    ds_read_b128 v[80:83], v0 offset:4288
    ds_read_b128 v[84:87], v0 offset:4320
    v_mov_b32 v48, v160
    v_mov_b32 v49, v161
    v_mov_b32 v50, 0
    v_mov_b32 v51, 0
    v_mov_b32 v52, v164
    v_mov_b32 v53, v165
    v_mov_b32 v54, 0
    v_mov_b32 v55, 0
    v_mfma_f32_32x32x16_bf16 v[8:23], v[120:123], v[128:131], v[8:23]
    ds_read_b128 v[104:107], v144 offset:0
    ds_read_b64_tr_b16 v[112:113], v148 offset:0
    ds_read_b64_tr_b16 v[114:115], v148 offset:512
    ds_read_b128 v[108:111], v144 offset:4096
    v_mul_f32 v150, 0x3eb8aa3b, v162
    v_mul_f32 v151, 0x3eb8aa3b, v166
    v_mov_b32 v156, s61
    v_bfe_u32 v136, v2, 4, 1
    v_mfma_f32_32x32x16_bf16 v[56:71], v[124:127], v[128:131], v[56:71]
    ds_read_b64_tr_b16 v[116:117], v148 offset:2048
    ds_read_b64_tr_b16 v[118:119], v148 offset:2560
    v_lshlrev_b32 v136, 16, v136
    v_lshl_add_u32 v136, v4, 8, v136
    v_and_b32 v137, 15, v2
    v_lshl_add_u32 v136, v137, 4, v136
    v_mfma_f32_32x32x16_bf16 v[8:23], v[48:51], v[40:43], v[8:23]
    v_mfma_f32_32x32x16_bf16 v[56:71], v[52:55], v[40:43], v[56:71]
    ds_read_b128 v[120:123], v145 offset:0
    ds_read_b64_tr_b16 v[128:129], v148 offset:4096
    ds_read_b64_tr_b16 v[130:131], v148 offset:4608
    ds_read_b128 v[124:127], v145 offset:4096
    ds_read_b64_tr_b16 v[132:133], v148 offset:6144
    ds_read_b64_tr_b16 v[134:135], v148 offset:6656
    s_waitcnt lgkmcnt(12)
    s_add_u32 s38, s39, 4194304
    s_nop 9
    v_pk_mul_f32 v[8:9], v[8:9], v[24:25]
    v_pk_mul_f32 v[10:11], v[10:11], v[26:27]
    v_pk_mul_f32 v[12:13], v[12:13], v[28:29]
    v_pk_mul_f32 v[14:15], v[14:15], v[30:31]
    v_cvt_pk_bf16_f32 v8, v8, v9
    v_cvt_pk_bf16_f32 v9, v10, v11
    v_cvt_pk_bf16_f32 v10, v12, v13
    v_cvt_pk_bf16_f32 v11, v14, v15
    buffer_store_dwordx4 v[8:11], v136, s[28:31], s38 offen offset:0 sc1
    v_pk_mul_f32 v[16:17], v[16:17], v[32:33]
    v_pk_mul_f32 v[18:19], v[18:19], v[34:35]
    v_pk_mul_f32 v[20:21], v[20:21], v[36:37]
    v_pk_mul_f32 v[22:23], v[22:23], v[38:39]
    v_cvt_pk_bf16_f32 v16, v16, v17
    v_cvt_pk_bf16_f32 v17, v18, v19
    v_cvt_pk_bf16_f32 v18, v20, v21
    v_cvt_pk_bf16_f32 v19, v22, v23
    buffer_store_dwordx4 v[16:19], v136, s[28:31], s38 offen offset:512 sc1
    v_pk_mul_f32 v[56:57], v[56:57], v[72:73]
    v_pk_mul_f32 v[58:59], v[58:59], v[74:75]
    v_pk_mul_f32 v[60:61], v[60:61], v[76:77]
    v_pk_mul_f32 v[62:63], v[62:63], v[78:79]
    v_cvt_pk_bf16_f32 v56, v56, v57
    v_cvt_pk_bf16_f32 v57, v58, v59
    v_cvt_pk_bf16_f32 v58, v60, v61
    v_cvt_pk_bf16_f32 v59, v62, v63
    buffer_store_dwordx4 v[56:59], v136, s[28:31], s38 offen offset:1024 sc1
    v_pk_mul_f32 v[64:65], v[64:65], v[80:81]
    v_pk_mul_f32 v[66:67], v[66:67], v[82:83]
    v_pk_mul_f32 v[68:69], v[68:69], v[84:85]
    v_pk_mul_f32 v[70:71], v[70:71], v[86:87]
    v_cvt_pk_bf16_f32 v64, v64, v65
    v_cvt_pk_bf16_f32 v65, v66, v67
    v_cvt_pk_bf16_f32 v66, v68, v69
    v_cvt_pk_bf16_f32 v67, v70, v71
    buffer_store_dwordx4 v[64:67], v136, s[28:31], s38 offen offset:1536 sc1
    s_waitcnt lgkmcnt(6)
    v_mfma_f32_32x32x16_bf16 v[24:39], v[112:115], v[104:107], 0
    ds_read_b128 v[8:11], v146 offset:0
    ds_read_b64_tr_b16 v[16:17], v148 offset:8192
    ds_read_b64_tr_b16 v[18:19], v148 offset:8704
    v_mfma_f32_32x32x16_bf16 v[72:87], v[112:115], v[108:111], 0
    ds_read_b128 v[12:15], v146 offset:4096
    ds_read_b64_tr_b16 v[20:21], v148 offset:10240
    ds_read_b64_tr_b16 v[22:23], v148 offset:10752
    v_mfma_f32_32x32x16_bf16 v[40:55], v[116:119], v[104:107], 0
    v_mfma_f32_32x32x16_bf16 v[88:103], v[116:119], v[108:111], 0
    s_waitcnt lgkmcnt(6)
    v_mfma_f32_32x32x16_bf16 v[24:39], v[128:131], v[120:123], v[24:39]
    ds_read_b128 v[104:107], v147 offset:0
    ds_read_b64_tr_b16 v[112:113], v148 offset:12288
    ds_read_b64_tr_b16 v[114:115], v148 offset:12800
    v_mfma_f32_32x32x16_bf16 v[72:87], v[128:131], v[124:127], v[72:87]
    ds_read_b128 v[108:111], v147 offset:4096
    ds_read_b64_tr_b16 v[116:117], v148 offset:14336
    ds_read_b64_tr_b16 v[118:119], v148 offset:14848
    v_mfma_f32_32x32x16_bf16 v[40:55], v[132:135], v[120:123], v[40:55]
    v_mfma_f32_32x32x16_bf16 v[88:103], v[132:135], v[124:127], v[88:103]
    s_waitcnt lgkmcnt(6)
    v_mfma_f32_32x32x16_bf16 v[24:39], v[16:19], v[8:11], v[24:39]
    ds_read_b128 v[120:123], v144 offset:16384
    ds_read_b64_tr_b16 v[128:129], v148 offset:16384
    ds_read_b64_tr_b16 v[130:131], v148 offset:16896
    v_mfma_f32_32x32x16_bf16 v[72:87], v[16:19], v[12:15], v[72:87]
    ds_read_b128 v[124:127], v144 offset:20480
    ds_read_b64_tr_b16 v[132:133], v148 offset:18432
    ds_read_b64_tr_b16 v[134:135], v148 offset:18944
    v_mfma_f32_32x32x16_bf16 v[40:55], v[20:23], v[8:11], v[40:55]
    v_mfma_f32_32x32x16_bf16 v[88:103], v[20:23], v[12:15], v[88:103]
    s_waitcnt lgkmcnt(6)
    v_mfma_f32_32x32x16_bf16 v[24:39], v[112:115], v[104:107], v[24:39]
    ds_read_b128 v[8:11], v145 offset:16384
    ds_read_b64_tr_b16 v[16:17], v148 offset:20480
    ds_read_b64_tr_b16 v[18:19], v148 offset:20992
    v_mfma_f32_32x32x16_bf16 v[72:87], v[112:115], v[108:111], v[72:87]
    ds_read_b128 v[12:15], v145 offset:20480
    ds_read_b64_tr_b16 v[20:21], v148 offset:22528
    ds_read_b64_tr_b16 v[22:23], v148 offset:23040
    v_mfma_f32_32x32x16_bf16 v[40:55], v[116:119], v[104:107], v[40:55]
    v_mfma_f32_32x32x16_bf16 v[88:103], v[116:119], v[108:111], v[88:103]
    s_waitcnt lgkmcnt(6)
    v_mfma_f32_32x32x16_bf16 v[24:39], v[128:131], v[120:123], v[24:39]
    ds_read_b128 v[104:107], v146 offset:16384
    ds_read_b64_tr_b16 v[112:113], v148 offset:24576
    ds_read_b64_tr_b16 v[114:115], v148 offset:25088
    v_mfma_f32_32x32x16_bf16 v[72:87], v[128:131], v[124:127], v[72:87]
    ds_read_b128 v[108:111], v146 offset:20480
    ds_read_b64_tr_b16 v[116:117], v148 offset:26624
    ds_read_b64_tr_b16 v[118:119], v148 offset:27136
    s_waitcnt vmcnt(0)
    v_mfma_f32_32x32x16_bf16 v[40:55], v[132:135], v[120:123], v[40:55]
    v_mfma_f32_32x32x16_bf16 v[88:103], v[132:135], v[124:127], v[88:103]
    buffer_store_dword v156, off, s[28:31], s19 sc1
    s_waitcnt lgkmcnt(6)
    v_mfma_f32_32x32x16_bf16 v[24:39], v[16:19], v[8:11], v[24:39]
    ds_read_b128 v[120:123], v147 offset:16384
    ds_read_b64_tr_b16 v[128:129], v148 offset:28672
    ds_read_b64_tr_b16 v[130:131], v148 offset:29184
    v_mfma_f32_32x32x16_bf16 v[72:87], v[16:19], v[12:15], v[72:87]
    ds_read_b128 v[124:127], v147 offset:20480
    ds_read_b64_tr_b16 v[132:133], v148 offset:30720
    ds_read_b64_tr_b16 v[134:135], v148 offset:31232
    v_mfma_f32_32x32x16_bf16 v[40:55], v[20:23], v[8:11], v[40:55]
    v_mfma_f32_32x32x16_bf16 v[88:103], v[20:23], v[12:15], v[88:103]
    s_waitcnt lgkmcnt(0)
    s_barrier
    v_mfma_f32_32x32x16_bf16 v[24:39], v[112:115], v[104:107], v[24:39]
    ds_read_b128 v[8:11], v144 offset:32768
    ds_read_b64_tr_b16 v[16:17], v148 offset:32768
    ds_read_b64_tr_b16 v[18:19], v148 offset:33280
    v_mfma_f32_32x32x16_bf16 v[72:87], v[112:115], v[108:111], v[72:87]
    ds_read_b128 v[12:15], v144 offset:36864
    ds_read_b64_tr_b16 v[20:21], v148 offset:34816
    ds_read_b64_tr_b16 v[22:23], v148 offset:35328
    v_mfma_f32_32x32x16_bf16 v[40:55], v[116:119], v[104:107], v[40:55]
    v_mfma_f32_32x32x16_bf16 v[88:103], v[116:119], v[108:111], v[88:103]
    v_mfma_f32_32x32x16_bf16 v[24:39], v[128:131], v[120:123], v[24:39]
    ds_read_b128 v[104:107], v145 offset:32768
    ds_read_b64_tr_b16 v[112:113], v148 offset:36864
    ds_read_b64_tr_b16 v[114:115], v148 offset:37376
    v_mfma_f32_32x32x16_bf16 v[72:87], v[128:131], v[124:127], v[72:87]
    ds_read_b128 v[108:111], v145 offset:36864
    ds_read_b64_tr_b16 v[116:117], v148 offset:38912
    ds_read_b64_tr_b16 v[118:119], v148 offset:39424
    v_mfma_f32_32x32x16_bf16 v[40:55], v[132:135], v[120:123], v[40:55]
    v_mfma_f32_32x32x16_bf16 v[88:103], v[132:135], v[124:127], v[88:103]
    s_waitcnt lgkmcnt(6)
    v_mfma_f32_32x32x16_bf16 v[24:39], v[16:19], v[8:11], v[24:39]
    ds_read_b128 v[120:123], v146 offset:32768
    ds_read_b64_tr_b16 v[128:129], v148 offset:40960
    ds_read_b64_tr_b16 v[130:131], v148 offset:41472
    v_mfma_f32_32x32x16_bf16 v[72:87], v[16:19], v[12:15], v[72:87]
    ds_read_b128 v[124:127], v146 offset:36864
    ds_read_b64_tr_b16 v[132:133], v148 offset:43008
    ds_read_b64_tr_b16 v[134:135], v148 offset:43520
    v_mfma_f32_32x32x16_bf16 v[40:55], v[20:23], v[8:11], v[40:55]
    v_mfma_f32_32x32x16_bf16 v[88:103], v[20:23], v[12:15], v[88:103]
    s_waitcnt lgkmcnt(6)
    v_mfma_f32_32x32x16_bf16 v[24:39], v[112:115], v[104:107], v[24:39]
    ds_read_b128 v[8:11], v147 offset:32768
    ds_read_b64_tr_b16 v[16:17], v148 offset:45056
    ds_read_b64_tr_b16 v[18:19], v148 offset:45568
    v_mfma_f32_32x32x16_bf16 v[72:87], v[112:115], v[108:111], v[72:87]
    ds_read_b128 v[12:15], v147 offset:36864
    ds_read_b64_tr_b16 v[20:21], v148 offset:47104
    ds_read_b64_tr_b16 v[22:23], v148 offset:47616
    v_mfma_f32_32x32x16_bf16 v[40:55], v[116:119], v[104:107], v[40:55]
    v_mfma_f32_32x32x16_bf16 v[88:103], v[116:119], v[108:111], v[88:103]
    s_waitcnt lgkmcnt(6)
    v_mfma_f32_32x32x16_bf16 v[24:39], v[128:131], v[120:123], v[24:39]
    ds_read_b128 v[104:107], v144 offset:49152
    ds_read_b64_tr_b16 v[112:113], v148 offset:49152
    ds_read_b64_tr_b16 v[114:115], v148 offset:49664
    v_mfma_f32_32x32x16_bf16 v[72:87], v[128:131], v[124:127], v[72:87]
    ds_read_b128 v[108:111], v144 offset:53248
    ds_read_b64_tr_b16 v[116:117], v148 offset:51200
    ds_read_b64_tr_b16 v[118:119], v148 offset:51712
    v_mfma_f32_32x32x16_bf16 v[40:55], v[132:135], v[120:123], v[40:55]
    v_mfma_f32_32x32x16_bf16 v[88:103], v[132:135], v[124:127], v[88:103]
    s_waitcnt lgkmcnt(6)
    v_mfma_f32_32x32x16_bf16 v[24:39], v[16:19], v[8:11], v[24:39]
    ds_read_b128 v[120:123], v145 offset:49152
    ds_read_b64_tr_b16 v[128:129], v148 offset:53248
    ds_read_b64_tr_b16 v[130:131], v148 offset:53760
    v_mfma_f32_32x32x16_bf16 v[72:87], v[16:19], v[12:15], v[72:87]
    ds_read_b128 v[124:127], v145 offset:53248
    ds_read_b64_tr_b16 v[132:133], v148 offset:55296
    ds_read_b64_tr_b16 v[134:135], v148 offset:55808
    v_mfma_f32_32x32x16_bf16 v[40:55], v[20:23], v[8:11], v[40:55]
    v_mfma_f32_32x32x16_bf16 v[88:103], v[20:23], v[12:15], v[88:103]
    s_waitcnt lgkmcnt(6)
    v_mfma_f32_32x32x16_bf16 v[24:39], v[112:115], v[104:107], v[24:39]
    ds_read_b128 v[8:11], v146 offset:49152
    ds_read_b64_tr_b16 v[16:17], v148 offset:57344
    ds_read_b64_tr_b16 v[18:19], v148 offset:57856
    v_mfma_f32_32x32x16_bf16 v[72:87], v[112:115], v[108:111], v[72:87]
    ds_read_b128 v[12:15], v146 offset:53248
    ds_read_b64_tr_b16 v[20:21], v148 offset:59392
    ds_read_b64_tr_b16 v[22:23], v148 offset:59904
    v_mfma_f32_32x32x16_bf16 v[40:55], v[116:119], v[104:107], v[40:55]
    v_mfma_f32_32x32x16_bf16 v[88:103], v[116:119], v[108:111], v[88:103]
    s_waitcnt lgkmcnt(6)
    v_mfma_f32_32x32x16_bf16 v[24:39], v[128:131], v[120:123], v[24:39]
    ds_read_b128 v[104:107], v147 offset:49152
    ds_read_b64_tr_b16 v[112:113], v148 offset:61440
    ds_read_b64_tr_b16 v[114:115], v148 offset:61952
    v_mfma_f32_32x32x16_bf16 v[72:87], v[128:131], v[124:127], v[72:87]
    ds_read_b128 v[108:111], v147 offset:53248
    ds_read_b64_tr_b16 v[116:117], v148 offset:63488
    ds_read_b64_tr_b16 v[118:119], v148 offset:64000
    v_mfma_f32_32x32x16_bf16 v[40:55], v[132:135], v[120:123], v[40:55]
    v_mfma_f32_32x32x16_bf16 v[88:103], v[132:135], v[124:127], v[88:103]
    s_waitcnt lgkmcnt(0)
    s_barrier
    v_mfma_f32_32x32x16_bf16 v[24:39], v[16:19], v[8:11], v[24:39]
    ds_read_b128 v[120:123], v144 offset:0
    ds_read_b64_tr_b16 v[128:129], v148 offset:0
    ds_read_b64_tr_b16 v[130:131], v148 offset:512
    v_mfma_f32_32x32x16_bf16 v[72:87], v[16:19], v[12:15], v[72:87]
    ds_read_b128 v[124:127], v144 offset:4096
    ds_read_b64_tr_b16 v[132:133], v148 offset:2048
    ds_read_b64_tr_b16 v[134:135], v148 offset:2560
    v_mfma_f32_32x32x16_bf16 v[40:55], v[20:23], v[8:11], v[40:55]
    v_mfma_f32_32x32x16_bf16 v[88:103], v[20:23], v[12:15], v[88:103]
    v_mfma_f32_32x32x16_bf16 v[24:39], v[112:115], v[104:107], v[24:39]
    ds_read_b128 v[8:11], v145 offset:0
    ds_read_b64_tr_b16 v[16:17], v148 offset:4096
    ds_read_b64_tr_b16 v[18:19], v148 offset:4608
    v_mfma_f32_32x32x16_bf16 v[72:87], v[112:115], v[108:111], v[72:87]
    ds_read_b128 v[12:15], v145 offset:4096
    ds_read_b64_tr_b16 v[20:21], v148 offset:6144
    ds_read_b64_tr_b16 v[22:23], v148 offset:6656
    v_mfma_f32_32x32x16_bf16 v[40:55], v[116:119], v[104:107], v[40:55]
    v_mfma_f32_32x32x16_bf16 v[88:103], v[116:119], v[108:111], v[88:103]
    s_waitcnt lgkmcnt(6)
    v_mfma_f32_32x32x16_bf16 v[24:39], v[128:131], v[120:123], v[24:39]
    ds_read_b128 v[104:107], v146 offset:0
    ds_read_b64_tr_b16 v[112:113], v148 offset:8192
    ds_read_b64_tr_b16 v[114:115], v148 offset:8704
    v_mfma_f32_32x32x16_bf16 v[72:87], v[128:131], v[124:127], v[72:87]
    ds_read_b128 v[108:111], v146 offset:4096
    ds_read_b64_tr_b16 v[116:117], v148 offset:10240
    ds_read_b64_tr_b16 v[118:119], v148 offset:10752
    v_mfma_f32_32x32x16_bf16 v[40:55], v[132:135], v[120:123], v[40:55]
    v_mfma_f32_32x32x16_bf16 v[88:103], v[132:135], v[124:127], v[88:103]
    s_waitcnt lgkmcnt(6)
    v_mfma_f32_32x32x16_bf16 v[24:39], v[16:19], v[8:11], v[24:39]
    ds_read_b128 v[120:123], v147 offset:0
    ds_read_b64_tr_b16 v[128:129], v148 offset:12288
    ds_read_b64_tr_b16 v[130:131], v148 offset:12800
    v_mfma_f32_32x32x16_bf16 v[72:87], v[16:19], v[12:15], v[72:87]
    ds_read_b128 v[124:127], v147 offset:4096
    ds_read_b64_tr_b16 v[132:133], v148 offset:14336
    ds_read_b64_tr_b16 v[134:135], v148 offset:14848
    v_mfma_f32_32x32x16_bf16 v[40:55], v[20:23], v[8:11], v[40:55]
    v_mfma_f32_32x32x16_bf16 v[88:103], v[20:23], v[12:15], v[88:103]
    s_waitcnt lgkmcnt(6)
    v_mfma_f32_32x32x16_bf16 v[24:39], v[112:115], v[104:107], v[24:39]
    ds_read_b128 v[8:11], v144 offset:16384
    ds_read_b64_tr_b16 v[16:17], v148 offset:16384
    ds_read_b64_tr_b16 v[18:19], v148 offset:16896
    v_mfma_f32_32x32x16_bf16 v[72:87], v[112:115], v[108:111], v[72:87]
    ds_read_b128 v[12:15], v144 offset:20480
    ds_read_b64_tr_b16 v[20:21], v148 offset:18432
    ds_read_b64_tr_b16 v[22:23], v148 offset:18944
    v_mfma_f32_32x32x16_bf16 v[40:55], v[116:119], v[104:107], v[40:55]
    v_mfma_f32_32x32x16_bf16 v[88:103], v[116:119], v[108:111], v[88:103]
    s_waitcnt lgkmcnt(6)
    v_mfma_f32_32x32x16_bf16 v[24:39], v[128:131], v[120:123], v[24:39]
    ds_read_b128 v[104:107], v145 offset:16384
    ds_read_b64_tr_b16 v[112:113], v148 offset:20480
    ds_read_b64_tr_b16 v[114:115], v148 offset:20992
    v_mfma_f32_32x32x16_bf16 v[72:87], v[128:131], v[124:127], v[72:87]
    ds_read_b128 v[108:111], v145 offset:20480
    ds_read_b64_tr_b16 v[116:117], v148 offset:22528
    ds_read_b64_tr_b16 v[118:119], v148 offset:23040
    v_mfma_f32_32x32x16_bf16 v[40:55], v[132:135], v[120:123], v[40:55]
    v_mfma_f32_32x32x16_bf16 v[88:103], v[132:135], v[124:127], v[88:103]
    s_waitcnt lgkmcnt(6)
    v_mfma_f32_32x32x16_bf16 v[24:39], v[16:19], v[8:11], v[24:39]
    ds_read_b128 v[120:123], v146 offset:16384
    ds_read_b64_tr_b16 v[128:129], v148 offset:24576
    ds_read_b64_tr_b16 v[130:131], v148 offset:25088
    v_mfma_f32_32x32x16_bf16 v[72:87], v[16:19], v[12:15], v[72:87]
    ds_read_b128 v[124:127], v146 offset:20480
    ds_read_b64_tr_b16 v[132:133], v148 offset:26624
    ds_read_b64_tr_b16 v[134:135], v148 offset:27136
    v_mfma_f32_32x32x16_bf16 v[40:55], v[20:23], v[8:11], v[40:55]
    v_mfma_f32_32x32x16_bf16 v[88:103], v[20:23], v[12:15], v[88:103]
    s_waitcnt lgkmcnt(6)
    v_mfma_f32_32x32x16_bf16 v[24:39], v[112:115], v[104:107], v[24:39]
    ds_read_b128 v[8:11], v147 offset:16384
    ds_read_b64_tr_b16 v[16:17], v148 offset:28672
    ds_read_b64_tr_b16 v[18:19], v148 offset:29184
    v_mfma_f32_32x32x16_bf16 v[72:87], v[112:115], v[108:111], v[72:87]
    ds_read_b128 v[12:15], v147 offset:20480
    ds_read_b64_tr_b16 v[20:21], v148 offset:30720
    ds_read_b64_tr_b16 v[22:23], v148 offset:31232
    v_mfma_f32_32x32x16_bf16 v[40:55], v[116:119], v[104:107], v[40:55]
    v_mfma_f32_32x32x16_bf16 v[88:103], v[116:119], v[108:111], v[88:103]
    s_waitcnt lgkmcnt(0)
    s_barrier
    v_mfma_f32_32x32x16_bf16 v[24:39], v[128:131], v[120:123], v[24:39]
    ds_read_b128 v[104:107], v144 offset:32768
    ds_read_b64_tr_b16 v[112:113], v148 offset:32768
    ds_read_b64_tr_b16 v[114:115], v148 offset:33280
    v_mfma_f32_32x32x16_bf16 v[72:87], v[128:131], v[124:127], v[72:87]
    ds_read_b128 v[108:111], v144 offset:36864
    ds_read_b64_tr_b16 v[116:117], v148 offset:34816
    ds_read_b64_tr_b16 v[118:119], v148 offset:35328
    v_mfma_f32_32x32x16_bf16 v[40:55], v[132:135], v[120:123], v[40:55]
    v_mfma_f32_32x32x16_bf16 v[88:103], v[132:135], v[124:127], v[88:103]
    v_mfma_f32_32x32x16_bf16 v[24:39], v[16:19], v[8:11], v[24:39]
    ds_read_b128 v[120:123], v145 offset:32768
    ds_read_b64_tr_b16 v[128:129], v148 offset:36864
    ds_read_b64_tr_b16 v[130:131], v148 offset:37376
    v_mfma_f32_32x32x16_bf16 v[72:87], v[16:19], v[12:15], v[72:87]
    ds_read_b128 v[124:127], v145 offset:36864
    ds_read_b64_tr_b16 v[132:133], v148 offset:38912
    ds_read_b64_tr_b16 v[134:135], v148 offset:39424
    v_mfma_f32_32x32x16_bf16 v[40:55], v[20:23], v[8:11], v[40:55]
    v_mfma_f32_32x32x16_bf16 v[88:103], v[20:23], v[12:15], v[88:103]
    s_waitcnt lgkmcnt(6)
    v_mfma_f32_32x32x16_bf16 v[24:39], v[112:115], v[104:107], v[24:39]
    ds_read_b128 v[8:11], v146 offset:32768
    ds_read_b64_tr_b16 v[16:17], v148 offset:40960
    ds_read_b64_tr_b16 v[18:19], v148 offset:41472
    v_mfma_f32_32x32x16_bf16 v[72:87], v[112:115], v[108:111], v[72:87]
    ds_read_b128 v[12:15], v146 offset:36864
    ds_read_b64_tr_b16 v[20:21], v148 offset:43008
    ds_read_b64_tr_b16 v[22:23], v148 offset:43520
    v_mfma_f32_32x32x16_bf16 v[40:55], v[116:119], v[104:107], v[40:55]
    v_mfma_f32_32x32x16_bf16 v[88:103], v[116:119], v[108:111], v[88:103]
    s_waitcnt lgkmcnt(6)
    v_mfma_f32_32x32x16_bf16 v[24:39], v[128:131], v[120:123], v[24:39]
    ds_read_b128 v[104:107], v147 offset:32768
    ds_read_b64_tr_b16 v[112:113], v148 offset:45056
    ds_read_b64_tr_b16 v[114:115], v148 offset:45568
    v_mfma_f32_32x32x16_bf16 v[72:87], v[128:131], v[124:127], v[72:87]
    ds_read_b128 v[108:111], v147 offset:36864
    ds_read_b64_tr_b16 v[116:117], v148 offset:47104
    ds_read_b64_tr_b16 v[118:119], v148 offset:47616
    v_mfma_f32_32x32x16_bf16 v[40:55], v[132:135], v[120:123], v[40:55]
    v_mfma_f32_32x32x16_bf16 v[88:103], v[132:135], v[124:127], v[88:103]
    s_waitcnt lgkmcnt(6)
    v_mfma_f32_32x32x16_bf16 v[24:39], v[16:19], v[8:11], v[24:39]
    ds_read_b128 v[120:123], v144 offset:49152
    ds_read_b64_tr_b16 v[128:129], v148 offset:49152
    ds_read_b64_tr_b16 v[130:131], v148 offset:49664
    v_mfma_f32_32x32x16_bf16 v[72:87], v[16:19], v[12:15], v[72:87]
    ds_read_b128 v[124:127], v144 offset:53248
    ds_read_b64_tr_b16 v[132:133], v148 offset:51200
    ds_read_b64_tr_b16 v[134:135], v148 offset:51712
    v_mfma_f32_32x32x16_bf16 v[40:55], v[20:23], v[8:11], v[40:55]
    v_mfma_f32_32x32x16_bf16 v[88:103], v[20:23], v[12:15], v[88:103]
    s_waitcnt lgkmcnt(6)
    v_mfma_f32_32x32x16_bf16 v[24:39], v[112:115], v[104:107], v[24:39]
    ds_read_b128 v[8:11], v145 offset:49152
    ds_read_b64_tr_b16 v[16:17], v148 offset:53248
    ds_read_b64_tr_b16 v[18:19], v148 offset:53760
    v_mfma_f32_32x32x16_bf16 v[72:87], v[112:115], v[108:111], v[72:87]
    ds_read_b128 v[12:15], v145 offset:53248
    ds_read_b64_tr_b16 v[20:21], v148 offset:55296
    ds_read_b64_tr_b16 v[22:23], v148 offset:55808
    v_mfma_f32_32x32x16_bf16 v[40:55], v[116:119], v[104:107], v[40:55]
    v_mfma_f32_32x32x16_bf16 v[88:103], v[116:119], v[108:111], v[88:103]
    s_waitcnt lgkmcnt(6)
    v_mfma_f32_32x32x16_bf16 v[24:39], v[128:131], v[120:123], v[24:39]
    ds_read_b128 v[104:107], v146 offset:49152
    ds_read_b64_tr_b16 v[112:113], v148 offset:57344
    ds_read_b64_tr_b16 v[114:115], v148 offset:57856
    v_mfma_f32_32x32x16_bf16 v[72:87], v[128:131], v[124:127], v[72:87]
    ds_read_b128 v[108:111], v146 offset:53248
    ds_read_b64_tr_b16 v[116:117], v148 offset:59392
    ds_read_b64_tr_b16 v[118:119], v148 offset:59904
    v_mfma_f32_32x32x16_bf16 v[40:55], v[132:135], v[120:123], v[40:55]
    ds_read_b64 v[152:153], v7 offset:3072
    v_mfma_f32_32x32x16_bf16 v[88:103], v[132:135], v[124:127], v[88:103]
    s_waitcnt lgkmcnt(7)
    v_mfma_f32_32x32x16_bf16 v[24:39], v[16:19], v[8:11], v[24:39]
    ds_read_b128 v[120:123], v147 offset:49152
    ds_read_b64_tr_b16 v[128:129], v148 offset:61440
    ds_read_b64_tr_b16 v[130:131], v148 offset:61952
    v_mfma_f32_32x32x16_bf16 v[72:87], v[16:19], v[12:15], v[72:87]
    ds_read_b128 v[124:127], v147 offset:53248
    ds_read_b64_tr_b16 v[132:133], v148 offset:63488
    ds_read_b64_tr_b16 v[134:135], v148 offset:64000
    v_mfma_f32_32x32x16_bf16 v[40:55], v[20:23], v[8:11], v[40:55]
    v_mfma_f32_32x32x16_bf16 v[88:103], v[20:23], v[12:15], v[88:103]
    s_waitcnt lgkmcnt(6)
    v_mfma_f32_32x32x16_bf16 v[24:39], v[112:115], v[104:107], v[24:39]
    v_cvt_pk_bf16_f32 v154, v152, v152
    v_mov_b32 v58, 0
    v_and_b32 v154, 0xffff0000, v154
    v_sub_f32 v154, v152, v154
    v_cvt_pk_bf16_f32 v56, v152, v154
    v_mfma_f32_32x32x16_bf16 v[72:87], v[112:115], v[108:111], v[72:87]
    v_mov_b32 v59, 0
    v_mov_b32 v57, v56
    v_cvt_pk_bf16_f32 v154, v153, v153
    v_mov_b32 v62, 0
    v_and_b32 v154, 0xffff0000, v154
    v_sub_f32 v154, v153, v154
    v_mfma_f32_32x32x16_bf16 v[40:55], v[116:119], v[104:107], v[40:55]
    v_cvt_pk_bf16_f32 v60, v153, v154
    v_mov_b32 v63, 0
    v_mov_b32 v61, v60
    v_mov_b32 v64, v160
    v_mov_b32 v65, v161
    v_mfma_f32_32x32x16_bf16 v[88:103], v[116:119], v[108:111], v[88:103]
    v_mov_b32 v66, 0
    v_mov_b32 v67, 0
    v_mov_b32 v68, v164
    v_mov_b32 v69, v165
    v_mov_b32 v70, 0
    v_mov_b32 v71, 0
    s_waitcnt lgkmcnt(0)
    s_barrier
    v_mfma_f32_32x32x16_bf16 v[24:39], v[128:131], v[120:123], v[24:39]
    v_mov_b32 v136, v163
    v_mul_f32 v137, 0xc0135761, v162
    v_mfma_f32_32x32x16_bf16 v[72:87], v[128:131], v[124:127], v[72:87]
    v_mul_f32 v138, v162, v162
    v_mul_f32 v138, v138, v137
    v_mul_f32 v138, 0x3d372713, v138
    v_mfma_f32_32x32x16_bf16 v[40:55], v[132:135], v[120:123], v[40:55]
    v_mov_b32 v140, v167
    v_mul_f32 v141, 0xc0135761, v166
    v_mfma_f32_32x32x16_bf16 v[88:103], v[132:135], v[124:127], v[88:103]
    v_mul_f32 v142, v166, v166
    v_mul_f32 v142, v142, v141
    v_mul_f32 v142, 0x3d372713, v142
    s_barrier
    s_setprio 3
    v_mfma_f32_32x32x16_bf16 v[24:39], v[56:59], v[64:67], v[24:39]
    v_mfma_f32_32x32x16_bf16 v[72:87], v[56:59], v[68:71], v[72:87]
    v_mfma_f32_32x32x16_bf16 v[40:55], v[60:63], v[64:67], v[40:55]
    v_mfma_f32_32x32x16_bf16 v[88:103], v[60:63], v[68:71], v[88:103]
    s_nop 8
    v_pk_mul_f32 v[160:161], v[24:25], v[24:25]
    v_pk_mul_f32 v[162:163], v[26:27], v[26:27]
    v_pk_mul_f32 v[164:165], v[28:29], v[28:29]
    v_pk_mul_f32 v[166:167], v[30:31], v[30:31]
    v_pk_fma_f32 v[160:161], v[160:161], v[138:139], v[136:137] op_sel:[0,0,1] op_sel_hi:[1,0,1]
    v_pk_fma_f32 v[162:163], v[162:163], v[138:139], v[136:137] op_sel:[0,0,1] op_sel_hi:[1,0,1]
    v_pk_fma_f32 v[164:165], v[164:165], v[138:139], v[136:137] op_sel:[0,0,1] op_sel_hi:[1,0,1]
    v_pk_fma_f32 v[166:167], v[166:167], v[138:139], v[136:137] op_sel:[0,0,1] op_sel_hi:[1,0,1]
    v_pk_mul_f32 v[160:161], v[160:161], v[24:25]
    v_pk_mul_f32 v[162:163], v[162:163], v[26:27]
    v_pk_mul_f32 v[164:165], v[164:165], v[28:29]
    v_pk_mul_f32 v[166:167], v[166:167], v[30:31]
    v_exp_f32 v160, v160
    v_exp_f32 v161, v161
    v_exp_f32 v162, v162
    v_exp_f32 v163, v163
    v_exp_f32 v164, v164
    v_exp_f32 v165, v165
    v_exp_f32 v166, v166
    v_exp_f32 v167, v167
    v_pk_fma_f32 v[160:161], v[160:161], v[136:137], v[136:137] op_sel_hi:[1,0,0]
    v_pk_fma_f32 v[162:163], v[162:163], v[136:137], v[136:137] op_sel_hi:[1,0,0]
    v_pk_fma_f32 v[164:165], v[164:165], v[136:137], v[136:137] op_sel_hi:[1,0,0]
    v_pk_fma_f32 v[166:167], v[166:167], v[136:137], v[136:137] op_sel_hi:[1,0,0]
    v_rcp_f32 v160, v160
    v_rcp_f32 v161, v161
    v_rcp_f32 v162, v162
    v_rcp_f32 v163, v163
    v_rcp_f32 v164, v164
    v_rcp_f32 v165, v165
    v_rcp_f32 v166, v166
    v_rcp_f32 v167, v167
    v_pk_mul_f32 v[24:25], v[24:25], v[160:161]
    v_pk_mul_f32 v[26:27], v[26:27], v[162:163]
    v_pk_mul_f32 v[28:29], v[28:29], v[164:165]
    v_pk_mul_f32 v[30:31], v[30:31], v[166:167]
    v_pk_mul_f32 v[160:161], v[32:33], v[32:33]
    v_pk_mul_f32 v[162:163], v[34:35], v[34:35]
    v_pk_mul_f32 v[164:165], v[36:37], v[36:37]
    v_pk_mul_f32 v[166:167], v[38:39], v[38:39]
    v_pk_fma_f32 v[160:161], v[160:161], v[138:139], v[136:137] op_sel:[0,0,1] op_sel_hi:[1,0,1]
    v_pk_fma_f32 v[162:163], v[162:163], v[138:139], v[136:137] op_sel:[0,0,1] op_sel_hi:[1,0,1]
    v_pk_fma_f32 v[164:165], v[164:165], v[138:139], v[136:137] op_sel:[0,0,1] op_sel_hi:[1,0,1]
    v_pk_fma_f32 v[166:167], v[166:167], v[138:139], v[136:137] op_sel:[0,0,1] op_sel_hi:[1,0,1]
    v_pk_mul_f32 v[160:161], v[160:161], v[32:33]
    v_pk_mul_f32 v[162:163], v[162:163], v[34:35]
    v_pk_mul_f32 v[164:165], v[164:165], v[36:37]
    v_pk_mul_f32 v[166:167], v[166:167], v[38:39]
    v_exp_f32 v160, v160
    v_exp_f32 v161, v161
    v_exp_f32 v162, v162
    v_exp_f32 v163, v163
    v_exp_f32 v164, v164
    v_exp_f32 v165, v165
    v_exp_f32 v166, v166
    v_exp_f32 v167, v167
    v_pk_fma_f32 v[160:161], v[160:161], v[136:137], v[136:137] op_sel_hi:[1,0,0]
    v_pk_fma_f32 v[162:163], v[162:163], v[136:137], v[136:137] op_sel_hi:[1,0,0]
    v_pk_fma_f32 v[164:165], v[164:165], v[136:137], v[136:137] op_sel_hi:[1,0,0]
    v_pk_fma_f32 v[166:167], v[166:167], v[136:137], v[136:137] op_sel_hi:[1,0,0]
    v_rcp_f32 v160, v160
    v_rcp_f32 v161, v161
    v_rcp_f32 v162, v162
    v_rcp_f32 v163, v163
    v_rcp_f32 v164, v164
    v_rcp_f32 v165, v165
    v_rcp_f32 v166, v166
    v_rcp_f32 v167, v167
    v_pk_mul_f32 v[32:33], v[32:33], v[160:161]
    v_pk_mul_f32 v[34:35], v[34:35], v[162:163]
    v_pk_mul_f32 v[36:37], v[36:37], v[164:165]
    v_pk_mul_f32 v[38:39], v[38:39], v[166:167]
    v_pk_mul_f32 v[160:161], v[72:73], v[72:73]
    v_pk_mul_f32 v[162:163], v[74:75], v[74:75]
    v_pk_mul_f32 v[164:165], v[76:77], v[76:77]
    v_pk_mul_f32 v[166:167], v[78:79], v[78:79]
    v_pk_fma_f32 v[160:161], v[160:161], v[142:143], v[140:141] op_sel:[0,0,1] op_sel_hi:[1,0,1]
    v_pk_fma_f32 v[162:163], v[162:163], v[142:143], v[140:141] op_sel:[0,0,1] op_sel_hi:[1,0,1]
    v_pk_fma_f32 v[164:165], v[164:165], v[142:143], v[140:141] op_sel:[0,0,1] op_sel_hi:[1,0,1]
    v_pk_fma_f32 v[166:167], v[166:167], v[142:143], v[140:141] op_sel:[0,0,1] op_sel_hi:[1,0,1]
    v_pk_mul_f32 v[160:161], v[160:161], v[72:73]
    v_pk_mul_f32 v[162:163], v[162:163], v[74:75]
    v_pk_mul_f32 v[164:165], v[164:165], v[76:77]
    v_pk_mul_f32 v[166:167], v[166:167], v[78:79]
    v_exp_f32 v160, v160
    v_exp_f32 v161, v161
    v_exp_f32 v162, v162
    v_exp_f32 v163, v163
    v_exp_f32 v164, v164
    v_exp_f32 v165, v165
    v_exp_f32 v166, v166
    v_exp_f32 v167, v167
    v_pk_fma_f32 v[160:161], v[160:161], v[140:141], v[140:141] op_sel_hi:[1,0,0]
    v_pk_fma_f32 v[162:163], v[162:163], v[140:141], v[140:141] op_sel_hi:[1,0,0]
    v_pk_fma_f32 v[164:165], v[164:165], v[140:141], v[140:141] op_sel_hi:[1,0,0]
    v_pk_fma_f32 v[166:167], v[166:167], v[140:141], v[140:141] op_sel_hi:[1,0,0]
    v_rcp_f32 v160, v160
    v_rcp_f32 v161, v161
    v_rcp_f32 v162, v162
    v_rcp_f32 v163, v163
    v_rcp_f32 v164, v164
    v_rcp_f32 v165, v165
    v_rcp_f32 v166, v166
    v_rcp_f32 v167, v167
    v_pk_mul_f32 v[72:73], v[72:73], v[160:161]
    v_pk_mul_f32 v[74:75], v[74:75], v[162:163]
    v_pk_mul_f32 v[76:77], v[76:77], v[164:165]
    v_pk_mul_f32 v[78:79], v[78:79], v[166:167]
    v_pk_mul_f32 v[160:161], v[80:81], v[80:81]
    v_pk_mul_f32 v[162:163], v[82:83], v[82:83]
    v_pk_mul_f32 v[164:165], v[84:85], v[84:85]
    v_pk_mul_f32 v[166:167], v[86:87], v[86:87]
    v_pk_fma_f32 v[160:161], v[160:161], v[142:143], v[140:141] op_sel:[0,0,1] op_sel_hi:[1,0,1]
    v_pk_fma_f32 v[162:163], v[162:163], v[142:143], v[140:141] op_sel:[0,0,1] op_sel_hi:[1,0,1]
    v_pk_fma_f32 v[164:165], v[164:165], v[142:143], v[140:141] op_sel:[0,0,1] op_sel_hi:[1,0,1]
    v_pk_fma_f32 v[166:167], v[166:167], v[142:143], v[140:141] op_sel:[0,0,1] op_sel_hi:[1,0,1]
    v_pk_mul_f32 v[160:161], v[160:161], v[80:81]
    v_pk_mul_f32 v[162:163], v[162:163], v[82:83]
    v_pk_mul_f32 v[164:165], v[164:165], v[84:85]
    v_pk_mul_f32 v[166:167], v[166:167], v[86:87]
    v_exp_f32 v160, v160
    v_exp_f32 v161, v161
    v_exp_f32 v162, v162
    v_exp_f32 v163, v163
    v_exp_f32 v164, v164
    v_exp_f32 v165, v165
    v_exp_f32 v166, v166
    v_exp_f32 v167, v167
    v_pk_fma_f32 v[160:161], v[160:161], v[140:141], v[140:141] op_sel_hi:[1,0,0]
    v_pk_fma_f32 v[162:163], v[162:163], v[140:141], v[140:141] op_sel_hi:[1,0,0]
    v_pk_fma_f32 v[164:165], v[164:165], v[140:141], v[140:141] op_sel_hi:[1,0,0]
    v_pk_fma_f32 v[166:167], v[166:167], v[140:141], v[140:141] op_sel_hi:[1,0,0]
    v_rcp_f32 v160, v160
    v_rcp_f32 v161, v161
    v_rcp_f32 v162, v162
    v_rcp_f32 v163, v163
    v_rcp_f32 v164, v164
    v_rcp_f32 v165, v165
    v_rcp_f32 v166, v166
    v_rcp_f32 v167, v167
    v_pk_mul_f32 v[80:81], v[80:81], v[160:161]
    v_pk_mul_f32 v[82:83], v[82:83], v[162:163]
    v_pk_mul_f32 v[84:85], v[84:85], v[164:165]
    v_pk_mul_f32 v[86:87], v[86:87], v[166:167]
    s_cmp_ge_u32 s52, 43
    s_cbranch_scc1 m_t1_rest
    s_lshl_b32 s42, s52, 11
    s_add_u32 s42, s42, s41
    s_add_u32 s43, s42, 88064
    s_cmp_ge_u32 s52, 22
    s_cbranch_scc1 m_t1_stat
    v_cvt_pk_bf16_f32 v144, v24, v25
    v_cvt_pk_bf16_f32 v145, v26, v27
    v_cvt_pk_bf16_f32 v146, v28, v29
    v_cvt_pk_bf16_f32 v147, v30, v31
    buffer_store_dwordx4 v[144:147], v1, s[28:31], s42 offen offset:0 sc1
    v_cvt_pk_bf16_f32 v148, v72, v73
    v_cvt_pk_bf16_f32 v149, v74, v75
    v_cvt_pk_bf16_f32 v150, v76, v77
    v_cvt_pk_bf16_f32 v151, v78, v79
    buffer_store_dwordx4 v[148:151], v1, s[28:31], s43 offen offset:0 sc1
    s_cmp_eq_u32 s52, 21
    s_cbranch_scc1 m_t1_mixed
    v_cvt_pk_bf16_f32 v32, v32, v33
    v_cvt_pk_bf16_f32 v33, v34, v35
    v_cvt_pk_bf16_f32 v34, v36, v37
    v_cvt_pk_bf16_f32 v35, v38, v39
    buffer_store_dwordx4 v[32:35], v1, s[28:31], s42 offen offset:1024 sc1
    v_cvt_pk_bf16_f32 v80, v80, v81
    v_cvt_pk_bf16_f32 v81, v82, v83
    v_cvt_pk_bf16_f32 v82, v84, v85
    v_cvt_pk_bf16_f32 v83, v86, v87
    buffer_store_dwordx4 v[80:83], v1, s[28:31], s43 offen offset:1024 sc1
    s_branch m_t1_rest
m_t1_mixed:
    v_mov_b32 v24, 0
    v_mov_b32 v25, 0
    v_mov_b32 v26, 0
    v_mov_b32 v27, 0
    v_mov_b32 v28, 0
    v_mov_b32 v29, 0
    v_mov_b32 v30, 0
    v_mov_b32 v31, 0
    v_mov_b32 v72, 0
    v_mov_b32 v73, 0
    v_mov_b32 v74, 0
    v_mov_b32 v75, 0
    v_mov_b32 v76, 0
    v_mov_b32 v77, 0
    v_mov_b32 v78, 0
    v_mov_b32 v79, 0
m_t1_stat:
    v_pk_add_f32 v[160:161], v[24:25], v[26:27]
    v_pk_mul_f32 v[162:163], v[24:25], v[24:25]
    v_pk_fma_f32 v[162:163], v[26:27], v[26:27], v[162:163]
    v_pk_add_f32 v[160:161], v[160:161], v[28:29]
    v_pk_fma_f32 v[162:163], v[28:29], v[28:29], v[162:163]
    v_pk_add_f32 v[160:161], v[160:161], v[30:31]
    v_pk_fma_f32 v[162:163], v[30:31], v[30:31], v[162:163]
    v_pk_add_f32 v[160:161], v[160:161], v[32:33]
    v_pk_fma_f32 v[162:163], v[32:33], v[32:33], v[162:163]
    v_pk_add_f32 v[160:161], v[160:161], v[34:35]
    v_pk_fma_f32 v[162:163], v[34:35], v[34:35], v[162:163]
    v_pk_add_f32 v[160:161], v[160:161], v[36:37]
    v_pk_fma_f32 v[162:163], v[36:37], v[36:37], v[162:163]
    v_pk_add_f32 v[160:161], v[160:161], v[38:39]
    v_pk_fma_f32 v[162:163], v[38:39], v[38:39], v[162:163]
    v_add_f32 v152, v160, v161
    v_add_f32 v153, v162, v163
    v_mov_b32 v156, v152
    v_mov_b32 v157, v153
    v_pk_add_f32 v[164:165], v[72:73], v[74:75]
    v_pk_mul_f32 v[166:167], v[72:73], v[72:73]
    v_pk_fma_f32 v[166:167], v[74:75], v[74:75], v[166:167]
    v_pk_add_f32 v[164:165], v[164:165], v[76:77]
    v_pk_fma_f32 v[166:167], v[76:77], v[76:77], v[166:167]
    v_pk_add_f32 v[164:165], v[164:165], v[78:79]
    v_pk_fma_f32 v[166:167], v[78:79], v[78:79], v[166:167]
    v_pk_add_f32 v[164:165], v[164:165], v[80:81]
    v_pk_fma_f32 v[166:167], v[80:81], v[80:81], v[166:167]
    v_pk_add_f32 v[164:165], v[164:165], v[82:83]
    v_pk_fma_f32 v[166:167], v[82:83], v[82:83], v[166:167]
    v_pk_add_f32 v[164:165], v[164:165], v[84:85]
    v_pk_fma_f32 v[166:167], v[84:85], v[84:85], v[166:167]
    v_pk_add_f32 v[164:165], v[164:165], v[86:87]
    v_pk_fma_f32 v[166:167], v[86:87], v[86:87], v[166:167]
    v_add_f32 v154, v164, v165
    v_add_f32 v155, v166, v167
    v_mov_b32 v158, v154
    v_mov_b32 v159, v155
    v_mov_b32 v116, 0xfff
    v_lshlrev_b32 v117, 4, v3
    s_lshl_b32 s45, s52, 9
    s_add_u32 s45, s45, s48
    s_sub_u32 s45, s45, 10240
    v_permlane32_swap_b32 v152, v156
    v_permlane32_swap_b32 v153, v157
    v_permlane32_swap_b32 v154, v158
    v_permlane32_swap_b32 v155, v159
    v_pk_add_f32 v[152:153], v[152:153], v[156:157]
    v_bfi_b32 v153, v116, s60, v153
    v_pk_add_f32 v[154:155], v[154:155], v[158:159]
    v_bfi_b32 v155, v116, s63, v155
    buffer_store_dwordx4 v[152:155], v117, s[28:31], s45 offen sc1
m_t1_rest:
    s_lshl_b32 s42, s53, 11
    s_add_u32 s42, s42, s41
    s_add_u32 s43, s42, 88064
    v_mov_b32 v118, 0x80000000
    s_cmp_ge_u32 s53, 43
    s_cbranch_scc1 m_t1_noz
    v_mov_b32 v118, v1
    v_pk_mul_f32 v[160:161], v[40:41], v[40:41]
    v_pk_mul_f32 v[162:163], v[42:43], v[42:43]
    v_pk_mul_f32 v[164:165], v[44:45], v[44:45]
    v_pk_mul_f32 v[166:167], v[46:47], v[46:47]
    v_pk_fma_f32 v[160:161], v[160:161], v[138:139], v[136:137] op_sel:[0,0,1] op_sel_hi:[1,0,1]
    v_pk_fma_f32 v[162:163], v[162:163], v[138:139], v[136:137] op_sel:[0,0,1] op_sel_hi:[1,0,1]
    v_pk_fma_f32 v[164:165], v[164:165], v[138:139], v[136:137] op_sel:[0,0,1] op_sel_hi:[1,0,1]
    v_pk_fma_f32 v[166:167], v[166:167], v[138:139], v[136:137] op_sel:[0,0,1] op_sel_hi:[1,0,1]
    v_pk_mul_f32 v[160:161], v[160:161], v[40:41]
    v_pk_mul_f32 v[162:163], v[162:163], v[42:43]
    v_pk_mul_f32 v[164:165], v[164:165], v[44:45]
    v_pk_mul_f32 v[166:167], v[166:167], v[46:47]
    v_exp_f32 v160, v160
    v_exp_f32 v161, v161
    v_exp_f32 v162, v162
    v_exp_f32 v163, v163
    v_exp_f32 v164, v164
    v_exp_f32 v165, v165
    v_exp_f32 v166, v166
    v_exp_f32 v167, v167
    v_pk_fma_f32 v[160:161], v[160:161], v[136:137], v[136:137] op_sel_hi:[1,0,0]
    v_pk_fma_f32 v[162:163], v[162:163], v[136:137], v[136:137] op_sel_hi:[1,0,0]
    v_pk_fma_f32 v[164:165], v[164:165], v[136:137], v[136:137] op_sel_hi:[1,0,0]
    v_pk_fma_f32 v[166:167], v[166:167], v[136:137], v[136:137] op_sel_hi:[1,0,0]
    v_rcp_f32 v160, v160
    v_rcp_f32 v161, v161
    v_rcp_f32 v162, v162
    v_rcp_f32 v163, v163
    v_rcp_f32 v164, v164
    v_rcp_f32 v165, v165
    v_rcp_f32 v166, v166
    v_rcp_f32 v167, v167
    v_pk_mul_f32 v[40:41], v[40:41], v[160:161]
    v_pk_mul_f32 v[42:43], v[42:43], v[162:163]
    v_pk_mul_f32 v[44:45], v[44:45], v[164:165]
    v_pk_mul_f32 v[46:47], v[46:47], v[166:167]
    v_cvt_pk_bf16_f32 v40, v40, v41
    v_cvt_pk_bf16_f32 v41, v42, v43
    v_cvt_pk_bf16_f32 v42, v44, v45
    v_cvt_pk_bf16_f32 v43, v46, v47
    v_pk_mul_f32 v[160:161], v[48:49], v[48:49]
    v_pk_mul_f32 v[162:163], v[50:51], v[50:51]
    v_pk_mul_f32 v[164:165], v[52:53], v[52:53]
    v_pk_mul_f32 v[166:167], v[54:55], v[54:55]
    v_pk_fma_f32 v[160:161], v[160:161], v[138:139], v[136:137] op_sel:[0,0,1] op_sel_hi:[1,0,1]
    v_pk_fma_f32 v[162:163], v[162:163], v[138:139], v[136:137] op_sel:[0,0,1] op_sel_hi:[1,0,1]
    v_pk_fma_f32 v[164:165], v[164:165], v[138:139], v[136:137] op_sel:[0,0,1] op_sel_hi:[1,0,1]
    v_pk_fma_f32 v[166:167], v[166:167], v[138:139], v[136:137] op_sel:[0,0,1] op_sel_hi:[1,0,1]
    v_pk_mul_f32 v[160:161], v[160:161], v[48:49]
    v_pk_mul_f32 v[162:163], v[162:163], v[50:51]
    v_pk_mul_f32 v[164:165], v[164:165], v[52:53]
    v_pk_mul_f32 v[166:167], v[166:167], v[54:55]
    v_exp_f32 v160, v160
    v_exp_f32 v161, v161
    v_exp_f32 v162, v162
    v_exp_f32 v163, v163
    v_exp_f32 v164, v164
    v_exp_f32 v165, v165
    v_exp_f32 v166, v166
    v_exp_f32 v167, v167
    v_pk_fma_f32 v[160:161], v[160:161], v[136:137], v[136:137] op_sel_hi:[1,0,0]
    v_pk_fma_f32 v[162:163], v[162:163], v[136:137], v[136:137] op_sel_hi:[1,0,0]
    v_pk_fma_f32 v[164:165], v[164:165], v[136:137], v[136:137] op_sel_hi:[1,0,0]
    v_pk_fma_f32 v[166:167], v[166:167], v[136:137], v[136:137] op_sel_hi:[1,0,0]
    v_rcp_f32 v160, v160
    v_rcp_f32 v161, v161
    v_rcp_f32 v162, v162
    v_rcp_f32 v163, v163
    v_rcp_f32 v164, v164
    v_rcp_f32 v165, v165
    v_rcp_f32 v166, v166
    v_rcp_f32 v167, v167
    v_pk_mul_f32 v[48:49], v[48:49], v[160:161]
    v_pk_mul_f32 v[50:51], v[50:51], v[162:163]
    v_pk_mul_f32 v[52:53], v[52:53], v[164:165]
    v_pk_mul_f32 v[54:55], v[54:55], v[166:167]
    v_cvt_pk_bf16_f32 v48, v48, v49
    v_cvt_pk_bf16_f32 v49, v50, v51
    v_cvt_pk_bf16_f32 v50, v52, v53
    v_cvt_pk_bf16_f32 v51, v54, v55
    v_pk_mul_f32 v[160:161], v[88:89], v[88:89]
    v_pk_mul_f32 v[162:163], v[90:91], v[90:91]
    v_pk_mul_f32 v[164:165], v[92:93], v[92:93]
    v_pk_mul_f32 v[166:167], v[94:95], v[94:95]
    v_pk_fma_f32 v[160:161], v[160:161], v[142:143], v[140:141] op_sel:[0,0,1] op_sel_hi:[1,0,1]
    v_pk_fma_f32 v[162:163], v[162:163], v[142:143], v[140:141] op_sel:[0,0,1] op_sel_hi:[1,0,1]
    v_pk_fma_f32 v[164:165], v[164:165], v[142:143], v[140:141] op_sel:[0,0,1] op_sel_hi:[1,0,1]
    v_pk_fma_f32 v[166:167], v[166:167], v[142:143], v[140:141] op_sel:[0,0,1] op_sel_hi:[1,0,1]
    v_pk_mul_f32 v[160:161], v[160:161], v[88:89]
    v_pk_mul_f32 v[162:163], v[162:163], v[90:91]
    v_pk_mul_f32 v[164:165], v[164:165], v[92:93]
    v_pk_mul_f32 v[166:167], v[166:167], v[94:95]
    v_exp_f32 v160, v160
    v_exp_f32 v161, v161
    v_exp_f32 v162, v162
    v_exp_f32 v163, v163
    v_exp_f32 v164, v164
    v_exp_f32 v165, v165
    v_exp_f32 v166, v166
    v_exp_f32 v167, v167
    v_pk_fma_f32 v[160:161], v[160:161], v[140:141], v[140:141] op_sel_hi:[1,0,0]
    v_pk_fma_f32 v[162:163], v[162:163], v[140:141], v[140:141] op_sel_hi:[1,0,0]
    v_pk_fma_f32 v[164:165], v[164:165], v[140:141], v[140:141] op_sel_hi:[1,0,0]
    v_pk_fma_f32 v[166:167], v[166:167], v[140:141], v[140:141] op_sel_hi:[1,0,0]
    v_rcp_f32 v160, v160
    v_rcp_f32 v161, v161
    v_rcp_f32 v162, v162
    v_rcp_f32 v163, v163
    v_rcp_f32 v164, v164
    v_rcp_f32 v165, v165
    v_rcp_f32 v166, v166
    v_rcp_f32 v167, v167
    v_pk_mul_f32 v[88:89], v[88:89], v[160:161]
    v_pk_mul_f32 v[90:91], v[90:91], v[162:163]
    v_pk_mul_f32 v[92:93], v[92:93], v[164:165]
    v_pk_mul_f32 v[94:95], v[94:95], v[166:167]
    v_cvt_pk_bf16_f32 v88, v88, v89
    v_cvt_pk_bf16_f32 v89, v90, v91
    v_cvt_pk_bf16_f32 v90, v92, v93
    v_cvt_pk_bf16_f32 v91, v94, v95
    v_pk_mul_f32 v[160:161], v[96:97], v[96:97]
    v_pk_mul_f32 v[162:163], v[98:99], v[98:99]
    v_pk_mul_f32 v[164:165], v[100:101], v[100:101]
    v_pk_mul_f32 v[166:167], v[102:103], v[102:103]
    v_pk_fma_f32 v[160:161], v[160:161], v[142:143], v[140:141] op_sel:[0,0,1] op_sel_hi:[1,0,1]
    v_pk_fma_f32 v[162:163], v[162:163], v[142:143], v[140:141] op_sel:[0,0,1] op_sel_hi:[1,0,1]
    v_pk_fma_f32 v[164:165], v[164:165], v[142:143], v[140:141] op_sel:[0,0,1] op_sel_hi:[1,0,1]
    v_pk_fma_f32 v[166:167], v[166:167], v[142:143], v[140:141] op_sel:[0,0,1] op_sel_hi:[1,0,1]
    v_pk_mul_f32 v[160:161], v[160:161], v[96:97]
    v_pk_mul_f32 v[162:163], v[162:163], v[98:99]
    v_pk_mul_f32 v[164:165], v[164:165], v[100:101]
    v_pk_mul_f32 v[166:167], v[166:167], v[102:103]
    v_exp_f32 v160, v160
    v_exp_f32 v161, v161
    v_exp_f32 v162, v162
    v_exp_f32 v163, v163
    v_exp_f32 v164, v164
    v_exp_f32 v165, v165
    v_exp_f32 v166, v166
    v_exp_f32 v167, v167
    v_pk_fma_f32 v[160:161], v[160:161], v[140:141], v[140:141] op_sel_hi:[1,0,0]
    v_pk_fma_f32 v[162:163], v[162:163], v[140:141], v[140:141] op_sel_hi:[1,0,0]
    v_pk_fma_f32 v[164:165], v[164:165], v[140:141], v[140:141] op_sel_hi:[1,0,0]
    v_pk_fma_f32 v[166:167], v[166:167], v[140:141], v[140:141] op_sel_hi:[1,0,0]
    v_rcp_f32 v160, v160
    v_rcp_f32 v161, v161
    v_rcp_f32 v162, v162
    v_rcp_f32 v163, v163
    v_rcp_f32 v164, v164
    v_rcp_f32 v165, v165
    v_rcp_f32 v166, v166
    v_rcp_f32 v167, v167
    v_pk_mul_f32 v[96:97], v[96:97], v[160:161]
    v_pk_mul_f32 v[98:99], v[98:99], v[162:163]
    v_pk_mul_f32 v[100:101], v[100:101], v[164:165]
    v_pk_mul_f32 v[102:103], v[102:103], v[166:167]
    v_cvt_pk_bf16_f32 v96, v96, v97
    v_cvt_pk_bf16_f32 v97, v98, v99
    v_cvt_pk_bf16_f32 v98, v100, v101
    v_cvt_pk_bf16_f32 v99, v102, v103
m_t1_noz:
    s_sub_u32 s36, s52, 21
    s_cmp_lt_u32 s36, 22
    s_cbranch_scc1 m_t1_dog
    buffer_store_dwordx4 v[40:43], v118, s[28:31], s42 offen offset:0 sc1
    buffer_store_dwordx4 v[48:51], v118, s[28:31], s42 offen offset:1024 sc1
    buffer_store_dwordx4 v[88:91], v118, s[28:31], s43 offen offset:0 sc1
    buffer_store_dwordx4 v[96:99], v118, s[28:31], s43 offen offset:1024 sc1
    s_branch m_t1_flags
m_t1_dog:
    v_mul_u32_u24 v119, 5632, v4
    v_add_u32 v119, v119, v117
    s_add_u32 s48, s48, 512
    s_add_u32 s49, s48, 4096
    s_mov_b32 s47, 0x100000
m_t1_gather:
    buffer_load_dwordx4 v[8:11], v119, s[28:31], s48 offen offset:0 sc1
    buffer_load_dwordx4 v[12:15], v119, s[28:31], s48 offen offset:512 sc1
    buffer_load_dwordx4 v[16:19], v119, s[28:31], s48 offen offset:1024 sc1
    buffer_load_dwordx4 v[20:23], v119, s[28:31], s48 offen offset:1536 sc1
    buffer_load_dwordx4 v[64:67], v119, s[28:31], s48 offen offset:2048 sc1
    buffer_load_dwordx4 v[68:71], v119, s[28:31], s48 offen offset:2560 sc1
    buffer_load_dwordx4 v[104:107], v119, s[28:31], s48 offen offset:3072 sc1
    buffer_load_dwordx4 v[108:111], v119, s[28:31], s48 offen offset:3584 sc1
    buffer_load_dwordx4 v[112:115], v119, s[28:31], s49 offen offset:0 sc1
    buffer_load_dwordx4 v[124:127], v119, s[28:31], s49 offen offset:512 sc1
    buffer_load_dwordx4 v[128:131], v119, s[28:31], s49 offen offset:1024 sc1
    v_bfe_u32 v160, v2, 4, 1
    v_and_b32 v161, 15, v2
    v_lshlrev_b32 v120, 10, v4
    v_lshl_add_u32 v120, v160, 9, v120
    v_lshl_add_u32 v120, v161, 4, v120
    s_lshl_b32 s36, s12, 12
    s_add_u32 s36, s36, 139264
    v_lshlrev_b32 v121, 5, v3
    v_lshl_add_u32 v121, v4, 3, v121
    v_add_u32 v121, s36, v121
    v_lshrrev_b32 v160, 4, v2
    v_lshlrev_b32 v122, 8, v160
    v_lshl_add_u32 v122, v161, 3, v122
    v_add_u32 v122, s36, v122
    s_waitcnt vmcnt(0)
    v_xor_b32 v9, s60, v9
    v_xor_b32 v11, s63, v11
    v_xor_b32 v13, s60, v13
    v_xor_b32 v15, s63, v15
    v_xor_b32 v17, s60, v17
    v_xor_b32 v19, s63, v19
    v_xor_b32 v21, s60, v21
    v_xor_b32 v23, s63, v23
    v_xor_b32 v65, s60, v65
    v_xor_b32 v67, s63, v67
    v_xor_b32 v69, s60, v69
    v_xor_b32 v71, s63, v71
    v_xor_b32 v105, s60, v105
    v_xor_b32 v107, s63, v107
    v_xor_b32 v109, s60, v109
    v_xor_b32 v111, s63, v111
    v_xor_b32 v113, s60, v113
    v_xor_b32 v115, s63, v115
    v_xor_b32 v125, s60, v125
    v_xor_b32 v127, s63, v127
    v_xor_b32 v129, s60, v129
    v_xor_b32 v131, s63, v131
    v_or_b32 v160, v9, v11
    v_or3_b32 v160, v160, v13, v15
    v_or3_b32 v160, v160, v17, v19
    v_or3_b32 v160, v160, v21, v23
    v_or3_b32 v160, v160, v65, v67
    v_or3_b32 v160, v160, v69, v71
    v_or3_b32 v160, v160, v105, v107
    v_or3_b32 v160, v160, v109, v111
    v_or3_b32 v160, v160, v113, v115
    v_or3_b32 v160, v160, v125, v127
    v_or3_b32 v160, v160, v129, v131
    v_and_b32 v160, v160, v116
    v_cmp_ne_u32 vcc, 0, v160
    s_cbranch_vccz m_t1_have
    s_sleep 6
    s_sub_u32 s47, s47, 1
    s_cmp_lg_u32 s47, 0
    s_cbranch_scc1 m_t1_gather
m_t1_have:
    buffer_store_dwordx4 v[40:43], v118, s[28:31], s42 offen offset:0 sc1
    buffer_store_dwordx4 v[48:51], v118, s[28:31], s42 offen offset:1024 sc1
    buffer_store_dwordx4 v[88:91], v118, s[28:31], s43 offen offset:0 sc1
    buffer_store_dwordx4 v[96:99], v118, s[28:31], s43 offen offset:1024 sc1
    s_mov_b32 s36, 0x3abe82fa
    v_pk_add_f32 v[8:9], v[8:9], v[104:105]
    v_pk_add_f32 v[10:11], v[10:11], v[106:107]
    v_pk_add_f32 v[12:13], v[12:13], v[108:109]
    v_pk_add_f32 v[14:15], v[14:15], v[110:111]
    v_pk_add_f32 v[16:17], v[16:17], v[112:113]
    v_pk_add_f32 v[18:19], v[18:19], v[114:115]
    v_pk_add_f32 v[20:21], v[20:21], v[124:125]
    v_pk_add_f32 v[22:23], v[22:23], v[126:127]
    v_pk_add_f32 v[64:65], v[64:65], v[128:129]
    v_pk_add_f32 v[66:67], v[66:67], v[130:131]
    v_pk_add_f32 v[8:9], v[8:9], v[20:21]
    v_pk_add_f32 v[10:11], v[10:11], v[22:23]
    v_pk_add_f32 v[12:13], v[12:13], v[64:65]
    v_pk_add_f32 v[14:15], v[14:15], v[66:67]
    v_pk_add_f32 v[16:17], v[16:17], v[68:69]
    v_pk_add_f32 v[18:19], v[18:19], v[70:71]
    v_pk_add_f32 v[8:9], v[8:9], v[12:13]
    v_pk_add_f32 v[10:11], v[10:11], v[14:15]
    v_pk_add_f32 v[8:9], v[8:9], v[16:17]
    v_pk_add_f32 v[10:11], v[10:11], v[18:19]
    v_mov_b32 v12, v8
    v_mov_b32 v13, v9
    v_mov_b32 v14, v10
    v_mov_b32 v15, v11
    s_sub_u32 s37, s52, 22
    s_lshl_b32 s37, s37, 17
    v_permlane32_swap_b32 v8, v12
    v_permlane32_swap_b32 v9, v13
    v_permlane32_swap_b32 v10, v14
    v_permlane32_swap_b32 v11, v15
    s_add_u32 s37, s37, s44
    s_add_u32 s38, s37, 131072
    s_add_u32 s37, s37, 256
    v_pk_add_f32 v[8:9], v[8:9], v[12:13]
    v_mul_f32 v8, s36, v8
    v_mul_f32 v16, v8, v8
    v_fma_f32 v16, v9, s36, -v16
    v_max_f32 v16, 0, v16
    v_add_f32 v16, 0x3727c5ac, v16
    v_rsq_f32 v16, v16
    s_nop 0
    v_mul_f32 v18, -v8, v16
    v_pk_add_f32 v[10:11], v[10:11], v[14:15]
    v_mul_f32 v10, s36, v10
    v_mul_f32 v20, v10, v10
    v_fma_f32 v20, v11, s36, -v20
    v_max_f32 v20, 0, v20
    v_add_f32 v20, 0x3727c5ac, v20
    v_rsq_f32 v20, v20
    s_nop 0
    v_mul_f32 v22, -v10, v20
    v_pk_fma_f32 v[24:25], v[24:25], v[16:17], v[18:19] op_sel_hi:[1,0,0]
    v_pk_fma_f32 v[26:27], v[26:27], v[16:17], v[18:19] op_sel_hi:[1,0,0]
    v_pk_fma_f32 v[28:29], v[28:29], v[16:17], v[18:19] op_sel_hi:[1,0,0]
    v_pk_fma_f32 v[30:31], v[30:31], v[16:17], v[18:19] op_sel_hi:[1,0,0]
    v_pk_fma_f32 v[32:33], v[32:33], v[16:17], v[18:19] op_sel_hi:[1,0,0]
    v_pk_fma_f32 v[34:35], v[34:35], v[16:17], v[18:19] op_sel_hi:[1,0,0]
    v_pk_fma_f32 v[36:37], v[36:37], v[16:17], v[18:19] op_sel_hi:[1,0,0]
    v_pk_fma_f32 v[38:39], v[38:39], v[16:17], v[18:19] op_sel_hi:[1,0,0]
    v_cvt_pk_bf16_f32 v24, v24, v25
    v_cvt_pk_bf16_f32 v25, v26, v27
    v_cvt_pk_bf16_f32 v26, v28, v29
    v_cvt_pk_bf16_f32 v27, v30, v31
    v_cvt_pk_bf16_f32 v28, v32, v33
    v_cvt_pk_bf16_f32 v29, v34, v35
    v_cvt_pk_bf16_f32 v30, v36, v37
    v_cvt_pk_bf16_f32 v31, v38, v39
    ds_write_b64 v121, v[24:25] offset:0
    ds_write_b64 v121, v[26:27] offset:16
    ds_write_b64 v121, v[28:29] offset:1024
    ds_write_b64 v121, v[30:31] offset:1040
    v_pk_fma_f32 v[72:73], v[72:73], v[20:21], v[22:23] op_sel_hi:[1,0,0]
    v_pk_fma_f32 v[74:75], v[74:75], v[20:21], v[22:23] op_sel_hi:[1,0,0]
    v_pk_fma_f32 v[76:77], v[76:77], v[20:21], v[22:23] op_sel_hi:[1,0,0]
    v_pk_fma_f32 v[78:79], v[78:79], v[20:21], v[22:23] op_sel_hi:[1,0,0]
    v_pk_fma_f32 v[80:81], v[80:81], v[20:21], v[22:23] op_sel_hi:[1,0,0]
    v_pk_fma_f32 v[82:83], v[82:83], v[20:21], v[22:23] op_sel_hi:[1,0,0]
    v_pk_fma_f32 v[84:85], v[84:85], v[20:21], v[22:23] op_sel_hi:[1,0,0]
    v_pk_fma_f32 v[86:87], v[86:87], v[20:21], v[22:23] op_sel_hi:[1,0,0]
    v_cvt_pk_bf16_f32 v72, v72, v73
    v_cvt_pk_bf16_f32 v73, v74, v75
    v_cvt_pk_bf16_f32 v74, v76, v77
    v_cvt_pk_bf16_f32 v75, v78, v79
    v_cvt_pk_bf16_f32 v76, v80, v81
    v_cvt_pk_bf16_f32 v77, v82, v83
    v_cvt_pk_bf16_f32 v78, v84, v85
    v_cvt_pk_bf16_f32 v79, v86, v87
    ds_write_b64 v121, v[72:73] offset:2048
    ds_write_b64 v121, v[74:75] offset:2064
    ds_write_b64 v121, v[76:77] offset:3072
    ds_write_b64 v121, v[78:79] offset:3088
    s_waitcnt lgkmcnt(0)
    ds_read_b64_tr_b16 v[104:105], v122 offset:0
    ds_read_b64_tr_b16 v[106:107], v122 offset:128
    ds_read_b64_tr_b16 v[108:109], v122 offset:1024
    ds_read_b64_tr_b16 v[110:111], v122 offset:1152
    ds_read_b64_tr_b16 v[112:113], v122 offset:2048
    ds_read_b64_tr_b16 v[114:115], v122 offset:2176
    ds_read_b64_tr_b16 v[116:117], v122 offset:3072
    ds_read_b64_tr_b16 v[118:119], v122 offset:3200
    s_waitcnt lgkmcnt(0)
    buffer_store_dwordx4 v[108:111], v120, s[28:31], s38 offen offset:0 sc1
    buffer_store_dwordx4 v[116:119], v120, s[28:31], s38 offen offset:2048 sc1
    s_cmp_eq_u32 s52, 21
    s_cbranch_scc1 m_t1_flags
    buffer_store_dwordx4 v[104:107], v120, s[28:31], s37 offen offset:0 sc1
    buffer_store_dwordx4 v[112:115], v120, s[28:31], s37 offen offset:2048 sc1
m_t1_flags:
m_gemm:
    s_load_dwordx4 s[56:59], s[0:1], 40
    s_load_dwordx2 s[62:63], s[0:1], 64
    s_lshl_b32 s66, s52, 10
    s_add_u32 s66, s66, s18
    s_lshl_b32 s67, s53, 10
    s_add_u32 s67, s67, s18
    s_and_b32 s15, s2, 7
    s_lshl_b32 s15, s15, 2
    s_bfe_u32 s36, s2, 0x20003
    s_add_u32 s15, s15, s36
    s_lshr_b32 s16, s2, 5
    v_mov_b32 v167, s61
    v_lshlrev_b32 v4, 4, v2
    v_lshrrev_b32 v12, 4, v2
    v_and_b32 v13, 15, v2
    v_lshrrev_b32 v15, 5, v2
    v_and_b32 v16, 31, v2
    s_lshl_b32 s36, s15, 6
    s_lshl_b32 s37, s12, 4
    s_add_u32 s36, s36, s37
    v_add_u32 v14, s36, v12
    v_lshlrev_b32 v14, 12, v14
    v_xor_b32 v12, v13, v12
    s_lshl_b32 s18, s12, 12
    s_mov_b32 s64, 0
    s_mul_i32 s76, s16, 393216
    s_lshl_b32 s37, s12, 11
    s_add_u32 s72, s76, s37
    s_add_u32 s73, s72, 131072
    s_add_u32 s74, s72, 262144
    v_xor_b32 v13, v13, v15
    s_lshl_b32 s36, s12, 2
    v_xor_b32 v13, s36, v13
    v_lshlrev_b32 v17, 8, v16
    v_lshl_add_u32 v5, v13, 4, v17
    v_xor_b32 v6, 32, v5
    s_mul_i32 s36, s16, 3
    v_and_b32 v20, 3, v2
    v_add_u32 v20, s36, v20
    v_min_u32 v20, 21, v20
    v_lshlrev_b32 v20, 10, v20
    s_lshl_b32 s37, s15, 5
    v_add_u32 v20, s37, v20
    s_add_u32 s36, s36, 21
    v_add_u32 v18, s36, v15
    v_add_u32 v19, 2, v18
    v_min_u32 v18, 42, v18
    v_min_u32 v19, 42, v19
    v_lshlrev_b32 v16, 5, v16
    v_lshl_add_u32 v18, v18, 10, v16
    v_lshl_add_u32 v19, v19, 10, v16
    v_xor_b32 v15, 0, v12
    v_lshl_add_u32 v0, v15, 4, v14
    v_xor_b32 v15, 4, v12
    v_lshl_add_u32 v1, v15, 4, v14
    v_add_u32 v1, 15360, v1
    v_xor_b32 v15, 8, v12
    v_lshl_add_u32 v2, v15, 4, v14
    v_add_u32 v2, 30720, v2
    v_xor_b32 v15, 12, v12
    v_lshl_add_u32 v3, v15, 4, v14
    v_add_u32 v3, 46080, v3
    s_waitcnt vmcnt(0)
    s_cmp_ge_u32 s52, 43
    s_cbranch_scc1 m_nf1
    buffer_store_dword v167, off, s[28:31], s66 sc1
m_nf1:
    s_cmp_ge_u32 s53, 43
    s_cbranch_scc1 m_nf2
    buffer_store_dword v167, off, s[28:31], s67 sc1
m_nf2:
    s_cmp_lg_u32 s12, 0
    s_cbranch_scc1 m_nf3
    s_lshl_b32 s66, s2, 5
    s_add_u32 s66, s66, 25198592
    buffer_store_dword v167, off, s[28:31], s66 sc1
m_nf3:
    s_lshr_b32 s36, s12, 1
    s_lshl_b32 s37, s15, 1
    s_add_u32 s36, s36, s37
    s_and_b32 s37, s12, 1
    s_mul_i32 s38, s16, 6
    s_add_u32 s37, s37, s38
    s_mul_i32 s38, s36, 86
    s_add_u32 s38, s38, s37
    s_lshl_b32 s38, s38, 10
    s_add_u32 s38, s38, 6291456
    s_mul_i32 s39, s36, 75
    s_add_u32 s39, s39, s37
    s_lshl_b32 s39, s39, 10
    s_add_u32 s39, s39, 16809984
    s_lshl_b32 s36, s36, 6
    s_add_u32 s40, s38, 4096
    s_add_u32 s41, s39, 4096
    s_mov_b32 s35, 25231360
    s_waitcnt lgkmcnt(0)
    s_add_u32 s24, s10, 12582912
    s_addc_u32 s25, s11, 0
    s_mov_b32 s26, 2883584
    s_mov_b32 s27, 0x20000
    s_mov_b32 s20, s56
    s_mov_b32 s21, s57
    s_mov_b32 s22, 8388608
    s_mov_b32 s23, 0x20000
    s_mov_b32 s48, s58
    s_mov_b32 s49, s59
    s_mov_b32 s50, 4096
    s_mov_b32 s51, 0x20000
    s_mov_b32 s52, s4
    s_mov_b32 s53, s5
    s_mov_b32 s54, 2097152
    s_mov_b32 s55, 0x20000
    s_mov_b32 s44, s62
    s_mov_b32 s45, s63
    s_mov_b32 s46, 2097152
    s_mov_b32 s47, 0x20000
    v_mov_b32 v7, 1
    s_mov_b64 exec, 1
    ds_add_u32 v4, v7 offset:61448
    s_mov_b64 exec, -1
    ds_read_b32 v7, v4 offset:61448
m_gs1:
    s_waitcnt lgkmcnt(0)
    v_readfirstlane_b32 s34, v7
    s_cmp_ge_u32 s34, 4
    s_cbranch_scc1 m_gs1_ok
    s_sleep 1
    ds_read_b32 v7, v4 offset:61448
    s_branch m_gs1
m_gs1_ok:
    s_add_u32 m0, s18, 0
    s_nop 0
    buffer_load_dwordx4 v0, s[20:23], s64 offen offset:0 lds
    buffer_load_dwordx4 v1, s[20:23], s64 offen offset:1024 lds
    buffer_load_dwordx4 v2, s[20:23], s64 offen offset:2048 lds
    buffer_load_dwordx4 v3, s[20:23], s64 offen offset:3072 lds
    s_add_u32 s64, s64, 256
    s_add_u32 m0, s18, 16384
    s_nop 0
    buffer_load_dwordx4 v0, s[20:23], s64 offen offset:0 lds
    buffer_load_dwordx4 v1, s[20:23], s64 offen offset:1024 lds
    buffer_load_dwordx4 v2, s[20:23], s64 offen offset:2048 lds
    buffer_load_dwordx4 v3, s[20:23], s64 offen offset:3072 lds
    s_add_u32 s64, s64, 256
    s_add_u32 m0, s18, 32768
    s_nop 0
    buffer_load_dwordx4 v0, s[20:23], s64 offen offset:0 lds
    buffer_load_dwordx4 v1, s[20:23], s64 offen offset:1024 lds
    buffer_load_dwordx4 v2, s[20:23], s64 offen offset:2048 lds
    buffer_load_dwordx4 v3, s[20:23], s64 offen offset:3072 lds
    s_add_u32 s64, s64, 256
    v_lshlrev_b32 v8, 1, v4
    s_mov_b32 s66, 25198592
    s_mov_b32 s67, 25200640
    s_mov_b32 s68, 25202688
    s_mov_b32 s69, 25204736
    s_cmp_lg_u32 s12, 0
    s_cbranch_scc1 m_pollz_ok
    s_mov_b32 s33, 0x100000
m_pollz:
    buffer_load_dword v21, v18, s[28:31], s35 offen sc1
    buffer_load_dword v22, v19, s[28:31], s35 offen sc1
    buffer_load_dword v23, v20, s[28:31], s35 offen sc1
    s_waitcnt vmcnt(0)
    v_xor_b32 v21, s61, v21
    v_bitop3_b32 v21, v21, v22, s61 bitop3:0xf6
    v_bitop3_b32 v21, v21, v23, s61 bitop3:0xf6
    v_cmp_ne_u32 vcc, 0, v21
    s_cbranch_vccz m_pollz_ok
    s_sleep 2
    s_sub_u32 s33, s33, 1
    s_cmp_lg_u32 s33, 0
    s_cbranch_scc1 m_pollz
m_pollz_ok:
    s_waitcnt vmcnt(0)
    v_mov_b32 v7, 1
    s_mov_b64 exec, 1
    ds_add_u32 v4, v7 offset:61448
    s_mov_b64 exec, -1
    ds_read_b32 v7, v4 offset:61448
m_gs2:
    s_waitcnt lgkmcnt(0)
    v_readfirstlane_b32 s34, v7
    s_cmp_ge_u32 s34, 8
    s_cbranch_scc1 m_gs2_ok
    s_sleep 2
    ds_read_b32 v7, v4 offset:61448
    s_branch m_gs2
m_gs2_ok:
    buffer_load_dwordx4 v[104:107], v4, s[24:27], s72 offen offset:0 sc1
    buffer_load_dwordx4 v[108:111], v4, s[24:27], s73 offen offset:0 sc1
    buffer_load_dwordx4 v[112:115], v4, s[24:27], s74 offen offset:0 sc1
    buffer_load_dwordx4 v[116:119], v4, s[24:27], s72 offen offset:1024 sc1
    s_add_u32 s72, s72, 8192
    buffer_load_dwordx4 v[120:123], v4, s[24:27], s73 offen offset:1024 sc1
    s_add_u32 s73, s73, 8192
    buffer_load_dwordx4 v[124:127], v4, s[24:27], s74 offen offset:1024 sc1
    s_add_u32 s74, s74, 8192
    buffer_load_dwordx4 v[128:131], v4, s[24:27], s72 offen offset:0 sc1
    buffer_load_dwordx4 v[132:135], v4, s[24:27], s73 offen offset:0 sc1
    buffer_load_dwordx4 v[136:139], v4, s[24:27], s74 offen offset:0 sc1
    buffer_load_dwordx4 v[140:143], v4, s[24:27], s72 offen offset:1024 sc1
    s_add_u32 s72, s72, 8192
    buffer_load_dwordx4 v[144:147], v4, s[24:27], s73 offen offset:1024 sc1
    s_add_u32 s73, s73, 8192
    buffer_load_dwordx4 v[148:151], v4, s[24:27], s74 offen offset:1024 sc1
    s_add_u32 s74, s74, 8192
    ds_read_b128 v[152:155], v5 offset:0
    ds_read_b128 v[156:159], v5 offset:8192
    ds_read_b128 v[160:163], v6 offset:0
    ds_read_b128 v[164:167], v6 offset:8192
    s_waitcnt vmcnt(9)
    s_waitcnt lgkmcnt(2)
    s_setprio 1
    v_mfma_f32_32x32x16_bf16 v[8:23], v[104:107], v[152:155], 0
    v_mfma_f32_32x32x16_bf16 v[24:39], v[104:107], v[156:159], 0
    buffer_load_dwordx4 v[104:107], v4, s[24:27], s72 offen offset:0 sc1
    v_mfma_f32_32x32x16_bf16 v[40:55], v[108:111], v[152:155], 0
    v_mfma_f32_32x32x16_bf16 v[56:71], v[108:111], v[156:159], 0
    buffer_load_dwordx4 v[108:111], v4, s[24:27], s73 offen offset:0 sc1
    v_mfma_f32_32x32x16_bf16 v[72:87], v[112:115], v[152:155], 0
    v_mfma_f32_32x32x16_bf16 v[88:103], v[112:115], v[156:159], 0
    s_setprio 3
    buffer_load_dwordx4 v[112:115], v4, s[24:27], s74 offen offset:0 sc1
    s_waitcnt lgkmcnt(0)
    v_mov_b32 v7, 1
    s_mov_b64 exec, 1
    ds_add_u32 v4, v7 offset:61448
    s_mov_b64 exec, -1
    ds_read_b32 v7, v4 offset:61448
m_gs3:
    s_waitcnt lgkmcnt(0)
    v_readfirstlane_b32 s34, v7
    s_cmp_ge_u32 s34, 12
    s_cbranch_scc1 m_gs3_ok
    s_sleep 1
    ds_read_b32 v7, v4 offset:61448
    s_branch m_gs3
m_gs3_ok:
    s_add_u32 m0, s18, 0
    s_nop 0
    buffer_load_dwordx4 v0, s[20:23], s64 offen offset:0 lds
    buffer_load_dwordx4 v1, s[20:23], s64 offen offset:1024 lds
    buffer_load_dwordx4 v2, s[20:23], s64 offen offset:2048 lds
    buffer_load_dwordx4 v3, s[20:23], s64 offen offset:3072 lds
    s_add_u32 s64, s64, 256
    ds_read_b128 v[152:155], v5 offset:16384
    ds_read_b128 v[156:159], v5 offset:24576
    s_waitcnt vmcnt(13)
    s_setprio 1
    v_mfma_f32_32x32x16_bf16 v[8:23], v[116:119], v[160:163], v[8:23]
    v_mfma_f32_32x32x16_bf16 v[24:39], v[116:119], v[164:167], v[24:39]
    buffer_load_dwordx4 v[116:119], v4, s[24:27], s72 offen offset:1024 sc1
    s_add_u32 s72, s72, 8192
    v_mfma_f32_32x32x16_bf16 v[40:55], v[120:123], v[160:163], v[40:55]
    v_mfma_f32_32x32x16_bf16 v[56:71], v[120:123], v[164:167], v[56:71]
    buffer_load_dwordx4 v[120:123], v4, s[24:27], s73 offen offset:1024 sc1
    s_add_u32 s73, s73, 8192
    v_mfma_f32_32x32x16_bf16 v[72:87], v[124:127], v[160:163], v[72:87]
    v_mfma_f32_32x32x16_bf16 v[88:103], v[124:127], v[164:167], v[88:103]
    s_setprio 3
    buffer_load_dwordx4 v[124:127], v4, s[24:27], s74 offen offset:1024 sc1
    s_add_u32 s74, s74, 8192
    ds_read_b128 v[160:163], v6 offset:16384
    ds_read_b128 v[164:167], v6 offset:24576
    s_waitcnt vmcnt(13)
    s_waitcnt lgkmcnt(2)
    s_setprio 1
    v_mfma_f32_32x32x16_bf16 v[8:23], v[128:131], v[152:155], v[8:23]
    v_mfma_f32_32x32x16_bf16 v[24:39], v[128:131], v[156:159], v[24:39]
    buffer_load_dwordx4 v[128:131], v4, s[24:27], s72 offen offset:0 sc1
    v_mfma_f32_32x32x16_bf16 v[40:55], v[132:135], v[152:155], v[40:55]
    v_mfma_f32_32x32x16_bf16 v[56:71], v[132:135], v[156:159], v[56:71]
    buffer_load_dwordx4 v[132:135], v4, s[24:27], s73 offen offset:0 sc1
    v_mfma_f32_32x32x16_bf16 v[72:87], v[136:139], v[152:155], v[72:87]
    v_mfma_f32_32x32x16_bf16 v[88:103], v[136:139], v[156:159], v[88:103]
    s_setprio 3
    buffer_load_dwordx4 v[136:139], v4, s[24:27], s74 offen offset:0 sc1
    s_waitcnt lgkmcnt(0)
    v_mov_b32 v7, 1
    s_mov_b64 exec, 1
    ds_add_u32 v4, v7 offset:61448
    s_mov_b64 exec, -1
    ds_read_b32 v7, v4 offset:61448
m_gs4:
    s_waitcnt lgkmcnt(0)
    v_readfirstlane_b32 s34, v7
    s_cmp_ge_u32 s34, 16
    s_cbranch_scc1 m_gs4_ok
    s_sleep 1
    ds_read_b32 v7, v4 offset:61448
    s_branch m_gs4
m_gs4_ok:
    s_add_u32 m0, s18, 16384
    s_nop 0
    buffer_load_dwordx4 v0, s[20:23], s64 offen offset:0 lds
    buffer_load_dwordx4 v1, s[20:23], s64 offen offset:1024 lds
    buffer_load_dwordx4 v2, s[20:23], s64 offen offset:2048 lds
    buffer_load_dwordx4 v3, s[20:23], s64 offen offset:3072 lds
    s_add_u32 s64, s64, 256
    ds_read_b128 v[152:155], v5 offset:32768
    ds_read_b128 v[156:159], v5 offset:40960
    s_waitcnt vmcnt(17)
    s_setprio 1
    v_mfma_f32_32x32x16_bf16 v[8:23], v[140:143], v[160:163], v[8:23]
    v_mfma_f32_32x32x16_bf16 v[24:39], v[140:143], v[164:167], v[24:39]
    buffer_load_dwordx4 v[140:143], v4, s[24:27], s72 offen offset:1024 sc1
    s_add_u32 s72, s72, 8192
    v_mfma_f32_32x32x16_bf16 v[40:55], v[144:147], v[160:163], v[40:55]
    v_mfma_f32_32x32x16_bf16 v[56:71], v[144:147], v[164:167], v[56:71]
    buffer_load_dwordx4 v[144:147], v4, s[24:27], s73 offen offset:1024 sc1
    s_add_u32 s73, s73, 8192
    v_mfma_f32_32x32x16_bf16 v[72:87], v[148:151], v[160:163], v[72:87]
    v_mfma_f32_32x32x16_bf16 v[88:103], v[148:151], v[164:167], v[88:103]
    s_setprio 3
    buffer_load_dwordx4 v[148:151], v4, s[24:27], s74 offen offset:1024 sc1
    s_add_u32 s74, s74, 8192
    ds_read_b128 v[160:163], v6 offset:32768
    ds_read_b128 v[164:167], v6 offset:40960
    s_waitcnt vmcnt(17)
    s_waitcnt lgkmcnt(2)
    s_setprio 1
    v_mfma_f32_32x32x16_bf16 v[8:23], v[104:107], v[152:155], v[8:23]
    v_mfma_f32_32x32x16_bf16 v[24:39], v[104:107], v[156:159], v[24:39]
    buffer_load_dwordx4 v[104:107], v4, s[24:27], s72 offen offset:0 sc1
    v_mfma_f32_32x32x16_bf16 v[40:55], v[108:111], v[152:155], v[40:55]
    v_mfma_f32_32x32x16_bf16 v[56:71], v[108:111], v[156:159], v[56:71]
    buffer_load_dwordx4 v[108:111], v4, s[24:27], s73 offen offset:0 sc1
    v_mfma_f32_32x32x16_bf16 v[72:87], v[112:115], v[152:155], v[72:87]
    v_mfma_f32_32x32x16_bf16 v[88:103], v[112:115], v[156:159], v[88:103]
    s_setprio 3
    buffer_load_dwordx4 v[112:115], v4, s[24:27], s74 offen offset:0 sc1
    s_waitcnt vmcnt(16)
    s_waitcnt lgkmcnt(0)
    v_mov_b32 v7, 1
    s_mov_b64 exec, 1
    ds_add_u32 v4, v7 offset:61448
    s_mov_b64 exec, -1
    ds_read_b32 v7, v4 offset:61448
m_gs5:
    s_waitcnt lgkmcnt(0)
    v_readfirstlane_b32 s34, v7
    s_cmp_ge_u32 s34, 20
    s_cbranch_scc1 m_gs5_ok
    s_sleep 1
    ds_read_b32 v7, v4 offset:61448
    s_branch m_gs5
m_gs5_ok:
    s_add_u32 m0, s18, 32768
    s_nop 0
    buffer_load_dwordx4 v0, s[20:23], s64 offen offset:0 lds
    buffer_load_dwordx4 v1, s[20:23], s64 offen offset:1024 lds
    buffer_load_dwordx4 v2, s[20:23], s64 offen offset:2048 lds
    buffer_load_dwordx4 v3, s[20:23], s64 offen offset:3072 lds
    s_add_u32 s64, s64, 256
    ds_read_b128 v[152:155], v5 offset:0
    ds_read_b128 v[156:159], v5 offset:8192
    s_waitcnt vmcnt(17)
    s_setprio 1
    v_mfma_f32_32x32x16_bf16 v[8:23], v[116:119], v[160:163], v[8:23]
    v_mfma_f32_32x32x16_bf16 v[24:39], v[116:119], v[164:167], v[24:39]
    buffer_load_dwordx4 v[116:119], v4, s[24:27], s72 offen offset:1024 sc1
    s_add_u32 s72, s72, 8192
    v_mfma_f32_32x32x16_bf16 v[40:55], v[120:123], v[160:163], v[40:55]
    v_mfma_f32_32x32x16_bf16 v[56:71], v[120:123], v[164:167], v[56:71]
    buffer_load_dwordx4 v[120:123], v4, s[24:27], s73 offen offset:1024 sc1
    s_add_u32 s73, s73, 8192
    v_mfma_f32_32x32x16_bf16 v[72:87], v[124:127], v[160:163], v[72:87]
    v_mfma_f32_32x32x16_bf16 v[88:103], v[124:127], v[164:167], v[88:103]
    s_setprio 3
    buffer_load_dwordx4 v[124:127], v4, s[24:27], s74 offen offset:1024 sc1
    s_add_u32 s74, s74, 8192
    ds_read_b128 v[160:163], v6 offset:0
    ds_read_b128 v[164:167], v6 offset:8192
    s_waitcnt vmcnt(17)
    s_waitcnt lgkmcnt(2)
    s_setprio 1
    v_mfma_f32_32x32x16_bf16 v[8:23], v[128:131], v[152:155], v[8:23]
    v_mfma_f32_32x32x16_bf16 v[24:39], v[128:131], v[156:159], v[24:39]
    buffer_load_dwordx4 v[128:131], v4, s[24:27], s72 offen offset:0 sc1
    v_mfma_f32_32x32x16_bf16 v[40:55], v[132:135], v[152:155], v[40:55]
    v_mfma_f32_32x32x16_bf16 v[56:71], v[132:135], v[156:159], v[56:71]
    buffer_load_dwordx4 v[132:135], v4, s[24:27], s73 offen offset:0 sc1
    v_mfma_f32_32x32x16_bf16 v[72:87], v[136:139], v[152:155], v[72:87]
    v_mfma_f32_32x32x16_bf16 v[88:103], v[136:139], v[156:159], v[88:103]
    s_setprio 3
    buffer_load_dwordx4 v[136:139], v4, s[24:27], s74 offen offset:0 sc1
    s_waitcnt vmcnt(16)
    s_waitcnt lgkmcnt(0)
    v_mov_b32 v7, 1
    s_mov_b64 exec, 1
    ds_add_u32 v4, v7 offset:61448
    s_mov_b64 exec, -1
    ds_read_b32 v7, v4 offset:61448
m_gs6:
    s_waitcnt lgkmcnt(0)
    v_readfirstlane_b32 s34, v7
    s_cmp_ge_u32 s34, 24
    s_cbranch_scc1 m_gs6_ok
    s_sleep 1
    ds_read_b32 v7, v4 offset:61448
    s_branch m_gs6
m_gs6_ok:
    s_add_u32 m0, s18, 0
    s_nop 0
    buffer_load_dwordx4 v0, s[20:23], s64 offen offset:0 lds
    buffer_load_dwordx4 v1, s[20:23], s64 offen offset:1024 lds
    buffer_load_dwordx4 v2, s[20:23], s64 offen offset:2048 lds
    buffer_load_dwordx4 v3, s[20:23], s64 offen offset:3072 lds
    s_add_u32 s64, s64, 256
    ds_read_b128 v[152:155], v5 offset:16384
    ds_read_b128 v[156:159], v5 offset:24576
    s_waitcnt vmcnt(17)
    s_setprio 1
    v_mfma_f32_32x32x16_bf16 v[8:23], v[140:143], v[160:163], v[8:23]
    v_mfma_f32_32x32x16_bf16 v[24:39], v[140:143], v[164:167], v[24:39]
    buffer_load_dwordx4 v[140:143], v4, s[24:27], s72 offen offset:1024 sc1
    s_add_u32 s72, s72, 8192
    v_mfma_f32_32x32x16_bf16 v[40:55], v[144:147], v[160:163], v[40:55]
    v_mfma_f32_32x32x16_bf16 v[56:71], v[144:147], v[164:167], v[56:71]
    buffer_load_dwordx4 v[144:147], v4, s[24:27], s73 offen offset:1024 sc1
    s_add_u32 s73, s73, 8192
    v_mfma_f32_32x32x16_bf16 v[72:87], v[148:151], v[160:163], v[72:87]
    v_mfma_f32_32x32x16_bf16 v[88:103], v[148:151], v[164:167], v[88:103]
    s_setprio 3
    buffer_load_dwordx4 v[148:151], v4, s[24:27], s74 offen offset:1024 sc1
    s_add_u32 s74, s74, 8192
    ds_read_b128 v[160:163], v6 offset:16384
    ds_read_b128 v[164:167], v6 offset:24576
    s_waitcnt vmcnt(17)
    s_waitcnt lgkmcnt(2)
    s_setprio 1
    v_mfma_f32_32x32x16_bf16 v[8:23], v[104:107], v[152:155], v[8:23]
    v_mfma_f32_32x32x16_bf16 v[24:39], v[104:107], v[156:159], v[24:39]
    buffer_load_dwordx4 v[104:107], v4, s[24:27], s72 offen offset:0 sc1
    v_mfma_f32_32x32x16_bf16 v[40:55], v[108:111], v[152:155], v[40:55]
    v_mfma_f32_32x32x16_bf16 v[56:71], v[108:111], v[156:159], v[56:71]
    buffer_load_dwordx4 v[108:111], v4, s[24:27], s73 offen offset:0 sc1
    v_mfma_f32_32x32x16_bf16 v[72:87], v[112:115], v[152:155], v[72:87]
    v_mfma_f32_32x32x16_bf16 v[88:103], v[112:115], v[156:159], v[88:103]
    s_setprio 3
    buffer_load_dwordx4 v[112:115], v4, s[24:27], s74 offen offset:0 sc1
    s_waitcnt vmcnt(16)
    s_waitcnt lgkmcnt(0)
    v_mov_b32 v7, 1
    s_mov_b64 exec, 1
    ds_add_u32 v4, v7 offset:61448
    s_mov_b64 exec, -1
    ds_read_b32 v7, v4 offset:61448
m_gs7:
    s_waitcnt lgkmcnt(0)
    v_readfirstlane_b32 s34, v7
    s_cmp_ge_u32 s34, 28
    s_cbranch_scc1 m_gs7_ok
    s_sleep 1
    ds_read_b32 v7, v4 offset:61448
    s_branch m_gs7
m_gs7_ok:
    s_add_u32 m0, s18, 16384
    s_nop 0
    buffer_load_dwordx4 v0, s[20:23], s64 offen offset:0 lds
    buffer_load_dwordx4 v1, s[20:23], s64 offen offset:1024 lds
    buffer_load_dwordx4 v2, s[20:23], s64 offen offset:2048 lds
    buffer_load_dwordx4 v3, s[20:23], s64 offen offset:3072 lds
    s_add_u32 s64, s64, 256
    ds_read_b128 v[152:155], v5 offset:32768
    ds_read_b128 v[156:159], v5 offset:40960
    s_waitcnt vmcnt(17)
    s_setprio 1
    v_mfma_f32_32x32x16_bf16 v[8:23], v[116:119], v[160:163], v[8:23]
    v_mfma_f32_32x32x16_bf16 v[24:39], v[116:119], v[164:167], v[24:39]
    buffer_load_dwordx4 v[116:119], v4, s[24:27], s72 offen offset:1024 sc1
    s_add_u32 s72, s72, 8192
    v_mfma_f32_32x32x16_bf16 v[40:55], v[120:123], v[160:163], v[40:55]
    v_mfma_f32_32x32x16_bf16 v[56:71], v[120:123], v[164:167], v[56:71]
    buffer_load_dwordx4 v[120:123], v4, s[24:27], s73 offen offset:1024 sc1
    s_add_u32 s73, s73, 8192
    v_mfma_f32_32x32x16_bf16 v[72:87], v[124:127], v[160:163], v[72:87]
    v_mfma_f32_32x32x16_bf16 v[88:103], v[124:127], v[164:167], v[88:103]
    s_setprio 3
    buffer_load_dwordx4 v[124:127], v4, s[24:27], s74 offen offset:1024 sc1
    s_add_u32 s74, s74, 8192
    ds_read_b128 v[160:163], v6 offset:32768
    ds_read_b128 v[164:167], v6 offset:40960
    s_waitcnt vmcnt(17)
    s_waitcnt lgkmcnt(2)
    s_setprio 1
    v_mfma_f32_32x32x16_bf16 v[8:23], v[128:131], v[152:155], v[8:23]
    v_mfma_f32_32x32x16_bf16 v[24:39], v[128:131], v[156:159], v[24:39]
    buffer_load_dwordx4 v[128:131], v4, s[24:27], s72 offen offset:0 sc1
    v_mfma_f32_32x32x16_bf16 v[40:55], v[132:135], v[152:155], v[40:55]
    v_mfma_f32_32x32x16_bf16 v[56:71], v[132:135], v[156:159], v[56:71]
    buffer_load_dwordx4 v[132:135], v4, s[24:27], s73 offen offset:0 sc1
    v_mfma_f32_32x32x16_bf16 v[72:87], v[136:139], v[152:155], v[72:87]
    v_mfma_f32_32x32x16_bf16 v[88:103], v[136:139], v[156:159], v[88:103]
    s_setprio 3
    buffer_load_dwordx4 v[136:139], v4, s[24:27], s74 offen offset:0 sc1
    s_waitcnt vmcnt(16)
    s_waitcnt lgkmcnt(0)
    v_mov_b32 v7, 1
    s_mov_b64 exec, 1
    ds_add_u32 v4, v7 offset:61448
    s_mov_b64 exec, -1
    ds_read_b32 v7, v4 offset:61448
m_gs8:
    s_waitcnt lgkmcnt(0)
    v_readfirstlane_b32 s34, v7
    s_cmp_ge_u32 s34, 32
    s_cbranch_scc1 m_gs8_ok
    s_sleep 1
    ds_read_b32 v7, v4 offset:61448
    s_branch m_gs8
m_gs8_ok:
    s_add_u32 m0, s18, 32768
    s_nop 0
    buffer_load_dwordx4 v0, s[20:23], s64 offen offset:0 lds
    buffer_load_dwordx4 v1, s[20:23], s64 offen offset:1024 lds
    buffer_load_dwordx4 v2, s[20:23], s64 offen offset:2048 lds
    buffer_load_dwordx4 v3, s[20:23], s64 offen offset:3072 lds
    s_add_u32 s64, s64, 256
    ds_read_b128 v[152:155], v5 offset:0
    ds_read_b128 v[156:159], v5 offset:8192
    s_waitcnt vmcnt(17)
    s_setprio 1
    v_mfma_f32_32x32x16_bf16 v[8:23], v[140:143], v[160:163], v[8:23]
    v_mfma_f32_32x32x16_bf16 v[24:39], v[140:143], v[164:167], v[24:39]
    buffer_load_dwordx4 v[140:143], v4, s[24:27], s72 offen offset:1024 sc1
    s_add_u32 s72, s72, 8192
    v_mfma_f32_32x32x16_bf16 v[40:55], v[144:147], v[160:163], v[40:55]
    v_mfma_f32_32x32x16_bf16 v[56:71], v[144:147], v[164:167], v[56:71]
    buffer_load_dwordx4 v[144:147], v4, s[24:27], s73 offen offset:1024 sc1
    s_add_u32 s73, s73, 8192
    v_mfma_f32_32x32x16_bf16 v[72:87], v[148:151], v[160:163], v[72:87]
    v_mfma_f32_32x32x16_bf16 v[88:103], v[148:151], v[164:167], v[88:103]
    s_setprio 3
    buffer_load_dwordx4 v[148:151], v4, s[24:27], s74 offen offset:1024 sc1
    s_add_u32 s74, s74, 8192
    ds_read_b128 v[160:163], v6 offset:0
    ds_read_b128 v[164:167], v6 offset:8192
    s_waitcnt vmcnt(17)
    s_waitcnt lgkmcnt(2)
    s_setprio 1
    v_mfma_f32_32x32x16_bf16 v[8:23], v[104:107], v[152:155], v[8:23]
    v_mfma_f32_32x32x16_bf16 v[24:39], v[104:107], v[156:159], v[24:39]
    buffer_load_dwordx4 v[104:107], v4, s[24:27], s72 offen offset:0 sc1
    v_mfma_f32_32x32x16_bf16 v[40:55], v[108:111], v[152:155], v[40:55]
    v_mfma_f32_32x32x16_bf16 v[56:71], v[108:111], v[156:159], v[56:71]
    buffer_load_dwordx4 v[108:111], v4, s[24:27], s73 offen offset:0 sc1
    v_mfma_f32_32x32x16_bf16 v[72:87], v[112:115], v[152:155], v[72:87]
    v_mfma_f32_32x32x16_bf16 v[88:103], v[112:115], v[156:159], v[88:103]
    s_setprio 3
    buffer_load_dwordx4 v[112:115], v4, s[24:27], s74 offen offset:0 sc1
    s_waitcnt vmcnt(16)
    s_waitcnt lgkmcnt(0)
    v_mov_b32 v7, 1
    s_mov_b64 exec, 1
    ds_add_u32 v4, v7 offset:61448
    s_mov_b64 exec, -1
    ds_read_b32 v7, v4 offset:61448
m_gs9:
    s_waitcnt lgkmcnt(0)
    v_readfirstlane_b32 s34, v7
    s_cmp_ge_u32 s34, 36
    s_cbranch_scc1 m_gs9_ok
    s_sleep 1
    ds_read_b32 v7, v4 offset:61448
    s_branch m_gs9
m_gs9_ok:
    s_add_u32 m0, s18, 0
    s_nop 0
    buffer_load_dwordx4 v0, s[20:23], s64 offen offset:0 lds
    buffer_load_dwordx4 v1, s[20:23], s64 offen offset:1024 lds
    buffer_load_dwordx4 v2, s[20:23], s64 offen offset:2048 lds
    buffer_load_dwordx4 v3, s[20:23], s64 offen offset:3072 lds
    s_add_u32 s64, s64, 256
    ds_read_b128 v[152:155], v5 offset:16384
    ds_read_b128 v[156:159], v5 offset:24576
    s_waitcnt vmcnt(17)
    s_setprio 1
    v_mfma_f32_32x32x16_bf16 v[8:23], v[116:119], v[160:163], v[8:23]
    v_mfma_f32_32x32x16_bf16 v[24:39], v[116:119], v[164:167], v[24:39]
    buffer_load_dwordx4 v[116:119], v4, s[24:27], s72 offen offset:1024 sc1
    s_add_u32 s72, s72, 8192
    v_mfma_f32_32x32x16_bf16 v[40:55], v[120:123], v[160:163], v[40:55]
    v_mfma_f32_32x32x16_bf16 v[56:71], v[120:123], v[164:167], v[56:71]
    buffer_load_dwordx4 v[120:123], v4, s[24:27], s73 offen offset:1024 sc1
    s_add_u32 s73, s73, 8192
    v_mfma_f32_32x32x16_bf16 v[72:87], v[124:127], v[160:163], v[72:87]
    v_mfma_f32_32x32x16_bf16 v[88:103], v[124:127], v[164:167], v[88:103]
    s_setprio 3
    buffer_load_dwordx4 v[124:127], v4, s[24:27], s74 offen offset:1024 sc1
    s_add_u32 s74, s74, 8192
    ds_read_b128 v[160:163], v6 offset:16384
    ds_read_b128 v[164:167], v6 offset:24576
    s_waitcnt vmcnt(17)
    s_waitcnt lgkmcnt(2)
    s_setprio 1
    v_mfma_f32_32x32x16_bf16 v[8:23], v[128:131], v[152:155], v[8:23]
    v_mfma_f32_32x32x16_bf16 v[24:39], v[128:131], v[156:159], v[24:39]
    buffer_load_dwordx4 v[128:131], v4, s[24:27], s72 offen offset:0 sc1
    v_mfma_f32_32x32x16_bf16 v[40:55], v[132:135], v[152:155], v[40:55]
    v_mfma_f32_32x32x16_bf16 v[56:71], v[132:135], v[156:159], v[56:71]
    buffer_load_dwordx4 v[132:135], v4, s[24:27], s73 offen offset:0 sc1
    v_mfma_f32_32x32x16_bf16 v[72:87], v[136:139], v[152:155], v[72:87]
    v_mfma_f32_32x32x16_bf16 v[88:103], v[136:139], v[156:159], v[88:103]
    s_setprio 3
    buffer_load_dwordx4 v[136:139], v4, s[24:27], s74 offen offset:0 sc1
    s_waitcnt vmcnt(16)
    s_waitcnt lgkmcnt(0)
    v_mov_b32 v7, 1
    s_mov_b64 exec, 1
    ds_add_u32 v4, v7 offset:61448
    s_mov_b64 exec, -1
    ds_read_b32 v7, v4 offset:61448
m_gs10:
    s_waitcnt lgkmcnt(0)
    v_readfirstlane_b32 s34, v7
    s_cmp_ge_u32 s34, 40
    s_cbranch_scc1 m_gs10_ok
    s_sleep 1
    ds_read_b32 v7, v4 offset:61448
    s_branch m_gs10
m_gs10_ok:
    s_add_u32 m0, s18, 16384
    s_nop 0
    buffer_load_dwordx4 v0, s[20:23], s64 offen offset:0 lds
    buffer_load_dwordx4 v1, s[20:23], s64 offen offset:1024 lds
    buffer_load_dwordx4 v2, s[20:23], s64 offen offset:2048 lds
    buffer_load_dwordx4 v3, s[20:23], s64 offen offset:3072 lds
    s_add_u32 s64, s64, 256
    ds_read_b128 v[152:155], v5 offset:32768
    ds_read_b128 v[156:159], v5 offset:40960
    s_waitcnt vmcnt(17)
    s_setprio 1
    v_mfma_f32_32x32x16_bf16 v[8:23], v[140:143], v[160:163], v[8:23]
    v_mfma_f32_32x32x16_bf16 v[24:39], v[140:143], v[164:167], v[24:39]
    buffer_load_dwordx4 v[140:143], v4, s[24:27], s72 offen offset:1024 sc1
    s_add_u32 s72, s72, 8192
    v_mfma_f32_32x32x16_bf16 v[40:55], v[144:147], v[160:163], v[40:55]
    v_mfma_f32_32x32x16_bf16 v[56:71], v[144:147], v[164:167], v[56:71]
    buffer_load_dwordx4 v[144:147], v4, s[24:27], s73 offen offset:1024 sc1
    s_add_u32 s73, s73, 8192
    v_mfma_f32_32x32x16_bf16 v[72:87], v[148:151], v[160:163], v[72:87]
    v_mfma_f32_32x32x16_bf16 v[88:103], v[148:151], v[164:167], v[88:103]
    s_setprio 3
    buffer_load_dwordx4 v[148:151], v4, s[24:27], s74 offen offset:1024 sc1
    s_add_u32 s74, s74, 8192
    ds_read_b128 v[160:163], v6 offset:32768
    ds_read_b128 v[164:167], v6 offset:40960
    s_waitcnt vmcnt(17)
    s_waitcnt lgkmcnt(2)
    s_setprio 1
    v_mfma_f32_32x32x16_bf16 v[8:23], v[104:107], v[152:155], v[8:23]
    v_mfma_f32_32x32x16_bf16 v[24:39], v[104:107], v[156:159], v[24:39]
    buffer_load_dwordx4 v[104:107], v4, s[24:27], s72 offen offset:0 sc1
    v_mfma_f32_32x32x16_bf16 v[40:55], v[108:111], v[152:155], v[40:55]
    v_mfma_f32_32x32x16_bf16 v[56:71], v[108:111], v[156:159], v[56:71]
    buffer_load_dwordx4 v[108:111], v4, s[24:27], s73 offen offset:0 sc1
    v_mfma_f32_32x32x16_bf16 v[72:87], v[112:115], v[152:155], v[72:87]
    v_mfma_f32_32x32x16_bf16 v[88:103], v[112:115], v[156:159], v[88:103]
    s_setprio 3
    buffer_load_dwordx4 v[112:115], v4, s[24:27], s74 offen offset:0 sc1
    s_waitcnt vmcnt(16)
    s_waitcnt lgkmcnt(0)
    v_mov_b32 v7, 1
    s_mov_b64 exec, 1
    ds_add_u32 v4, v7 offset:61448
    s_mov_b64 exec, -1
    ds_read_b32 v7, v4 offset:61448
m_gs11:
    s_waitcnt lgkmcnt(0)
    v_readfirstlane_b32 s34, v7
    s_cmp_ge_u32 s34, 44
    s_cbranch_scc1 m_gs11_ok
    s_sleep 1
    ds_read_b32 v7, v4 offset:61448
    s_branch m_gs11
m_gs11_ok:
    s_add_u32 m0, s18, 32768
    s_nop 0
    buffer_load_dwordx4 v0, s[20:23], s64 offen offset:0 lds
    buffer_load_dwordx4 v1, s[20:23], s64 offen offset:1024 lds
    buffer_load_dwordx4 v2, s[20:23], s64 offen offset:2048 lds
    buffer_load_dwordx4 v3, s[20:23], s64 offen offset:3072 lds
    s_add_u32 s64, s64, 256
    ds_read_b128 v[152:155], v5 offset:0
    ds_read_b128 v[156:159], v5 offset:8192
    s_waitcnt vmcnt(17)
    s_setprio 1
    v_mfma_f32_32x32x16_bf16 v[8:23], v[116:119], v[160:163], v[8:23]
    v_mfma_f32_32x32x16_bf16 v[24:39], v[116:119], v[164:167], v[24:39]
    buffer_load_dwordx4 v[116:119], v4, s[24:27], s72 offen offset:1024 sc1
    s_add_u32 s72, s72, 8192
    v_mfma_f32_32x32x16_bf16 v[40:55], v[120:123], v[160:163], v[40:55]
    v_mfma_f32_32x32x16_bf16 v[56:71], v[120:123], v[164:167], v[56:71]
    buffer_load_dwordx4 v[120:123], v4, s[24:27], s73 offen offset:1024 sc1
    s_add_u32 s73, s73, 8192
    v_mfma_f32_32x32x16_bf16 v[72:87], v[124:127], v[160:163], v[72:87]
    v_mfma_f32_32x32x16_bf16 v[88:103], v[124:127], v[164:167], v[88:103]
    s_setprio 3
    buffer_load_dwordx4 v[124:127], v4, s[24:27], s74 offen offset:1024 sc1
    s_add_u32 s74, s74, 8192
    ds_read_b128 v[160:163], v6 offset:0
    ds_read_b128 v[164:167], v6 offset:8192
    s_waitcnt vmcnt(17)
    s_waitcnt lgkmcnt(2)
    s_setprio 1
    v_mfma_f32_32x32x16_bf16 v[8:23], v[128:131], v[152:155], v[8:23]
    v_mfma_f32_32x32x16_bf16 v[24:39], v[128:131], v[156:159], v[24:39]
    buffer_load_dwordx4 v[128:131], v4, s[24:27], s72 offen offset:0 sc1
    v_mfma_f32_32x32x16_bf16 v[40:55], v[132:135], v[152:155], v[40:55]
    v_mfma_f32_32x32x16_bf16 v[56:71], v[132:135], v[156:159], v[56:71]
    buffer_load_dwordx4 v[132:135], v4, s[24:27], s73 offen offset:0 sc1
    v_mfma_f32_32x32x16_bf16 v[72:87], v[136:139], v[152:155], v[72:87]
    v_mfma_f32_32x32x16_bf16 v[88:103], v[136:139], v[156:159], v[88:103]
    s_setprio 3
    buffer_load_dwordx4 v[136:139], v4, s[24:27], s74 offen offset:0 sc1
    s_waitcnt vmcnt(16)
    s_waitcnt lgkmcnt(0)
    v_mov_b32 v7, 1
    s_mov_b64 exec, 1
    ds_add_u32 v4, v7 offset:61448
    s_mov_b64 exec, -1
    ds_read_b32 v7, v4 offset:61448
m_gs12:
    s_waitcnt lgkmcnt(0)
    v_readfirstlane_b32 s34, v7
    s_cmp_ge_u32 s34, 48
    s_cbranch_scc1 m_gs12_ok
    s_sleep 1
    ds_read_b32 v7, v4 offset:61448
    s_branch m_gs12
m_gs12_ok:
    s_add_u32 m0, s18, 0
    s_nop 0
    buffer_load_dwordx4 v0, s[20:23], s64 offen offset:0 lds
    buffer_load_dwordx4 v1, s[20:23], s64 offen offset:1024 lds
    buffer_load_dwordx4 v2, s[20:23], s64 offen offset:2048 lds
    buffer_load_dwordx4 v3, s[20:23], s64 offen offset:3072 lds
    s_add_u32 s64, s64, 256
    ds_read_b128 v[152:155], v5 offset:16384
    ds_read_b128 v[156:159], v5 offset:24576
    s_waitcnt vmcnt(17)
    s_setprio 1
    v_mfma_f32_32x32x16_bf16 v[8:23], v[140:143], v[160:163], v[8:23]
    v_mfma_f32_32x32x16_bf16 v[24:39], v[140:143], v[164:167], v[24:39]
    buffer_load_dwordx4 v[140:143], v4, s[24:27], s72 offen offset:1024 sc1
    s_add_u32 s72, s72, 8192
    v_mfma_f32_32x32x16_bf16 v[40:55], v[144:147], v[160:163], v[40:55]
    v_mfma_f32_32x32x16_bf16 v[56:71], v[144:147], v[164:167], v[56:71]
    buffer_load_dwordx4 v[144:147], v4, s[24:27], s73 offen offset:1024 sc1
    s_add_u32 s73, s73, 8192
    v_mfma_f32_32x32x16_bf16 v[72:87], v[148:151], v[160:163], v[72:87]
    v_mfma_f32_32x32x16_bf16 v[88:103], v[148:151], v[164:167], v[88:103]
    s_setprio 3
    buffer_load_dwordx4 v[148:151], v4, s[24:27], s74 offen offset:1024 sc1
    s_add_u32 s74, s74, 8192
    ds_read_b128 v[160:163], v6 offset:16384
    ds_read_b128 v[164:167], v6 offset:24576
    s_waitcnt vmcnt(17)
    s_waitcnt lgkmcnt(2)
    s_setprio 1
    v_mfma_f32_32x32x16_bf16 v[8:23], v[104:107], v[152:155], v[8:23]
    v_mfma_f32_32x32x16_bf16 v[24:39], v[104:107], v[156:159], v[24:39]
    buffer_load_dwordx4 v[104:107], v4, s[24:27], s72 offen offset:0 sc1
    v_mfma_f32_32x32x16_bf16 v[40:55], v[108:111], v[152:155], v[40:55]
    v_mfma_f32_32x32x16_bf16 v[56:71], v[108:111], v[156:159], v[56:71]
    buffer_load_dwordx4 v[108:111], v4, s[24:27], s73 offen offset:0 sc1
    v_mfma_f32_32x32x16_bf16 v[72:87], v[112:115], v[152:155], v[72:87]
    v_mfma_f32_32x32x16_bf16 v[88:103], v[112:115], v[156:159], v[88:103]
    s_setprio 3
    buffer_load_dwordx4 v[112:115], v4, s[24:27], s74 offen offset:0 sc1
    s_waitcnt vmcnt(16)
    s_waitcnt lgkmcnt(0)
    v_mov_b32 v7, 1
    s_mov_b64 exec, 1
    ds_add_u32 v4, v7 offset:61448
    s_mov_b64 exec, -1
    ds_read_b32 v7, v4 offset:61448
m_gs13:
    s_waitcnt lgkmcnt(0)
    v_readfirstlane_b32 s34, v7
    s_cmp_ge_u32 s34, 52
    s_cbranch_scc1 m_gs13_ok
    s_sleep 1
    ds_read_b32 v7, v4 offset:61448
    s_branch m_gs13
m_gs13_ok:
    s_add_u32 m0, s18, 16384
    s_nop 0
    buffer_load_dwordx4 v0, s[20:23], s64 offen offset:0 lds
    buffer_load_dwordx4 v1, s[20:23], s64 offen offset:1024 lds
    buffer_load_dwordx4 v2, s[20:23], s64 offen offset:2048 lds
    buffer_load_dwordx4 v3, s[20:23], s64 offen offset:3072 lds
    s_add_u32 s64, s64, 256
    ds_read_b128 v[152:155], v5 offset:32768
    ds_read_b128 v[156:159], v5 offset:40960
    s_waitcnt vmcnt(17)
    s_setprio 1
    v_mfma_f32_32x32x16_bf16 v[8:23], v[116:119], v[160:163], v[8:23]
    v_mfma_f32_32x32x16_bf16 v[24:39], v[116:119], v[164:167], v[24:39]
    buffer_load_dwordx4 v[116:119], v4, s[24:27], s72 offen offset:1024 sc1
    s_add_u32 s72, s72, 8192
    v_mfma_f32_32x32x16_bf16 v[40:55], v[120:123], v[160:163], v[40:55]
    v_mfma_f32_32x32x16_bf16 v[56:71], v[120:123], v[164:167], v[56:71]
    buffer_load_dwordx4 v[120:123], v4, s[24:27], s73 offen offset:1024 sc1
    s_add_u32 s73, s73, 8192
    v_mfma_f32_32x32x16_bf16 v[72:87], v[124:127], v[160:163], v[72:87]
    v_mfma_f32_32x32x16_bf16 v[88:103], v[124:127], v[164:167], v[88:103]
    s_setprio 3
    buffer_load_dwordx4 v[124:127], v4, s[24:27], s74 offen offset:1024 sc1
    s_add_u32 s74, s74, 8192
    ds_read_b128 v[160:163], v6 offset:32768
    ds_read_b128 v[164:167], v6 offset:40960
    s_waitcnt vmcnt(17)
    s_waitcnt lgkmcnt(2)
    s_setprio 1
    v_mfma_f32_32x32x16_bf16 v[8:23], v[128:131], v[152:155], v[8:23]
    v_mfma_f32_32x32x16_bf16 v[24:39], v[128:131], v[156:159], v[24:39]
    buffer_load_dwordx4 v[128:131], v4, s[24:27], s72 offen offset:0 sc1
    v_mfma_f32_32x32x16_bf16 v[40:55], v[132:135], v[152:155], v[40:55]
    v_mfma_f32_32x32x16_bf16 v[56:71], v[132:135], v[156:159], v[56:71]
    buffer_load_dwordx4 v[132:135], v4, s[24:27], s73 offen offset:0 sc1
    v_mfma_f32_32x32x16_bf16 v[72:87], v[136:139], v[152:155], v[72:87]
    v_mfma_f32_32x32x16_bf16 v[88:103], v[136:139], v[156:159], v[88:103]
    s_setprio 3
    buffer_load_dwordx4 v[136:139], v4, s[24:27], s74 offen offset:0 sc1
    s_waitcnt vmcnt(16)
    s_waitcnt lgkmcnt(0)
    v_mov_b32 v7, 1
    s_mov_b64 exec, 1
    ds_add_u32 v4, v7 offset:61448
    s_mov_b64 exec, -1
    ds_read_b32 v7, v4 offset:61448
m_gs14:
    s_waitcnt lgkmcnt(0)
    v_readfirstlane_b32 s34, v7
    s_cmp_ge_u32 s34, 56
    s_cbranch_scc1 m_gs14_ok
    s_sleep 1
    ds_read_b32 v7, v4 offset:61448
    s_branch m_gs14
m_gs14_ok:
    s_add_u32 m0, s18, 32768
    s_nop 0
    buffer_load_dwordx4 v0, s[20:23], s64 offen offset:0 lds
    buffer_load_dwordx4 v1, s[20:23], s64 offen offset:1024 lds
    buffer_load_dwordx4 v2, s[20:23], s64 offen offset:2048 lds
    buffer_load_dwordx4 v3, s[20:23], s64 offen offset:3072 lds
    s_add_u32 s64, s64, 256
    ds_read_b128 v[152:155], v5 offset:0
    ds_read_b128 v[156:159], v5 offset:8192
    s_waitcnt vmcnt(17)
    s_setprio 1
    v_mfma_f32_32x32x16_bf16 v[8:23], v[140:143], v[160:163], v[8:23]
    v_mfma_f32_32x32x16_bf16 v[24:39], v[140:143], v[164:167], v[24:39]
    buffer_load_dwordx4 v[140:143], v4, s[24:27], s72 offen offset:1024 sc1
    s_add_u32 s72, s72, 8192
    v_mfma_f32_32x32x16_bf16 v[40:55], v[144:147], v[160:163], v[40:55]
    v_mfma_f32_32x32x16_bf16 v[56:71], v[144:147], v[164:167], v[56:71]
    buffer_load_dwordx4 v[144:147], v4, s[24:27], s73 offen offset:1024 sc1
    s_add_u32 s73, s73, 8192
    v_mfma_f32_32x32x16_bf16 v[72:87], v[148:151], v[160:163], v[72:87]
    v_mfma_f32_32x32x16_bf16 v[88:103], v[148:151], v[164:167], v[88:103]
    s_setprio 3
    buffer_load_dwordx4 v[148:151], v4, s[24:27], s74 offen offset:1024 sc1
    s_add_u32 s74, s74, 8192
    ds_read_b128 v[160:163], v6 offset:0
    ds_read_b128 v[164:167], v6 offset:8192
    s_waitcnt vmcnt(17)
    s_waitcnt lgkmcnt(2)
    s_setprio 1
    v_mfma_f32_32x32x16_bf16 v[8:23], v[104:107], v[152:155], v[8:23]
    v_mfma_f32_32x32x16_bf16 v[24:39], v[104:107], v[156:159], v[24:39]
    buffer_load_dwordx4 v[104:107], v4, s[24:27], s72 offen offset:0 sc1
    v_mfma_f32_32x32x16_bf16 v[40:55], v[108:111], v[152:155], v[40:55]
    v_mfma_f32_32x32x16_bf16 v[56:71], v[108:111], v[156:159], v[56:71]
    buffer_load_dwordx4 v[108:111], v4, s[24:27], s73 offen offset:0 sc1
    v_mfma_f32_32x32x16_bf16 v[72:87], v[112:115], v[152:155], v[72:87]
    v_mfma_f32_32x32x16_bf16 v[88:103], v[112:115], v[156:159], v[88:103]
    s_setprio 3
    buffer_load_dwordx4 v[112:115], v4, s[24:27], s74 offen offset:0 sc1
    s_waitcnt vmcnt(16)
    s_waitcnt lgkmcnt(0)
    v_mov_b32 v7, 1
    s_mov_b64 exec, 1
    ds_add_u32 v4, v7 offset:61448
    s_mov_b64 exec, -1
    ds_read_b32 v7, v4 offset:61448
m_gs15:
    s_waitcnt lgkmcnt(0)
    v_readfirstlane_b32 s34, v7
    s_cmp_ge_u32 s34, 60
    s_cbranch_scc1 m_gs15_ok
    s_sleep 1
    ds_read_b32 v7, v4 offset:61448
    s_branch m_gs15
m_gs15_ok:
    s_add_u32 m0, s18, 0
    s_nop 0
    buffer_load_dwordx4 v0, s[20:23], s64 offen offset:0 lds
    buffer_load_dwordx4 v1, s[20:23], s64 offen offset:1024 lds
    buffer_load_dwordx4 v2, s[20:23], s64 offen offset:2048 lds
    buffer_load_dwordx4 v3, s[20:23], s64 offen offset:3072 lds
    s_add_u32 s64, s64, 256
    ds_read_b128 v[152:155], v5 offset:16384
    ds_read_b128 v[156:159], v5 offset:24576
    s_waitcnt vmcnt(17)
    s_setprio 1
    v_mfma_f32_32x32x16_bf16 v[8:23], v[116:119], v[160:163], v[8:23]
    v_mfma_f32_32x32x16_bf16 v[24:39], v[116:119], v[164:167], v[24:39]
    buffer_load_dwordx4 v[116:119], v4, s[24:27], s72 offen offset:1024 sc1
    s_add_u32 s72, s72, 8192
    v_mfma_f32_32x32x16_bf16 v[40:55], v[120:123], v[160:163], v[40:55]
    v_mfma_f32_32x32x16_bf16 v[56:71], v[120:123], v[164:167], v[56:71]
    buffer_load_dwordx4 v[120:123], v4, s[24:27], s73 offen offset:1024 sc1
    s_add_u32 s73, s73, 8192
    v_mfma_f32_32x32x16_bf16 v[72:87], v[124:127], v[160:163], v[72:87]
    v_mfma_f32_32x32x16_bf16 v[88:103], v[124:127], v[164:167], v[88:103]
    s_setprio 3
    buffer_load_dwordx4 v[124:127], v4, s[24:27], s74 offen offset:1024 sc1
    s_add_u32 s74, s74, 8192
    ds_read_b128 v[160:163], v6 offset:16384
    ds_read_b128 v[164:167], v6 offset:24576
    s_waitcnt vmcnt(17)
    s_waitcnt lgkmcnt(2)
    s_setprio 1
    v_mfma_f32_32x32x16_bf16 v[8:23], v[128:131], v[152:155], v[8:23]
    v_mfma_f32_32x32x16_bf16 v[24:39], v[128:131], v[156:159], v[24:39]
    buffer_load_dwordx4 v[128:131], v4, s[24:27], s72 offen offset:0 sc1
    v_mfma_f32_32x32x16_bf16 v[40:55], v[132:135], v[152:155], v[40:55]
    v_mfma_f32_32x32x16_bf16 v[56:71], v[132:135], v[156:159], v[56:71]
    buffer_load_dwordx4 v[132:135], v4, s[24:27], s73 offen offset:0 sc1
    v_mfma_f32_32x32x16_bf16 v[72:87], v[136:139], v[152:155], v[72:87]
    v_mfma_f32_32x32x16_bf16 v[88:103], v[136:139], v[156:159], v[88:103]
    s_setprio 3
    buffer_load_dwordx4 v[136:139], v4, s[24:27], s74 offen offset:0 sc1
    s_waitcnt vmcnt(16)
    s_waitcnt lgkmcnt(0)
    v_mov_b32 v7, 1
    s_mov_b64 exec, 1
    ds_add_u32 v4, v7 offset:61448
    s_mov_b64 exec, -1
    ds_read_b32 v7, v4 offset:61448
m_gs16:
    s_waitcnt lgkmcnt(0)
    v_readfirstlane_b32 s34, v7
    s_cmp_ge_u32 s34, 64
    s_cbranch_scc1 m_gs16_ok
    s_sleep 1
    ds_read_b32 v7, v4 offset:61448
    s_branch m_gs16
m_gs16_ok:
    ds_read_b128 v[152:155], v5 offset:32768
    ds_read_b128 v[156:159], v5 offset:40960
    s_waitcnt vmcnt(13)
    s_setprio 1
    v_mfma_f32_32x32x16_bf16 v[8:23], v[140:143], v[160:163], v[8:23]
    v_mfma_f32_32x32x16_bf16 v[24:39], v[140:143], v[164:167], v[24:39]
    buffer_load_dwordx4 v[140:143], v4, s[24:27], s72 offen offset:1024 sc1
    s_add_u32 s72, s72, 8192
    v_mfma_f32_32x32x16_bf16 v[40:55], v[144:147], v[160:163], v[40:55]
    v_mfma_f32_32x32x16_bf16 v[56:71], v[144:147], v[164:167], v[56:71]
    buffer_load_dwordx4 v[144:147], v4, s[24:27], s73 offen offset:1024 sc1
    s_add_u32 s73, s73, 8192
    v_mfma_f32_32x32x16_bf16 v[72:87], v[148:151], v[160:163], v[72:87]
    v_mfma_f32_32x32x16_bf16 v[88:103], v[148:151], v[164:167], v[88:103]
    s_setprio 3
    buffer_load_dwordx4 v[148:151], v4, s[24:27], s74 offen offset:1024 sc1
    s_add_u32 s74, s74, 8192
    ds_read_b128 v[160:163], v6 offset:32768
    ds_read_b128 v[164:167], v6 offset:40960
    s_waitcnt vmcnt(13)
    s_waitcnt lgkmcnt(2)
    s_setprio 1
    v_mfma_f32_32x32x16_bf16 v[8:23], v[104:107], v[152:155], v[8:23]
    v_mfma_f32_32x32x16_bf16 v[24:39], v[104:107], v[156:159], v[24:39]
    v_mfma_f32_32x32x16_bf16 v[40:55], v[108:111], v[152:155], v[40:55]
    v_mfma_f32_32x32x16_bf16 v[56:71], v[108:111], v[156:159], v[56:71]
    v_mfma_f32_32x32x16_bf16 v[72:87], v[112:115], v[152:155], v[72:87]
    v_mfma_f32_32x32x16_bf16 v[88:103], v[112:115], v[156:159], v[88:103]
    s_setprio 3
    buffer_load_dwordx4 v[104:107], v4, s[28:31], s38 offen offset:0 sc1
    buffer_load_dwordx4 v[108:111], v4, s[28:31], s38 offen offset:2048 sc1
    buffer_load_dwordx4 v[112:115], v4, s[28:31], s40 offen offset:0 sc1
    v_bfe_u32 v2, v4, 3, 6
    buffer_load_ushort v3, v2, s[48:51], s36 offen
    s_waitcnt vmcnt(13)
    s_waitcnt lgkmcnt(0)
    v_mov_b32 v7, 1
    s_mov_b64 exec, 1
    ds_add_u32 v4, v7 offset:61448
    s_mov_b64 exec, -1
    ds_read_b32 v7, v4 offset:61448
m_gs17:
    s_waitcnt lgkmcnt(0)
    v_readfirstlane_b32 s34, v7
    s_cmp_ge_u32 s34, 68
    s_cbranch_scc1 m_gs17_ok
    s_sleep 1
    ds_read_b32 v7, v4 offset:61448
    s_branch m_gs17
m_gs17_ok:
    ds_read_b128 v[152:155], v5 offset:0
    ds_read_b128 v[156:159], v5 offset:8192
    s_waitcnt vmcnt(10)
    s_setprio 1
    v_mfma_f32_32x32x16_bf16 v[8:23], v[116:119], v[160:163], v[8:23]
    v_mfma_f32_32x32x16_bf16 v[24:39], v[116:119], v[164:167], v[24:39]
    v_mfma_f32_32x32x16_bf16 v[40:55], v[120:123], v[160:163], v[40:55]
    v_mfma_f32_32x32x16_bf16 v[56:71], v[120:123], v[164:167], v[56:71]
    v_mfma_f32_32x32x16_bf16 v[72:87], v[124:127], v[160:163], v[72:87]
    v_mfma_f32_32x32x16_bf16 v[88:103], v[124:127], v[164:167], v[88:103]
    s_setprio 3
    ds_read_b128 v[160:163], v6 offset:0
    ds_read_b128 v[164:167], v6 offset:8192
    s_waitcnt vmcnt(7)
    s_waitcnt lgkmcnt(2)
    s_setprio 1
    v_mfma_f32_32x32x16_bf16 v[8:23], v[128:131], v[152:155], v[8:23]
    v_mfma_f32_32x32x16_bf16 v[24:39], v[128:131], v[156:159], v[24:39]
    v_mfma_f32_32x32x16_bf16 v[40:55], v[132:135], v[152:155], v[40:55]
    v_mfma_f32_32x32x16_bf16 v[56:71], v[132:135], v[156:159], v[56:71]
    v_mfma_f32_32x32x16_bf16 v[72:87], v[136:139], v[152:155], v[72:87]
    v_mfma_f32_32x32x16_bf16 v[88:103], v[136:139], v[156:159], v[88:103]
    s_setprio 3
    s_waitcnt vmcnt(4)
    s_waitcnt lgkmcnt(0)
    s_setprio 1
    v_mfma_f32_32x32x16_bf16 v[8:23], v[140:143], v[160:163], v[8:23]
    v_mfma_f32_32x32x16_bf16 v[24:39], v[140:143], v[164:167], v[24:39]
    v_mfma_f32_32x32x16_bf16 v[40:55], v[144:147], v[160:163], v[40:55]
    v_mfma_f32_32x32x16_bf16 v[56:71], v[144:147], v[164:167], v[56:71]
    v_mfma_f32_32x32x16_bf16 v[72:87], v[148:151], v[160:163], v[72:87]
    v_mfma_f32_32x32x16_bf16 v[88:103], v[148:151], v[164:167], v[88:103]
    s_setprio 3
    s_setprio 3
    s_sub_u32 s79, s12, 1
    s_and_b32 s79, s79, 3
    s_add_u32 s79, s79, 0
    s_mul_i32 s79, s79, 2048
    v_add_u32 v163, s79, v4
    s_sub_u32 s79, s12, 2
    s_and_b32 s79, s79, 3
    s_add_u32 s79, s79, 3
    s_mul_i32 s79, s79, 2048
    v_add_u32 v164, s79, v4
    s_sub_u32 s79, s12, 3
    s_and_b32 s79, s79, 3
    s_add_u32 s79, s79, 6
    s_mul_i32 s79, s79, 2048
    v_add_u32 v165, s79, v4
    s_sub_u32 s79, s12, 4
    s_and_b32 s79, s79, 3
    s_add_u32 s79, s79, 9
    s_mul_i32 s79, s79, 2048
    v_add_u32 v166, s79, v4
    s_mul_i32 s79, s12, 6144
    v_add_u32 v1, s79, v4
    v_mov_b32 v7, 1
    s_mov_b64 exec, 1
    ds_add_u32 v4, v7 offset:61448
    s_mov_b64 exec, -1
    ds_read_b32 v7, v4 offset:61448
m_gs18:
    s_waitcnt lgkmcnt(0)
    v_readfirstlane_b32 s34, v7
    s_cmp_ge_u32 s34, 72
    s_cbranch_scc1 m_gs18_ok
    s_sleep 1
    ds_read_b32 v7, v4 offset:61448
    s_branch m_gs18
m_gs18_ok:
    s_cmp_lg_u32 s12, 0
    s_cselect_b64 exec, -1, 0
    ds_write_b128 v163, v[8:11] offset:0
    ds_write_b128 v163, v[12:15] offset:1024
    s_mov_b64 exec, -1
    s_cmp_lg_u32 s12, 1
    s_cselect_b64 exec, -1, 0
    ds_write_b128 v164, v[16:19] offset:0
    ds_write_b128 v164, v[20:23] offset:1024
    s_mov_b64 exec, -1
    s_cmp_lg_u32 s12, 2
    s_cselect_b64 exec, -1, 0
    ds_write_b128 v165, v[24:27] offset:0
    ds_write_b128 v165, v[28:31] offset:1024
    s_mov_b64 exec, -1
    s_cmp_lg_u32 s12, 3
    s_cselect_b64 exec, -1, 0
    ds_write_b128 v166, v[32:35] offset:0
    ds_write_b128 v166, v[36:39] offset:1024
    s_mov_b64 exec, -1
    s_cmp_lg_u32 s12, 0
    s_cselect_b64 exec, -1, 0
    ds_write_b128 v163, v[40:43] offset:24576
    ds_write_b128 v163, v[44:47] offset:25600
    s_mov_b64 exec, -1
    s_cmp_lg_u32 s12, 1
    s_cselect_b64 exec, -1, 0
    ds_write_b128 v164, v[48:51] offset:24576
    ds_write_b128 v164, v[52:55] offset:25600
    s_mov_b64 exec, -1
    s_cmp_lg_u32 s12, 2
    s_cselect_b64 exec, -1, 0
    ds_write_b128 v165, v[56:59] offset:24576
    ds_write_b128 v165, v[60:63] offset:25600
    s_mov_b64 exec, -1
    s_cmp_lg_u32 s12, 3
    s_cselect_b64 exec, -1, 0
    ds_write_b128 v166, v[64:67] offset:24576
    ds_write_b128 v166, v[68:71] offset:25600
    s_mov_b64 exec, -1
    v_add_u32 v163, 139264, v163
    s_cmp_lg_u32 s12, 0
    s_cselect_b64 exec, -1, 0
    ds_write_b128 v163, v[72:75] offset:0
    ds_write_b128 v163, v[76:79] offset:1024
    s_mov_b64 exec, -1
    v_add_u32 v164, 139264, v164
    s_cmp_lg_u32 s12, 1
    s_cselect_b64 exec, -1, 0
    ds_write_b128 v164, v[80:83] offset:0
    ds_write_b128 v164, v[84:87] offset:1024
    s_mov_b64 exec, -1
    v_add_u32 v165, 139264, v165
    s_cmp_lg_u32 s12, 2
    s_cselect_b64 exec, -1, 0
    ds_write_b128 v165, v[88:91] offset:0
    ds_write_b128 v165, v[92:95] offset:1024
    s_mov_b64 exec, -1
    v_add_u32 v166, 139264, v166
    s_cmp_lg_u32 s12, 3
    s_cselect_b64 exec, -1, 0
    ds_write_b128 v166, v[96:99] offset:0
    ds_write_b128 v166, v[100:103] offset:1024
    s_mov_b64 exec, -1
    s_waitcnt vmcnt(0)
    v_lshlrev_b32 v2, 16, v3
    v_add_u32 v0, 139264, v1
    s_waitcnt lgkmcnt(0)
    v_mov_b32 v7, 1
    s_mov_b64 exec, 1
    ds_add_u32 v4, v7 offset:61448
    s_mov_b64 exec, -1
    ds_read_b32 v7, v4 offset:61448
m_gs19:
    s_waitcnt lgkmcnt(0)
    v_readfirstlane_b32 s34, v7
    s_cmp_ge_u32 s34, 76
    s_cbranch_scc1 m_gs19_ok
    s_sleep 1
    ds_read_b32 v7, v4 offset:61448
    s_branch m_gs19
m_gs19_ok:
    ds_read_b128 v[120:123], v1 offset:0
    ds_read_b128 v[124:127], v1 offset:1024
    ds_read_b128 v[128:131], v1 offset:2048
    ds_read_b128 v[132:135], v1 offset:3072
    ds_read_b128 v[136:139], v1 offset:4096
    ds_read_b128 v[140:143], v1 offset:5120
    ds_read_b128 v[144:147], v1 offset:24576
    ds_read_b128 v[148:151], v1 offset:25600
    ds_read_b128 v[152:155], v1 offset:26624
    ds_read_b128 v[156:159], v1 offset:27648
    ds_read_b128 v[160:163], v1 offset:28672
    ds_read_b128 v[164:167], v1 offset:29696
    s_waitcnt lgkmcnt(6)
    v_pk_add_f32 v[120:121], v[120:121], v[128:129]
    v_pk_add_f32 v[136:137], v[136:137], v[2:3] op_sel_hi:[1,0]
    v_pk_add_f32 v[122:123], v[122:123], v[130:131]
    v_pk_add_f32 v[138:139], v[138:139], v[2:3] op_sel_hi:[1,0]
    v_pk_add_f32 v[124:125], v[124:125], v[132:133]
    v_pk_add_f32 v[140:141], v[140:141], v[2:3] op_sel_hi:[1,0]
    v_pk_add_f32 v[126:127], v[126:127], v[134:135]
    v_pk_add_f32 v[142:143], v[142:143], v[2:3] op_sel_hi:[1,0]
    s_cmp_lg_u32 s12, 0
    s_cbranch_scc1 m_oau0_0
    v_pk_add_f32 v[120:121], v[120:121], v[8:9]
    v_pk_add_f32 v[122:123], v[122:123], v[10:11]
    v_pk_add_f32 v[124:125], v[124:125], v[12:13]
    v_pk_add_f32 v[126:127], v[126:127], v[14:15]
    s_branch m_oau0_e
m_oau0_0:
    s_cmp_lg_u32 s12, 1
    s_cbranch_scc1 m_oau0_1
    v_pk_add_f32 v[120:121], v[120:121], v[16:17]
    v_pk_add_f32 v[122:123], v[122:123], v[18:19]
    v_pk_add_f32 v[124:125], v[124:125], v[20:21]
    v_pk_add_f32 v[126:127], v[126:127], v[22:23]
    s_branch m_oau0_e
m_oau0_1:
    s_cmp_lg_u32 s12, 2
    s_cbranch_scc1 m_oau0_2
    v_pk_add_f32 v[120:121], v[120:121], v[24:25]
    v_pk_add_f32 v[122:123], v[122:123], v[26:27]
    v_pk_add_f32 v[124:125], v[124:125], v[28:29]
    v_pk_add_f32 v[126:127], v[126:127], v[30:31]
    s_branch m_oau0_e
m_oau0_2:
    v_pk_add_f32 v[120:121], v[120:121], v[32:33]
    v_pk_add_f32 v[122:123], v[122:123], v[34:35]
    v_pk_add_f32 v[124:125], v[124:125], v[36:37]
    v_pk_add_f32 v[126:127], v[126:127], v[38:39]
m_oau0_e:
    v_pk_add_f32 v[16:17], v[120:121], v[136:137]
    v_pk_add_f32 v[18:19], v[122:123], v[138:139]
    v_pk_add_f32 v[20:21], v[124:125], v[140:141]
    v_pk_add_f32 v[22:23], v[126:127], v[142:143]
    ds_read_b128 v[120:123], v0 offset:0
    ds_read_b128 v[124:127], v0 offset:1024
    ds_read_b128 v[128:131], v0 offset:2048
    ds_read_b128 v[132:135], v0 offset:3072
    ds_read_b128 v[136:139], v0 offset:4096
    ds_read_b128 v[140:143], v0 offset:5120
    v_lshlrev_b32 v8, 16, v104
    v_and_b32 v9, 0xffff0000, v104
    v_lshlrev_b32 v10, 16, v105
    v_and_b32 v11, 0xffff0000, v105
    v_lshlrev_b32 v12, 16, v106
    v_and_b32 v13, 0xffff0000, v106
    v_lshlrev_b32 v14, 16, v107
    v_and_b32 v15, 0xffff0000, v107
    v_pk_mul_f32 v[16:17], v[16:17], v[8:9]
    v_pk_mul_f32 v[18:19], v[18:19], v[10:11]
    v_pk_mul_f32 v[20:21], v[20:21], v[12:13]
    v_pk_mul_f32 v[22:23], v[22:23], v[14:15]
    v_cvt_pk_bf16_f32 v24, v16, v17
    v_cvt_pk_bf16_f32 v25, v18, v19
    v_cvt_pk_bf16_f32 v26, v20, v21
    v_cvt_pk_bf16_f32 v27, v22, v23
    s_add_u32 s36, s37, 0
    s_cmp_ge_u32 s36, 43
    s_cbranch_scc1 m_g_ns0
    buffer_store_dwordx4 v[24:27], v4, s[28:31], s39 offen offset:0 sc1
m_g_ns0:
    s_waitcnt lgkmcnt(6)
    v_pk_add_f32 v[144:145], v[144:145], v[152:153]
    v_pk_add_f32 v[160:161], v[160:161], v[2:3] op_sel_hi:[1,0]
    v_pk_add_f32 v[146:147], v[146:147], v[154:155]
    v_pk_add_f32 v[162:163], v[162:163], v[2:3] op_sel_hi:[1,0]
    v_pk_add_f32 v[148:149], v[148:149], v[156:157]
    v_pk_add_f32 v[164:165], v[164:165], v[2:3] op_sel_hi:[1,0]
    v_pk_add_f32 v[150:151], v[150:151], v[158:159]
    v_pk_add_f32 v[166:167], v[166:167], v[2:3] op_sel_hi:[1,0]
    s_cmp_lg_u32 s12, 0
    s_cbranch_scc1 m_oau1_0
    v_pk_add_f32 v[144:145], v[144:145], v[40:41]
    v_pk_add_f32 v[146:147], v[146:147], v[42:43]
    v_pk_add_f32 v[148:149], v[148:149], v[44:45]
    v_pk_add_f32 v[150:151], v[150:151], v[46:47]
    s_branch m_oau1_e
m_oau1_0:
    s_cmp_lg_u32 s12, 1
    s_cbranch_scc1 m_oau1_1
    v_pk_add_f32 v[144:145], v[144:145], v[48:49]
    v_pk_add_f32 v[146:147], v[146:147], v[50:51]
    v_pk_add_f32 v[148:149], v[148:149], v[52:53]
    v_pk_add_f32 v[150:151], v[150:151], v[54:55]
    s_branch m_oau1_e
m_oau1_1:
    s_cmp_lg_u32 s12, 2
    s_cbranch_scc1 m_oau1_2
    v_pk_add_f32 v[144:145], v[144:145], v[56:57]
    v_pk_add_f32 v[146:147], v[146:147], v[58:59]
    v_pk_add_f32 v[148:149], v[148:149], v[60:61]
    v_pk_add_f32 v[150:151], v[150:151], v[62:63]
    s_branch m_oau1_e
m_oau1_2:
    v_pk_add_f32 v[144:145], v[144:145], v[64:65]
    v_pk_add_f32 v[146:147], v[146:147], v[66:67]
    v_pk_add_f32 v[148:149], v[148:149], v[68:69]
    v_pk_add_f32 v[150:151], v[150:151], v[70:71]
m_oau1_e:
    v_pk_add_f32 v[48:49], v[144:145], v[160:161]
    v_pk_add_f32 v[50:51], v[146:147], v[162:163]
    v_pk_add_f32 v[52:53], v[148:149], v[164:165]
    v_pk_add_f32 v[54:55], v[150:151], v[166:167]
    v_lshlrev_b32 v40, 16, v108
    v_and_b32 v41, 0xffff0000, v108
    v_lshlrev_b32 v42, 16, v109
    v_and_b32 v43, 0xffff0000, v109
    v_lshlrev_b32 v44, 16, v110
    v_and_b32 v45, 0xffff0000, v110
    v_lshlrev_b32 v46, 16, v111
    v_and_b32 v47, 0xffff0000, v111
    v_pk_mul_f32 v[48:49], v[48:49], v[40:41]
    v_pk_mul_f32 v[50:51], v[50:51], v[42:43]
    v_pk_mul_f32 v[52:53], v[52:53], v[44:45]
    v_pk_mul_f32 v[54:55], v[54:55], v[46:47]
    v_cvt_pk_bf16_f32 v56, v48, v49
    v_cvt_pk_bf16_f32 v57, v50, v51
    v_cvt_pk_bf16_f32 v58, v52, v53
    v_cvt_pk_bf16_f32 v59, v54, v55
    s_add_u32 s36, s37, 2
    s_cmp_ge_u32 s36, 43
    s_cbranch_scc1 m_g_ns1
    buffer_store_dwordx4 v[56:59], v4, s[28:31], s39 offen offset:2048 sc1
m_g_ns1:
    s_waitcnt lgkmcnt(0)
    v_pk_add_f32 v[120:121], v[120:121], v[128:129]
    v_pk_add_f32 v[136:137], v[136:137], v[2:3] op_sel_hi:[1,0]
    v_pk_add_f32 v[122:123], v[122:123], v[130:131]
    v_pk_add_f32 v[138:139], v[138:139], v[2:3] op_sel_hi:[1,0]
    v_pk_add_f32 v[124:125], v[124:125], v[132:133]
    v_pk_add_f32 v[140:141], v[140:141], v[2:3] op_sel_hi:[1,0]
    v_pk_add_f32 v[126:127], v[126:127], v[134:135]
    v_pk_add_f32 v[142:143], v[142:143], v[2:3] op_sel_hi:[1,0]
    s_cmp_lg_u32 s12, 0
    s_cbranch_scc1 m_oau2_0
    v_pk_add_f32 v[120:121], v[120:121], v[72:73]
    v_pk_add_f32 v[122:123], v[122:123], v[74:75]
    v_pk_add_f32 v[124:125], v[124:125], v[76:77]
    v_pk_add_f32 v[126:127], v[126:127], v[78:79]
    s_branch m_oau2_e
m_oau2_0:
    s_cmp_lg_u32 s12, 1
    s_cbranch_scc1 m_oau2_1
    v_pk_add_f32 v[120:121], v[120:121], v[80:81]
    v_pk_add_f32 v[122:123], v[122:123], v[82:83]
    v_pk_add_f32 v[124:125], v[124:125], v[84:85]
    v_pk_add_f32 v[126:127], v[126:127], v[86:87]
    s_branch m_oau2_e
m_oau2_1:
    s_cmp_lg_u32 s12, 2
    s_cbranch_scc1 m_oau2_2
    v_pk_add_f32 v[120:121], v[120:121], v[88:89]
    v_pk_add_f32 v[122:123], v[122:123], v[90:91]
    v_pk_add_f32 v[124:125], v[124:125], v[92:93]
    v_pk_add_f32 v[126:127], v[126:127], v[94:95]
    s_branch m_oau2_e
m_oau2_2:
    v_pk_add_f32 v[120:121], v[120:121], v[96:97]
    v_pk_add_f32 v[122:123], v[122:123], v[98:99]
    v_pk_add_f32 v[124:125], v[124:125], v[100:101]
    v_pk_add_f32 v[126:127], v[126:127], v[102:103]
m_oau2_e:
    v_pk_add_f32 v[80:81], v[120:121], v[136:137]
    v_pk_add_f32 v[82:83], v[122:123], v[138:139]
    v_pk_add_f32 v[84:85], v[124:125], v[140:141]
    v_pk_add_f32 v[86:87], v[126:127], v[142:143]
    v_lshlrev_b32 v72, 16, v112
    v_and_b32 v73, 0xffff0000, v112
    v_lshlrev_b32 v74, 16, v113
    v_and_b32 v75, 0xffff0000, v113
    v_lshlrev_b32 v76, 16, v114
    v_and_b32 v77, 0xffff0000, v114
    v_lshlrev_b32 v78, 16, v115
    v_and_b32 v79, 0xffff0000, v115
    v_pk_mul_f32 v[80:81], v[80:81], v[72:73]
    v_pk_mul_f32 v[82:83], v[82:83], v[74:75]
    v_pk_mul_f32 v[84:85], v[84:85], v[76:77]
    v_pk_mul_f32 v[86:87], v[86:87], v[78:79]
    v_cvt_pk_bf16_f32 v88, v80, v81
    v_cvt_pk_bf16_f32 v89, v82, v83
    v_cvt_pk_bf16_f32 v90, v84, v85
    v_cvt_pk_bf16_f32 v91, v86, v87
    s_add_u32 s36, s37, 4
    s_cmp_ge_u32 s36, 43
    s_cbranch_scc1 m_g_ns2
    buffer_store_dwordx4 v[88:91], v4, s[28:31], s41 offen offset:0 sc1
m_g_ns2:
    s_lshl_b32 s36, s15, 5
    s_lshl_b32 s37, s16, 2
    s_add_u32 s37, s37, s12
    s_add_u32 s37, s37, s36
    s_lshl_b32 s37, s37, 5
    s_add_u32 s65, s37, 24969216
    s_lshl_b32 s36, s36, 5
    s_add_u32 s66, s36, 24969216
    s_lshl_b32 s37, s12, 8
    s_add_u32 s67, s36, s37
    s_add_u32 s67, s67, 24903680
    s_mul_i32 s17, s12, 11
    s_cmp_lt_u32 s12, 3
    s_cselect_b32 s36, 32, 31
    s_add_u32 s17, s17, s36
    s_mul_i32 s36, s15, 150
    s_lshl_b32 s68, s36, 10
    s_add_u32 s68, s68, 16777216
    s_mul_i32 s36, s16, 150
    s_lshl_b32 s69, s36, 10
    s_add_u32 s69, s69, 23068672
    s_lshl_b32 s17, s17, 10
    s_add_u32 s40, s68, s17
    s_add_u32 s41, s40, 76800
    s_add_u32 s42, s69, s17
    s_add_u32 s43, s42, 76800
    s_lshl_b32 s17, s12, 13
    s_add_u32 s68, s68, s17
    s_add_u32 s69, s69, s17
    s_add_u32 s70, s68, 76800
    s_add_u32 s71, s69, 76800
    v_lshlrev_b32 v161, 1, v4
    v_and_b32 v161, 0x3ff, v161
    v_mov_b32 v162, s61
    s_waitcnt vmcnt(0)
    buffer_store_dword v162, off, s[28:31], s65 sc1
    v_lshlrev_b32 v8, 1, v4
    s_mov_b32 s72, 25198592
    s_mov_b32 s73, 25200640
    s_mov_b32 s74, 25202688
    s_mov_b32 s75, 25204736
    s_mov_b32 s33, 0x100000
m_pollw:
    buffer_load_dword v10, v8, s[28:31], s72 offen sc1
    buffer_load_dword v11, v8, s[28:31], s73 offen sc1
    buffer_load_dword v12, v8, s[28:31], s74 offen sc1
    buffer_load_dword v13, v8, s[28:31], s75 offen sc1
    s_waitcnt vmcnt(0)
    v_xor_b32 v10, s61, v10
    v_bitop3_b32 v10, v10, v11, s61 bitop3:0xf6
    v_bitop3_b32 v10, v10, v12, s61 bitop3:0xf6
    v_bitop3_b32 v10, v10, v13, s61 bitop3:0xf6
    v_cmp_ne_u32 vcc, 0, v10
    s_cbranch_vccz m_pollw_ok
    s_sleep 4
    s_sub_u32 s33, s33, 1
    s_cmp_lg_u32 s33, 0
    s_cbranch_scc1 m_pollw
m_pollw_ok:
    s_cmp_eq_u32 s12, 3
    s_cselect_b32 s36, 0x80000000, 0
    v_or_b32 v7, s36, v4
    buffer_load_dwordx4 v[80:83], v7, s[28:31], s42 offen offset:0 sc1
    buffer_load_dwordx4 v[84:87], v7, s[28:31], s43 offen offset:0 sc1
    buffer_load_dwordx4 v[96:99], v4, s[28:31], s42 offen offset:1024 sc1
    buffer_load_dwordx4 v[100:103], v4, s[28:31], s43 offen offset:1024 sc1
    buffer_load_dwordx4 v[112:115], v4, s[28:31], s42 offen offset:2048 sc1
    buffer_load_dwordx4 v[116:119], v4, s[28:31], s43 offen offset:2048 sc1
    buffer_load_dwordx4 v[128:131], v4, s[28:31], s42 offen offset:3072 sc1
    buffer_load_dwordx4 v[132:135], v4, s[28:31], s43 offen offset:3072 sc1
    s_add_u32 s42, s42, 4096
    buffer_load_dwordx4 v[144:147], v4, s[28:31], s42 offen offset:0 sc1
    s_add_u32 s43, s43, 4096
    buffer_load_dwordx4 v[148:151], v4, s[28:31], s43 offen offset:0 sc1
    v_bfe_u32 v160, v4, 4, 5
    s_lshl_b32 s36, s15, 6
    s_lshr_b32 s37, s12, 1
    s_lshl_b32 s37, s37, 5
    s_add_u32 s36, s36, s37
    v_add_u32 v160, s36, v160
    v_lshlrev_b32 v160, 10, v160
    v_lshrrev_b32 v7, 9, v4
    v_lshl_add_u32 v160, v7, 4, v160
    s_and_b32 s36, s12, 1
    s_lshl_b32 s36, s36, 6
    s_lshl_b32 s37, s16, 7
    s_add_u32 s36, s36, s37
    v_add_u32 v160, s36, v160
    buffer_load_dwordx4 v[152:155], v160, s[52:55], 0 offen
    buffer_load_dwordx4 v[156:159], v160, s[52:55], 0 offen offset:32
    s_sub_u32 s79, s12, 1
    s_and_b32 s79, s79, 3
    s_add_u32 s79, s79, 0
    s_mul_i32 s79, s79, 4096
    v_add_u32 v163, s79, v4
    s_sub_u32 s79, s12, 2
    s_and_b32 s79, s79, 3
    s_add_u32 s79, s79, 3
    s_mul_i32 s79, s79, 4096
    v_add_u32 v164, s79, v4
    s_sub_u32 s79, s12, 3
    s_and_b32 s79, s79, 3
    s_add_u32 s79, s79, 6
    s_mul_i32 s79, s79, 4096
    v_add_u32 v165, s79, v4
    s_sub_u32 s79, s12, 4
    s_and_b32 s79, s79, 3
    s_add_u32 s79, s79, 9
    s_mul_i32 s79, s79, 4096
    v_add_u32 v166, s79, v4
    s_mul_i32 s79, s12, 12288
    v_add_u32 v1, s79, v4
    s_cmp_lg_u32 s12, 0
    s_cbranch_scc1 m_pollu_ok
    s_mov_b32 s33, 0x100000
m_pollu:
    buffer_load_dword v162, v161, s[28:31], s66 offen sc1
    s_waitcnt vmcnt(0)
    v_xor_b32 v162, s61, v162
    v_cmp_ne_u32 vcc, 0, v162
    s_cbranch_vccz m_pollu_ok
    s_sleep 4
    s_sub_u32 s33, s33, 1
    s_cmp_lg_u32 s33, 0
    s_cbranch_scc1 m_pollu
m_pollu_ok:
    v_mov_b32 v7, 1
    s_mov_b64 exec, 1
    ds_add_u32 v4, v7 offset:61448
    s_mov_b64 exec, -1
    ds_read_b32 v7, v4 offset:61448
m_gs20:
    s_waitcnt lgkmcnt(0)
    v_readfirstlane_b32 s34, v7
    s_cmp_ge_u32 s34, 80
    s_cbranch_scc1 m_gs20_ok
    s_sleep 2
    ds_read_b32 v7, v4 offset:61448
    s_branch m_gs20
m_gs20_ok:
    v_and_b32 v161, 0xff, v161
    buffer_load_dwordx4 v[72:75], v4, s[28:31], s40 offen offset:0 sc1
    buffer_load_dwordx4 v[76:79], v4, s[28:31], s41 offen offset:0 sc1
    buffer_load_dwordx4 v[88:91], v4, s[28:31], s40 offen offset:1024 sc1
    buffer_load_dwordx4 v[92:95], v4, s[28:31], s41 offen offset:1024 sc1
    buffer_load_dwordx4 v[104:107], v4, s[28:31], s40 offen offset:2048 sc1
    buffer_load_dwordx4 v[108:111], v4, s[28:31], s41 offen offset:2048 sc1
    buffer_load_dwordx4 v[120:123], v4, s[28:31], s40 offen offset:3072 sc1
    buffer_load_dwordx4 v[124:127], v4, s[28:31], s41 offen offset:3072 sc1
    s_add_u32 s40, s40, 4096
    buffer_load_dwordx4 v[136:139], v4, s[28:31], s40 offen offset:0 sc1
    s_add_u32 s41, s41, 4096
    buffer_load_dwordx4 v[140:143], v4, s[28:31], s41 offen offset:0 sc1
    s_waitcnt vmcnt(8)
    s_setprio 3
    v_mfma_f32_32x32x16_bf16 v[8:23], v[80:83], v[72:75], 0
    v_mfma_f32_32x32x16_bf16 v[24:39], v[84:87], v[72:75], 0
    v_mfma_f32_32x32x16_bf16 v[40:55], v[80:83], v[76:79], 0
    v_mfma_f32_32x32x16_bf16 v[56:71], v[84:87], v[76:79], 0
    s_setprio 3
    buffer_load_dwordx4 v[72:75], v4, s[28:31], s40 offen offset:1024 sc1
    buffer_load_dwordx4 v[76:79], v4, s[28:31], s41 offen offset:1024 sc1
    buffer_load_dwordx4 v[80:83], v4, s[28:31], s42 offen offset:1024 sc1
    buffer_load_dwordx4 v[84:87], v4, s[28:31], s43 offen offset:1024 sc1
    s_waitcnt vmcnt(10)
    s_setprio 3
    v_mfma_f32_32x32x16_bf16 v[8:23], v[96:99], v[88:91], v[8:23]
    v_mfma_f32_32x32x16_bf16 v[24:39], v[100:103], v[88:91], v[24:39]
    v_mfma_f32_32x32x16_bf16 v[40:55], v[96:99], v[92:95], v[40:55]
    v_mfma_f32_32x32x16_bf16 v[56:71], v[100:103], v[92:95], v[56:71]
    s_setprio 3
    buffer_load_dwordx4 v[88:91], v4, s[28:31], s40 offen offset:2048 sc1
    buffer_load_dwordx4 v[92:95], v4, s[28:31], s41 offen offset:2048 sc1
    buffer_load_dwordx4 v[96:99], v4, s[28:31], s42 offen offset:2048 sc1
    buffer_load_dwordx4 v[100:103], v4, s[28:31], s43 offen offset:2048 sc1
    s_waitcnt vmcnt(12)
    s_setprio 3
    v_mfma_f32_32x32x16_bf16 v[8:23], v[112:115], v[104:107], v[8:23]
    v_mfma_f32_32x32x16_bf16 v[24:39], v[116:119], v[104:107], v[24:39]
    v_mfma_f32_32x32x16_bf16 v[40:55], v[112:115], v[108:111], v[40:55]
    v_mfma_f32_32x32x16_bf16 v[56:71], v[116:119], v[108:111], v[56:71]
    s_setprio 3
    buffer_load_dwordx4 v[104:107], v4, s[28:31], s40 offen offset:3072 sc1
    buffer_load_dwordx4 v[108:111], v4, s[28:31], s41 offen offset:3072 sc1
    buffer_load_dwordx4 v[112:115], v4, s[28:31], s42 offen offset:3072 sc1
    buffer_load_dwordx4 v[116:119], v4, s[28:31], s43 offen offset:3072 sc1
    s_waitcnt vmcnt(14)
    s_setprio 3
    v_mfma_f32_32x32x16_bf16 v[8:23], v[128:131], v[120:123], v[8:23]
    v_mfma_f32_32x32x16_bf16 v[24:39], v[132:135], v[120:123], v[24:39]
    v_mfma_f32_32x32x16_bf16 v[40:55], v[128:131], v[124:127], v[40:55]
    v_mfma_f32_32x32x16_bf16 v[56:71], v[132:135], v[124:127], v[56:71]
    s_setprio 3
    s_add_u32 s40, s40, 4096
    buffer_load_dwordx4 v[120:123], v4, s[28:31], s40 offen offset:0 sc1
    s_add_u32 s41, s41, 4096
    buffer_load_dwordx4 v[124:127], v4, s[28:31], s41 offen offset:0 sc1
    s_add_u32 s42, s42, 4096
    buffer_load_dwordx4 v[128:131], v4, s[28:31], s42 offen offset:0 sc1
    s_add_u32 s43, s43, 4096
    buffer_load_dwordx4 v[132:135], v4, s[28:31], s43 offen offset:0 sc1
    s_waitcnt vmcnt(16)
    s_setprio 3
    v_mfma_f32_32x32x16_bf16 v[8:23], v[144:147], v[136:139], v[8:23]
    v_mfma_f32_32x32x16_bf16 v[24:39], v[148:151], v[136:139], v[24:39]
    v_mfma_f32_32x32x16_bf16 v[40:55], v[144:147], v[140:143], v[40:55]
    v_mfma_f32_32x32x16_bf16 v[56:71], v[148:151], v[140:143], v[56:71]
    s_setprio 3
    buffer_load_dwordx4 v[136:139], v4, s[28:31], s40 offen offset:1024 sc1
    buffer_load_dwordx4 v[140:143], v4, s[28:31], s41 offen offset:1024 sc1
    buffer_load_dwordx4 v[144:147], v4, s[28:31], s42 offen offset:1024 sc1
    buffer_load_dwordx4 v[148:151], v4, s[28:31], s43 offen offset:1024 sc1
    s_waitcnt vmcnt(16)
    s_setprio 3
    v_mfma_f32_32x32x16_bf16 v[8:23], v[80:83], v[72:75], v[8:23]
    v_mfma_f32_32x32x16_bf16 v[24:39], v[84:87], v[72:75], v[24:39]
    v_mfma_f32_32x32x16_bf16 v[40:55], v[80:83], v[76:79], v[40:55]
    v_mfma_f32_32x32x16_bf16 v[56:71], v[84:87], v[76:79], v[56:71]
    s_setprio 3
    buffer_load_dwordx4 v[72:75], v4, s[28:31], s40 offen offset:2048 sc1
    buffer_load_dwordx4 v[76:79], v4, s[28:31], s41 offen offset:2048 sc1
    buffer_load_dwordx4 v[80:83], v4, s[28:31], s42 offen offset:2048 sc1
    buffer_load_dwordx4 v[84:87], v4, s[28:31], s43 offen offset:2048 sc1
    s_waitcnt vmcnt(16)
    s_setprio 3
    v_mfma_f32_32x32x16_bf16 v[8:23], v[96:99], v[88:91], v[8:23]
    v_mfma_f32_32x32x16_bf16 v[24:39], v[100:103], v[88:91], v[24:39]
    v_mfma_f32_32x32x16_bf16 v[40:55], v[96:99], v[92:95], v[40:55]
    v_mfma_f32_32x32x16_bf16 v[56:71], v[100:103], v[92:95], v[56:71]
    s_setprio 3
    buffer_load_dwordx4 v[96:99], v4, s[28:31], s69 offen offset:0 sc1
    buffer_load_dwordx4 v[100:103], v4, s[28:31], s71 offen offset:0 sc1
    s_waitcnt vmcnt(14)
    s_setprio 3
    v_mfma_f32_32x32x16_bf16 v[8:23], v[112:115], v[104:107], v[8:23]
    v_mfma_f32_32x32x16_bf16 v[24:39], v[116:119], v[104:107], v[24:39]
    v_mfma_f32_32x32x16_bf16 v[40:55], v[112:115], v[108:111], v[40:55]
    v_mfma_f32_32x32x16_bf16 v[56:71], v[116:119], v[108:111], v[56:71]
    s_setprio 3
    buffer_load_dwordx4 v[112:115], v4, s[28:31], s69 offen offset:1024 sc1
    buffer_load_dwordx4 v[116:119], v4, s[28:31], s71 offen offset:1024 sc1
    s_waitcnt vmcnt(12)
    s_setprio 3
    v_mfma_f32_32x32x16_bf16 v[8:23], v[128:131], v[120:123], v[8:23]
    v_mfma_f32_32x32x16_bf16 v[24:39], v[132:135], v[120:123], v[24:39]
    v_mfma_f32_32x32x16_bf16 v[40:55], v[128:131], v[124:127], v[40:55]
    v_mfma_f32_32x32x16_bf16 v[56:71], v[132:135], v[124:127], v[56:71]
    s_setprio 3
    buffer_load_dwordx4 v[128:131], v4, s[28:31], s69 offen offset:2048 sc1
    buffer_load_dwordx4 v[132:135], v4, s[28:31], s71 offen offset:2048 sc1
    s_waitcnt vmcnt(10)
    s_setprio 3
    v_mfma_f32_32x32x16_bf16 v[8:23], v[144:147], v[136:139], v[8:23]
    v_mfma_f32_32x32x16_bf16 v[24:39], v[148:151], v[136:139], v[24:39]
    v_mfma_f32_32x32x16_bf16 v[40:55], v[144:147], v[140:143], v[40:55]
    v_mfma_f32_32x32x16_bf16 v[56:71], v[148:151], v[140:143], v[56:71]
    s_setprio 3
    buffer_load_dwordx4 v[144:147], v4, s[28:31], s69 offen offset:3072 sc1
    buffer_load_dwordx4 v[148:151], v4, s[28:31], s71 offen offset:3072 sc1
    s_waitcnt vmcnt(8)
    s_setprio 3
    v_mfma_f32_32x32x16_bf16 v[8:23], v[80:83], v[72:75], v[8:23]
    v_mfma_f32_32x32x16_bf16 v[24:39], v[84:87], v[72:75], v[24:39]
    v_mfma_f32_32x32x16_bf16 v[40:55], v[80:83], v[76:79], v[40:55]
    v_mfma_f32_32x32x16_bf16 v[56:71], v[84:87], v[76:79], v[56:71]
    s_setprio 3
    s_add_u32 s69, s69, 4096
    buffer_load_dwordx4 v[80:83], v4, s[28:31], s69 offen offset:0 sc1
    s_add_u32 s71, s71, 4096
    buffer_load_dwordx4 v[84:87], v4, s[28:31], s71 offen offset:0 sc1
    s_mov_b32 s33, 0x100000
m_pollo:
    buffer_load_dword v162, v161, s[28:31], s67 offen sc1
    s_waitcnt vmcnt(0)
    v_xor_b32 v162, s61, v162
    v_cmp_ne_u32 vcc, 0, v162
    s_cbranch_vccz m_pollo_ok
    s_sleep 1
    s_sub_u32 s33, s33, 1
    s_cmp_lg_u32 s33, 0
    s_cbranch_scc1 m_pollo
m_pollo_ok:
    s_setprio 3
    buffer_load_dwordx4 v[88:91], v4, s[28:31], s68 offen offset:0 sc1
    buffer_load_dwordx4 v[92:95], v4, s[28:31], s70 offen offset:0 sc1
    buffer_load_dwordx4 v[104:107], v4, s[28:31], s68 offen offset:1024 sc1
    buffer_load_dwordx4 v[108:111], v4, s[28:31], s70 offen offset:1024 sc1
    buffer_load_dwordx4 v[120:123], v4, s[28:31], s68 offen offset:2048 sc1
    buffer_load_dwordx4 v[124:127], v4, s[28:31], s70 offen offset:2048 sc1
    buffer_load_dwordx4 v[136:139], v4, s[28:31], s68 offen offset:3072 sc1
    buffer_load_dwordx4 v[140:143], v4, s[28:31], s70 offen offset:3072 sc1
    s_add_u32 s68, s68, 4096
    buffer_load_dwordx4 v[72:75], v4, s[28:31], s68 offen offset:0 sc1
    s_add_u32 s70, s70, 4096
    buffer_load_dwordx4 v[76:79], v4, s[28:31], s70 offen offset:0 sc1
    s_waitcnt vmcnt(8)
    v_mfma_f32_32x32x16_bf16 v[8:23], v[96:99], v[88:91], v[8:23]
    v_mfma_f32_32x32x16_bf16 v[24:39], v[100:103], v[88:91], v[24:39]
    v_mfma_f32_32x32x16_bf16 v[40:55], v[96:99], v[92:95], v[40:55]
    v_mfma_f32_32x32x16_bf16 v[56:71], v[100:103], v[92:95], v[56:71]
    buffer_load_dwordx4 v[88:91], v4, s[28:31], s68 offen offset:1024 sc1
    buffer_load_dwordx4 v[92:95], v4, s[28:31], s70 offen offset:1024 sc1
    buffer_load_dwordx4 v[96:99], v4, s[28:31], s69 offen offset:1024 sc1
    buffer_load_dwordx4 v[100:103], v4, s[28:31], s71 offen offset:1024 sc1
    s_waitcnt vmcnt(10)
    v_mfma_f32_32x32x16_bf16 v[8:23], v[112:115], v[104:107], v[8:23]
    v_mfma_f32_32x32x16_bf16 v[24:39], v[116:119], v[104:107], v[24:39]
    v_mfma_f32_32x32x16_bf16 v[40:55], v[112:115], v[108:111], v[40:55]
    v_mfma_f32_32x32x16_bf16 v[56:71], v[116:119], v[108:111], v[56:71]
    buffer_load_dwordx4 v[104:107], v4, s[28:31], s68 offen offset:2048 sc1
    buffer_load_dwordx4 v[108:111], v4, s[28:31], s70 offen offset:2048 sc1
    buffer_load_dwordx4 v[112:115], v4, s[28:31], s69 offen offset:2048 sc1
    buffer_load_dwordx4 v[116:119], v4, s[28:31], s71 offen offset:2048 sc1
    s_waitcnt vmcnt(12)
    v_mfma_f32_32x32x16_bf16 v[8:23], v[128:131], v[120:123], v[8:23]
    v_mfma_f32_32x32x16_bf16 v[24:39], v[132:135], v[120:123], v[24:39]
    v_mfma_f32_32x32x16_bf16 v[40:55], v[128:131], v[124:127], v[40:55]
    v_mfma_f32_32x32x16_bf16 v[56:71], v[132:135], v[124:127], v[56:71]
    buffer_load_dwordx4 v[120:123], v4, s[28:31], s68 offen offset:3072 sc1
    buffer_load_dwordx4 v[124:127], v4, s[28:31], s70 offen offset:3072 sc1
    buffer_load_dwordx4 v[128:131], v4, s[28:31], s69 offen offset:3072 sc1
    buffer_load_dwordx4 v[132:135], v4, s[28:31], s71 offen offset:3072 sc1
    s_waitcnt vmcnt(14)
    v_mfma_f32_32x32x16_bf16 v[8:23], v[144:147], v[136:139], v[8:23]
    v_mfma_f32_32x32x16_bf16 v[24:39], v[148:151], v[136:139], v[24:39]
    v_mfma_f32_32x32x16_bf16 v[40:55], v[144:147], v[140:143], v[40:55]
    v_mfma_f32_32x32x16_bf16 v[56:71], v[148:151], v[140:143], v[56:71]
    s_waitcnt vmcnt(12)
    v_mfma_f32_32x32x16_bf16 v[8:23], v[80:83], v[72:75], v[8:23]
    v_mfma_f32_32x32x16_bf16 v[24:39], v[84:87], v[72:75], v[24:39]
    v_mfma_f32_32x32x16_bf16 v[40:55], v[80:83], v[76:79], v[40:55]
    v_mfma_f32_32x32x16_bf16 v[56:71], v[84:87], v[76:79], v[56:71]
    s_waitcnt vmcnt(8)
    v_mfma_f32_32x32x16_bf16 v[8:23], v[96:99], v[88:91], v[8:23]
    v_mfma_f32_32x32x16_bf16 v[24:39], v[100:103], v[88:91], v[24:39]
    v_mfma_f32_32x32x16_bf16 v[40:55], v[96:99], v[92:95], v[40:55]
    v_mfma_f32_32x32x16_bf16 v[56:71], v[100:103], v[92:95], v[56:71]
    s_waitcnt vmcnt(4)
    v_mfma_f32_32x32x16_bf16 v[8:23], v[112:115], v[104:107], v[8:23]
    v_mfma_f32_32x32x16_bf16 v[24:39], v[116:119], v[104:107], v[24:39]
    v_mfma_f32_32x32x16_bf16 v[40:55], v[112:115], v[108:111], v[40:55]
    v_mfma_f32_32x32x16_bf16 v[56:71], v[116:119], v[108:111], v[56:71]
    s_waitcnt vmcnt(0)
    v_mfma_f32_32x32x16_bf16 v[8:23], v[128:131], v[120:123], v[8:23]
    v_mfma_f32_32x32x16_bf16 v[24:39], v[132:135], v[120:123], v[24:39]
    v_mfma_f32_32x32x16_bf16 v[40:55], v[128:131], v[124:127], v[40:55]
    v_mfma_f32_32x32x16_bf16 v[56:71], v[132:135], v[124:127], v[56:71]
    s_cmp_lg_u32 s12, 0
    s_cselect_b64 exec, -1, 0
    s_nop 8
    ds_write_b128 v163, v[8:11] offset:0
    ds_write_b128 v163, v[12:15] offset:1024
    ds_write_b128 v163, v[16:19] offset:2048
    ds_write_b128 v163, v[20:23] offset:3072
    s_cmp_lg_u32 s12, 1
    s_cselect_b64 exec, -1, 0
    ds_write_b128 v164, v[24:27] offset:0
    ds_write_b128 v164, v[28:31] offset:1024
    ds_write_b128 v164, v[32:35] offset:2048
    ds_write_b128 v164, v[36:39] offset:3072
    s_cmp_lg_u32 s12, 2
    s_cselect_b64 exec, -1, 0
    ds_write_b128 v165, v[40:43] offset:0
    ds_write_b128 v165, v[44:47] offset:1024
    ds_write_b128 v165, v[48:51] offset:2048
    ds_write_b128 v165, v[52:55] offset:3072
    s_cmp_lg_u32 s12, 3
    s_cselect_b64 exec, -1, 0
    ds_write_b128 v166, v[56:59] offset:0
    ds_write_b128 v166, v[60:63] offset:1024
    ds_write_b128 v166, v[64:67] offset:2048
    ds_write_b128 v166, v[68:71] offset:3072
    s_mov_b64 exec, -1
    s_waitcnt lgkmcnt(0)
    v_mov_b32 v7, 1
    s_mov_b64 exec, 1
    ds_add_u32 v4, v7 offset:61448
    s_mov_b64 exec, -1
    ds_read_b32 v7, v4 offset:61448
m_gs21:
    s_waitcnt lgkmcnt(0)
    v_readfirstlane_b32 s34, v7
    s_cmp_ge_u32 s34, 84
    s_cbranch_scc1 m_gs21_ok
    s_sleep 1
    ds_read_b32 v7, v4 offset:61448
    s_branch m_gs21
m_gs21_ok:
    ds_read_b128 v[72:75], v1 offset:0
    ds_read_b128 v[88:91], v1 offset:4096
    ds_read_b128 v[104:107], v1 offset:8192
    ds_read_b128 v[76:79], v1 offset:1024
    ds_read_b128 v[92:95], v1 offset:5120
    ds_read_b128 v[108:111], v1 offset:9216
    ds_read_b128 v[80:83], v1 offset:2048
    ds_read_b128 v[96:99], v1 offset:6144
    ds_read_b128 v[112:115], v1 offset:10240
    ds_read_b128 v[84:87], v1 offset:3072
    ds_read_b128 v[100:103], v1 offset:7168
    ds_read_b128 v[116:119], v1 offset:11264
    v_lshlrev_b32 v136, 16, v152
    v_and_b32 v137, 0xffff0000, v152
    v_lshlrev_b32 v138, 16, v153
    v_and_b32 v139, 0xffff0000, v153
    v_lshlrev_b32 v140, 16, v154
    v_and_b32 v141, 0xffff0000, v154
    v_lshlrev_b32 v142, 16, v155
    v_and_b32 v143, 0xffff0000, v155
    v_lshlrev_b32 v144, 16, v156
    v_and_b32 v145, 0xffff0000, v156
    v_lshlrev_b32 v146, 16, v157
    v_and_b32 v147, 0xffff0000, v157
    v_lshlrev_b32 v148, 16, v158
    v_and_b32 v149, 0xffff0000, v158
    v_lshlrev_b32 v150, 16, v159
    v_and_b32 v151, 0xffff0000, v159
    s_waitcnt lgkmcnt(9)
    v_pk_add_f32 v[72:73], v[72:73], v[88:89]
    v_pk_add_f32 v[74:75], v[74:75], v[90:91]
    v_pk_add_f32 v[72:73], v[72:73], v[104:105]
    v_pk_add_f32 v[74:75], v[74:75], v[106:107]
    s_waitcnt lgkmcnt(6)
    v_pk_add_f32 v[76:77], v[76:77], v[92:93]
    v_pk_add_f32 v[78:79], v[78:79], v[94:95]
    v_pk_add_f32 v[76:77], v[76:77], v[108:109]
    v_pk_add_f32 v[78:79], v[78:79], v[110:111]
    s_waitcnt lgkmcnt(3)
    v_pk_add_f32 v[80:81], v[80:81], v[96:97]
    v_pk_add_f32 v[82:83], v[82:83], v[98:99]
    v_pk_add_f32 v[80:81], v[80:81], v[112:113]
    v_pk_add_f32 v[82:83], v[82:83], v[114:115]
    s_waitcnt lgkmcnt(0)
    v_pk_add_f32 v[84:85], v[84:85], v[100:101]
    v_pk_add_f32 v[86:87], v[86:87], v[102:103]
    v_pk_add_f32 v[84:85], v[84:85], v[116:117]
    v_pk_add_f32 v[86:87], v[86:87], v[118:119]
    s_cmp_lg_u32 s12, 0
    s_cbranch_scc1 m_oao_0
    v_pk_add_f32 v[72:73], v[72:73], v[8:9]
    v_pk_add_f32 v[74:75], v[74:75], v[10:11]
    v_pk_add_f32 v[76:77], v[76:77], v[12:13]
    v_pk_add_f32 v[78:79], v[78:79], v[14:15]
    v_pk_add_f32 v[80:81], v[80:81], v[16:17]
    v_pk_add_f32 v[82:83], v[82:83], v[18:19]
    v_pk_add_f32 v[84:85], v[84:85], v[20:21]
    v_pk_add_f32 v[86:87], v[86:87], v[22:23]
    s_branch m_oao_e
m_oao_0:
    s_cmp_lg_u32 s12, 1
    s_cbranch_scc1 m_oao_1
    v_pk_add_f32 v[72:73], v[72:73], v[24:25]
    v_pk_add_f32 v[74:75], v[74:75], v[26:27]
    v_pk_add_f32 v[76:77], v[76:77], v[28:29]
    v_pk_add_f32 v[78:79], v[78:79], v[30:31]
    v_pk_add_f32 v[80:81], v[80:81], v[32:33]
    v_pk_add_f32 v[82:83], v[82:83], v[34:35]
    v_pk_add_f32 v[84:85], v[84:85], v[36:37]
    v_pk_add_f32 v[86:87], v[86:87], v[38:39]
    s_branch m_oao_e
m_oao_1:
    s_cmp_lg_u32 s12, 2
    s_cbranch_scc1 m_oao_2
    v_pk_add_f32 v[72:73], v[72:73], v[40:41]
    v_pk_add_f32 v[74:75], v[74:75], v[42:43]
    v_pk_add_f32 v[76:77], v[76:77], v[44:45]
    v_pk_add_f32 v[78:79], v[78:79], v[46:47]
    v_pk_add_f32 v[80:81], v[80:81], v[48:49]
    v_pk_add_f32 v[82:83], v[82:83], v[50:51]
    v_pk_add_f32 v[84:85], v[84:85], v[52:53]
    v_pk_add_f32 v[86:87], v[86:87], v[54:55]
    s_branch m_oao_e
m_oao_2:
    v_pk_add_f32 v[72:73], v[72:73], v[56:57]
    v_pk_add_f32 v[74:75], v[74:75], v[58:59]
    v_pk_add_f32 v[76:77], v[76:77], v[60:61]
    v_pk_add_f32 v[78:79], v[78:79], v[62:63]
    v_pk_add_f32 v[80:81], v[80:81], v[64:65]
    v_pk_add_f32 v[82:83], v[82:83], v[66:67]
    v_pk_add_f32 v[84:85], v[84:85], v[68:69]
    v_pk_add_f32 v[86:87], v[86:87], v[70:71]
m_oao_e:
    s_nop 1
    v_permlane32_swap_b32 v72, v76
    v_permlane32_swap_b32 v73, v77
    v_permlane32_swap_b32 v74, v78
    v_permlane32_swap_b32 v75, v79
    v_pk_add_f32 v[72:73], v[72:73], v[136:137]
    v_pk_add_f32 v[74:75], v[74:75], v[138:139]
    v_pk_add_f32 v[76:77], v[76:77], v[140:141]
    v_pk_add_f32 v[78:79], v[78:79], v[142:143]
    v_cvt_pk_bf16_f32 v152, v72, v73
    v_cvt_pk_bf16_f32 v153, v74, v75
    v_cvt_pk_bf16_f32 v154, v76, v77
    v_cvt_pk_bf16_f32 v155, v78, v79
    buffer_store_dwordx4 v[152:155], v160, s[44:47], 0 offen offset:0
    v_permlane32_swap_b32 v80, v84
    v_permlane32_swap_b32 v81, v85
    v_permlane32_swap_b32 v82, v86
    v_permlane32_swap_b32 v83, v87
    v_pk_add_f32 v[80:81], v[80:81], v[144:145]
    v_pk_add_f32 v[82:83], v[82:83], v[146:147]
    v_pk_add_f32 v[84:85], v[84:85], v[148:149]
    v_pk_add_f32 v[86:87], v[86:87], v[150:151]
    v_cvt_pk_bf16_f32 v156, v80, v81
    v_cvt_pk_bf16_f32 v157, v82, v83
    v_cvt_pk_bf16_f32 v158, v84, v85
    v_cvt_pk_bf16_f32 v159, v86, v87
    buffer_store_dwordx4 v[156:159], v160, s[44:47], 0 offen offset:32
    s_cmp_lg_u32 s12, 0
    s_cbranch_scc1 m_noep
    v_mov_b32 v162, s61
    s_mov_b32 s36, 24444928
    buffer_store_dword v162, off, s[28:31], s36
m_noep:
    s_endpgm
m_end:
    s_endpgm
.section .rodata,"a"
.p2align 6
.amdhsa_kernel parallel_sum__softmax_full_mha__mixer_gmlp__prompt_kernel
  .amdhsa_next_free_vgpr 168
  .amdhsa_next_free_sgpr 96
  .amdhsa_accum_offset 168
  .amdhsa_group_segment_fixed_size 0
  .amdhsa_kernarg_size 88
  .amdhsa_user_sgpr_count 2
  .amdhsa_user_sgpr_kernarg_segment_ptr 1
  .amdhsa_system_sgpr_workgroup_id_x 1
.end_amdhsa_kernel
```
